```python
import torch

def _softmax(x, axis=-1):
    return torch.softmax(x, dim=axis)

def _gelu(x):
    return torch.nn.functional.gelu(x, approximate='tanh')

def _silu(x):
    return torch.nn.functional.silu(x)

def _sigmoid(x):
    return torch.sigmoid(x)

def _layernorm(x, axis=-1, eps=1e-05):
    m = x.mean(dim=axis, keepdim=True)
    v = x.var(dim=axis, keepdim=True, unbiased=False)
    return (x - m) / torch.sqrt(v + eps)

def _scatter_add(tgt, idx, src, axis=0):
    return tgt.clone().index_add_(axis, idx, src)

def _segment_sum(src, seg, n):
    out = torch.zeros((n,) + src.shape[1:], dtype=src.dtype)
    return out.index_add_(0, seg, src)

def _pad(x, pw):
    flat = tuple((v for pair in reversed(pw) for v in pair))
    return torch.nn.functional.pad(x, flat)
kernel_name = 'adaLN_cond__compressed_kv_cla__geglu_ffn__prompt'

def setup_inputs():

    _w = lambda a: (lambda t: t.to(torch.bfloat16) if t.is_floating_point() else t)(torch.as_tensor(a))

    def _A_setup():
        B, H, Sq, Sk, D, M = (1, 32, 2048, 2048, 128, 512)
        Dc = 4 * D
        return {'x': _w((lambda *s: torch.randn(*s, dtype=torch.bfloat16) * 0.05)(B, Sq, M)), 'c_kv': _w((lambda *s: torch.randn(*s, dtype=torch.bfloat16) * 1.6)(B, Sk, Dc)), 'w_q': _w((lambda *s: torch.randn(*s, dtype=torch.bfloat16) * 0.8)(M, H, D) * M ** (-0.5)), 'w_uk': _w((lambda *s: torch.randn(*s, dtype=torch.bfloat16) * 0.8)(Dc, H, D) * Dc ** (-0.5)), 'w_uv': _w((lambda *s: torch.randn(*s, dtype=torch.bfloat16) * 1.6)(Dc, H, D) * Dc ** (-0.5)), 'w_o': _w((lambda *s: torch.randn(*s, dtype=torch.bfloat16) * 1.6)(H, D, M) * (H * D) ** (-0.5))}
    _A_in = _A_setup()

    def _B_setup():
        B, S, D, F = (1, 2048, 512, 1376)
        return {'x': _w((lambda *s: torch.randn(*s, dtype=torch.bfloat16) * 0.05)(B, S, D)), 'w_gate': _w((lambda *s: torch.randn(*s, dtype=torch.bfloat16) * 0.05)(D, F)), 'w_up': _w((lambda *s: torch.randn(*s, dtype=torch.bfloat16) * 0.05)(D, F)), 'w_down': _w((lambda *s: torch.randn(*s, dtype=torch.bfloat16) * 0.05)(F, D))}
    _B_in = _B_setup()
    return {'A_x': _A_in['x'], 'A_c_kv': _A_in['c_kv'], 'A_w_q': _A_in['w_q'], 'A_w_uk': _A_in['w_uk'], 'A_w_uv': _A_in['w_uv'], 'A_w_o': _A_in['w_o'], 'B_x': _B_in['x'], 'B_w_gate': _B_in['w_gate'], 'B_w_up': _B_in['w_up'], 'B_w_down': _B_in['w_down'], 'c': _w((lambda *s: torch.randn(*s, dtype=torch.bfloat16) * 0.1)(1, 512) * 8.0), 'w_mod': _w((lambda *s: torch.randn(*s, dtype=torch.bfloat16) * 0.1)(512, 6 * 512) * 512 ** (-0.5) * 8.0)}

def reference(A_x, A_c_kv, A_w_q, A_w_uk, A_w_uv, A_w_o, B_x, B_w_gate, B_w_up, B_w_down, c, w_mod):

    def _A_ref(x, c_kv, w_q, w_uk, w_uv, w_o):
        B, Sq, M = (x.shape[0], x.shape[1], x.shape[2])
        Sk = c_kv.shape[1]
        H, D = (w_q.shape[1], w_q.shape[2])
        q = torch.einsum('bqm,mhd->bhqd', x, w_q)
        k = torch.einsum('bkc,chd->bhkd', c_kv, w_uk)
        v = torch.einsum('bkc,chd->bhkd', c_kv, w_uv)
        scores = torch.einsum('bhqd,bhkd->bhqk', q, k) * D ** (-0.5)
        off = Sk - Sq
        qi = torch.arange(Sq)[:, None]
        kj = torch.arange(Sk)[None, :]
        cmask = kj <= qi + off
        scores = torch.where(cmask[None, None], scores, -1000000000.0)
        p = _softmax(scores, axis=-1)
        ctx = torch.einsum('bhqk,bhkd->bhqd', p, v)
        return torch.einsum('bhqd,hdm->bqm', ctx, w_o)

    def _B_ref(x, w_gate, w_up, w_down):
        return _gelu(x @ w_gate) * (x @ w_up) @ w_down
    x = A_x
    mod = (_silu(c) @ w_mod).reshape(c.shape[0], 6, 1, -1)
    sa, ca, ga, sb, cb, gb = (mod[:, 0].clone(), mod[:, 1].clone(), mod[:, 2].clone(), mod[:, 3].clone(), mod[:, 4].clone(), mod[:, 5].clone())
    h = _layernorm(x, axis=-1) * (1 + ca) + sa
    x = x + ga * _A_ref(h, A_c_kv, A_w_q, A_w_uk, A_w_uv, A_w_o)
    h = _layernorm(x, axis=-1) * (1 + cb) + sb
    x = x + gb * _B_ref(h, B_w_gate, B_w_up, B_w_down)
    return x
```

```asm
; @launch grid=(256,1,1) block=(512,1,1) lds=163840
.amdgcn_target "amdgcn-amd-amdhsa--gfx950"
.text
.globl adaLN_cond__compressed_kv_cla__geglu_ffn__prompt_kernel
.p2align 8
.type adaLN_cond__compressed_kv_cla__geglu_ffn__prompt_kernel,@function
adaLN_cond__compressed_kv_cla__geglu_ffn__prompt_kernel:
  s_cmp_ge_u32 s2, 256
  s_cbranch_scc1 adaLN_cond__compressed_kv_cla__geglu_ffn__prompt_kernel_end
  s_load_dwordx2 s[20:21], s[0:1], 8
  s_load_dwordx2 s[52:53], s[0:1], 24
  s_load_dwordx2 s[56:57], s[0:1], 32
  s_load_dwordx2 s[8:9], s[0:1], 16
  s_load_dwordx2 s[4:5], s[0:1], 112
  s_load_dwordx2 s[68:69], s[0:1], 104
  s_load_dwordx2 s[24:25], s[0:1], 80
  s_load_dwordx2 s[82:83], s[0:1], 88
  s_load_dwordx2 s[84:85], s[0:1], 0
  v_lshrrev_b32 v1, 6, v0
  v_and_b32 v0, 63, v0
  s_and_b32 s35, s2, 7
  v_readfirstlane_b32 s28, v1
  s_lshr_b32 s36, s2, 3
  s_lshl_b32 s30, s35, 2
  s_and_b32 s35, s36, 3
  s_add_u32 s30, s30, s35
  s_lshr_b32 s31, s36, 2
  s_lshl_b32 s60, s35, 1
  s_add_u32 s60, s60, s31
  s_and_b32 s60, s60, 7
  v_lshlrev_b32 v1, 4, v0
  v_lshrrev_b32 v208, 4, v0
  v_and_b32 v209, 16, v0
  v_and_b32 v210, 7, v0
  v_lshrrev_b32 v213, 3, v0
  v_lshlrev_b32 v2, 2, v210
  v_xor_b32 v2, v2, v209
  v_lshlrev_b32 v2, 2, v2
  v_lshl_add_u32 v2, v213, 13, v2
  v_xor_b32 v3, v210, v208
  v_lshlrev_b32 v3, 4, v3
  v_lshl_add_u32 v3, v213, 10, v3
  v_xor_b32 v4, 64, v3
  s_mov_b32 s22, 2097152
  s_mov_b32 s23, 0x20000
  s_mov_b32 s54, 4194304
  s_mov_b32 s55, 0x20000
  s_mov_b32 s58, 4194304
  s_mov_b32 s59, 0x20000
  s_lshl_b32 s37, s31, 18
  s_lshl_b32 s35, s28, 15
  s_add_u32 s37, s37, s35
  s_lshl_b32 s6, s28, 13
  s_lshl_b32 s48, s28, 10
  s_lshl_b32 s49, s30, 8
  s_lshl_b32 s35, s28, 16
  s_add_u32 s49, s49, s35
  s_lshl_b32 s60, s60, 12
  v_and_b32 v15, 3, v0
  v_lshlrev_b32 v15, 6, v15
  v_lshl_add_u32 v15, v208, 4, v15
  s_and_b32 s75, s2, 3
  s_lshl_b32 s73, s75, 8
  s_mov_b32 s26, 1024
  s_mov_b32 s27, 0x20000
  s_waitcnt lgkmcnt(0)
  buffer_load_dwordx4 v[252:255], v15, s[24:27], s73 offen
  s_add_u32 m0, s48, 65536
  s_add_u32 s35, s49, 0
  buffer_load_dwordx4 v2, s[52:55], s35 offen lds
  s_add_u32 m0, s48, 73728
  s_add_u32 s35, s49, 128
  buffer_load_dwordx4 v2, s[52:55], s35 offen lds
  s_add_u32 m0, s6, 0
  s_add_u32 s35, s37, 0
  buffer_load_dwordx4 v3, s[20:23], s35 offen lds
  s_add_u32 m0, s6, 1024
  s_add_u32 s35, s37, 8192
  buffer_load_dwordx4 v4, s[20:23], s35 offen lds
  s_add_u32 m0, s6, 2048
  s_add_u32 s35, s37, 16384
  buffer_load_dwordx4 v3, s[20:23], s35 offen lds
  s_add_u32 m0, s6, 3072
  s_add_u32 s35, s37, 24576
  buffer_load_dwordx4 v4, s[20:23], s35 offen lds
  v_mul_u32_u24 v13, 6144, v213
  v_lshl_add_u32 v13, v210, 4, v13
  s_lshl_b32 s73, s75, 3
  s_add_u32 s73, s73, s28
  s_mul_i32 s74, s73, 98304
  s_lshr_b32 s73, s2, 2
  s_lshl_b32 s73, s73, 7
  s_add_u32 s74, s74, s73
  s_cmp_lt_u32 s2, 192
  s_cselect_b32 s74, s74, 0x10000000
  s_lshl_b32 s36, s28, 11
  s_mov_b32 s24, s82
  s_mov_b32 s25, s83
  s_mov_b32 s26, 3145728
  s_mov_b32 s27, 0x20000
  s_lshr_b32 s50, s60, 5
  s_max_u32 s50, s50, 128
  s_barrier
  s_add_u32 m0, s36, 147456
  s_add_u32 s73, s74, 0
  buffer_load_dwordx4 v13, s[24:27], s73 offen lds
  s_add_u32 m0, s36, 148480
  s_add_u32 s73, s74, 49152
  buffer_load_dwordx4 v13, s[24:27], s73 offen lds
  s_add_u32 m0, s48, 81920
  s_add_u32 s35, s49, 524288
  buffer_load_dwordx4 v2, s[52:55], s35 offen lds
  s_add_u32 m0, s48, 90112
  s_add_u32 s35, s49, 524416
  buffer_load_dwordx4 v2, s[52:55], s35 offen lds
  s_getpc_b64 s[24:25]
u_pc:
  s_sub_u32 s24, s24, u_pc-adaLN_cond__compressed_kv_cla__geglu_ffn__prompt_kernel
  s_subb_u32 s25, s25, 0
  s_lshr_b32 s35, s2, 3
  s_lshl_b32 s35, s35, 3
  s_add_u32 s35, s35, s28
  s_lshl_b32 s35, s35, 9
  v_lshlrev_b32 v13, 7, v0
  v_add_u32 v13, s35, v13
  v_min_u32 v13, text_end-adaLN_cond__compressed_kv_cla__geglu_ffn__prompt_kernel-4, v13
  s_mov_b64 exec, 0xf
  global_load_dword v14, v13, s[24:25]
  s_mov_b64 exec, -1
  s_add_u32 m0, s6, 4096
  s_add_u32 s35, s37, 128
  buffer_load_dwordx4 v3, s[20:23], s35 offen lds
  s_add_u32 m0, s6, 5120
  s_add_u32 s35, s37, 8320
  buffer_load_dwordx4 v4, s[20:23], s35 offen lds
  s_add_u32 m0, s6, 6144
  s_add_u32 s35, s37, 16512
  buffer_load_dwordx4 v3, s[20:23], s35 offen lds
  s_add_u32 m0, s6, 7168
  s_add_u32 s35, s37, 24704
  buffer_load_dwordx4 v4, s[20:23], s35 offen lds
  s_lshr_b32 s29, s28, 2
  s_and_b32 s45, s28, 3
  s_sub_u32 s35, 15, s31
  s_cmp_eq_u32 s29, 0
  s_cselect_b32 s32, s35, s31
  s_lshl_b32 s32, s32, 2
  s_add_u32 s32, s32, s45
  s_lshl_b32 s34, s35, 1
  s_add_u32 s34, s34, 2
  s_cmp_lt_u32 s30, 16
  s_cselect_b32 s72, s31, s35
  s_lshl_b32 s72, s72, 7
  s_and_b32 s35, s30, 15
  s_lshl_b32 s35, s35, 3
  s_add_u32 s72, s72, s35
  s_lshl_b32 s42, s32, 15
  v_bfe_u32 v210, v0, 2, 2
  v_lshrrev_b32 v211, 5, v0
  v_lshl_add_u32 v240, v211, 3, v210
  v_lshlrev_b32 v240, 7, v240
  v_and_b32 v212, 8, v0
  v_lshl_add_u32 v240, v212, 3, v240
  v_lshl_add_u32 v240, v209, 1, v240
  v_and_b32 v212, 3, v0
  v_lshl_add_u32 v240, v212, 3, v240
  v_add_u32 v240, 0x10000, v240
  v_xor_b32 v241, 64, v240
  v_add_u32 v242, 0x10000, v240
  v_add_u32 v243, 0x10000, v241
  v_and_b32 v210, 31, v0
  v_bfe_u32 v212, v0, 1, 3
  v_xor_b32 v212, v212, v211
  v_lshlrev_b32 v5, 7, v210
  v_lshl_add_u32 v5, v212, 4, v5
  v_add_u32 v5, s6, v5
  v_xor_b32 v6, 32, v5
  v_xor_b32 v7, 64, v5
  v_xor_b32 v8, 96, v5
  s_mov_b32 s10, 4194304
  s_mov_b32 s11, 0x20000
  s_mov_b32 s70, 256
  s_mov_b32 s71, 0x20000
  s_lshl_b32 s35, s30, 20
  s_add_u32 s12, s4, s35
  s_addc_u32 s13, s5, 0
  s_mov_b32 s14, 1048576
  s_mov_b32 s15, 0x20000
  s_lshl_b32 s7, s31, 16
  s_add_u32 s7, s7, s6
  s_cmp_eq_u32 s28, 0
  s_cselect_b32 s63, 0, 0x10000000
  s_add_u32 s16, s4, 50331648
  s_addc_u32 s17, s5, 0
  s_mov_b32 s18, 2097152
  s_mov_b32 s19, 0x20000
  s_add_u32 s64, s4, 61865984
  s_addc_u32 s65, s5, 0
  s_mov_b32 s66, 65536
  s_mov_b32 s67, 0x20000
  s_add_u32 s76, s4, 60850176
  s_addc_u32 s77, s5, 0
  s_mov_b32 s78, 98304
  s_mov_b32 s79, 0x20000
  s_mov_b32 s24, s84
  s_mov_b32 s25, s85
  s_mov_b32 s26, 2097152
  s_mov_b32 s27, 0x20000
  s_waitcnt vmcnt(15)
  v_lshlrev_b32 v176, 16, v252
  v_and_b32 v177, 0xffff0000, v252
  v_lshlrev_b32 v178, 16, v253
  v_and_b32 v179, 0xffff0000, v253
  v_lshlrev_b32 v180, 16, v254
  v_and_b32 v181, 0xffff0000, v254
  v_lshlrev_b32 v182, 16, v255
  v_and_b32 v183, 0xffff0000, v255
  v_mul_f32 v184, 0xbfb8aa3b, v176
  v_mul_f32 v185, 0xbfb8aa3b, v177
  v_mul_f32 v186, 0xbfb8aa3b, v178
  v_mul_f32 v187, 0xbfb8aa3b, v179
  v_mul_f32 v188, 0xbfb8aa3b, v180
  v_mul_f32 v189, 0xbfb8aa3b, v181
  v_mul_f32 v190, 0xbfb8aa3b, v182
  v_mul_f32 v191, 0xbfb8aa3b, v183
  v_exp_f32 v184, v184
  v_exp_f32 v185, v185
  v_exp_f32 v186, v186
  v_exp_f32 v187, v187
  v_exp_f32 v188, v188
  v_exp_f32 v189, v189
  v_exp_f32 v190, v190
  v_exp_f32 v191, v191
  v_add_f32 v184, 1.0, v184
  v_add_f32 v185, 1.0, v185
  v_add_f32 v186, 1.0, v186
  v_add_f32 v187, 1.0, v187
  v_add_f32 v188, 1.0, v188
  v_add_f32 v189, 1.0, v189
  v_add_f32 v190, 1.0, v190
  v_add_f32 v191, 1.0, v191
  v_rcp_f32 v184, v184
  v_rcp_f32 v185, v185
  v_rcp_f32 v186, v186
  v_rcp_f32 v187, v187
  v_rcp_f32 v188, v188
  v_rcp_f32 v189, v189
  v_rcp_f32 v190, v190
  v_rcp_f32 v191, v191
  v_mul_f32 v176, v176, v184
  v_mul_f32 v177, v177, v185
  v_mul_f32 v178, v178, v186
  v_mul_f32 v179, v179, v187
  v_mul_f32 v180, v180, v188
  v_mul_f32 v181, v181, v189
  v_mul_f32 v182, v182, v190
  v_mul_f32 v183, v183, v191
  v_cvt_pk_bf16_f32 v252, v176, v177
  v_cvt_pk_bf16_f32 v253, v178, v179
  v_cvt_pk_bf16_f32 v254, v180, v181
  v_cvt_pk_bf16_f32 v255, v182, v183
  s_nop 0
  v_mov_b32_dpp v192, v252 quad_perm:[0,0,0,0] row_mask:0xf bank_mask:0xf
  v_mov_b32_dpp v193, v253 quad_perm:[0,0,0,0] row_mask:0xf bank_mask:0xf
  v_mov_b32_dpp v194, v254 quad_perm:[0,0,0,0] row_mask:0xf bank_mask:0xf
  v_mov_b32_dpp v195, v255 quad_perm:[0,0,0,0] row_mask:0xf bank_mask:0xf
  v_mov_b32_dpp v196, v252 quad_perm:[1,1,1,1] row_mask:0xf bank_mask:0xf
  v_mov_b32_dpp v197, v253 quad_perm:[1,1,1,1] row_mask:0xf bank_mask:0xf
  v_mov_b32_dpp v198, v254 quad_perm:[1,1,1,1] row_mask:0xf bank_mask:0xf
  v_mov_b32_dpp v199, v255 quad_perm:[1,1,1,1] row_mask:0xf bank_mask:0xf
  v_mov_b32_dpp v200, v252 quad_perm:[2,2,2,2] row_mask:0xf bank_mask:0xf
  v_mov_b32_dpp v201, v253 quad_perm:[2,2,2,2] row_mask:0xf bank_mask:0xf
  v_mov_b32_dpp v202, v254 quad_perm:[2,2,2,2] row_mask:0xf bank_mask:0xf
  v_mov_b32_dpp v203, v255 quad_perm:[2,2,2,2] row_mask:0xf bank_mask:0xf
  v_mov_b32_dpp v244, v252 quad_perm:[3,3,3,3] row_mask:0xf bank_mask:0xf
  v_mov_b32_dpp v245, v253 quad_perm:[3,3,3,3] row_mask:0xf bank_mask:0xf
  v_mov_b32_dpp v246, v254 quad_perm:[3,3,3,3] row_mask:0xf bank_mask:0xf
  v_mov_b32_dpp v247, v255 quad_perm:[3,3,3,3] row_mask:0xf bank_mask:0xf
  s_waitcnt vmcnt(9)
  ds_read_b128 v[80:83], v5 offset:0
  ds_read_b128 v[84:87], v6 offset:0
  ds_read_b128 v[88:91], v7 offset:0
  ds_read_b128 v[92:95], v8 offset:0
  s_barrier
  ds_read_b64_tr_b16 v[208:209], v240 offset:0
  ds_read_b64_tr_b16 v[210:211], v240 offset:512
  ds_read_b64_tr_b16 v[212:213], v241 offset:0
  ds_read_b64_tr_b16 v[214:215], v241 offset:512
  ds_read_b64_tr_b16 v[216:217], v240 offset:8192
  ds_read_b64_tr_b16 v[218:219], v240 offset:8704
  ds_read_b64_tr_b16 v[220:221], v241 offset:8192
  ds_read_b64_tr_b16 v[222:223], v241 offset:8704
  ds_read_b64_tr_b16 v[224:225], v240 offset:2048
  ds_read_b64_tr_b16 v[226:227], v240 offset:2560
  ds_read_b64_tr_b16 v[228:229], v241 offset:2048
  ds_read_b64_tr_b16 v[230:231], v241 offset:2560
  s_waitcnt lgkmcnt(12)
  s_waitcnt lgkmcnt(8)
  v_mfma_f32_32x32x16_bf16 v[16:31], v[208:211], v[80:83], 0
  ds_read_b64_tr_b16 v[232:233], v240 offset:10240
  ds_read_b64_tr_b16 v[234:235], v240 offset:10752
  s_add_u32 m0, s48, 98304
  s_add_u32 s35, s49, 1048576
  buffer_load_dwordx4 v2, s[52:55], s35 offen lds
  v_mfma_f32_32x32x16_bf16 v[32:47], v[212:215], v[80:83], 0
  ds_read_b64_tr_b16 v[236:237], v241 offset:10240
  ds_read_b64_tr_b16 v[238:239], v241 offset:10752
  s_add_u32 m0, s48, 131072
  s_and_b32 s35, s2, 0xf8
  s_lshl_b32 s35, s35, 14
  s_add_u32 s35, s35, s6
  s_and_b32 s36, s2, 7
  s_lshl_b32 s36, s36, 10
  s_add_u32 s35, s35, s36
  s_add_u32 s35, s35, 0
  buffer_load_dwordx4 v1, s[52:55], s35 offen lds
  s_waitcnt lgkmcnt(8)
  v_mfma_f32_32x32x16_bf16 v[48:63], v[216:219], v[80:83], 0
  ds_read_b64_tr_b16 v[208:209], v240 offset:4096
  ds_read_b64_tr_b16 v[210:211], v240 offset:4608
  s_add_u32 m0, s48, 106496
  s_add_u32 s35, s49, 1048704
  buffer_load_dwordx4 v2, s[52:55], s35 offen lds
  v_mfma_f32_32x32x16_bf16 v[64:79], v[220:223], v[80:83], 0
  ds_read_b64_tr_b16 v[212:213], v241 offset:4096
  ds_read_b64_tr_b16 v[214:215], v241 offset:4608
  s_add_u32 m0, s48, 131072
  s_and_b32 s35, s2, 0xf8
  s_lshl_b32 s35, s35, 14
  s_add_u32 s35, s35, s6
  s_and_b32 s36, s2, 7
  s_lshl_b32 s36, s36, 10
  s_add_u32 s35, s35, s36
  s_add_u32 s35, s35, 65536
  buffer_load_dwordx4 v1, s[52:55], s35 offen lds
  s_waitcnt lgkmcnt(8)
  v_mfma_f32_32x32x16_bf16 v[16:31], v[224:227], v[84:87], v[16:31]
  ds_read_b64_tr_b16 v[216:217], v240 offset:12288
  ds_read_b64_tr_b16 v[218:219], v240 offset:12800
  s_add_u32 m0, s6, 0
  s_add_u32 s35, s37, 256
  buffer_load_dwordx4 v3, s[20:23], s35 offen lds
  v_mfma_f32_32x32x16_bf16 v[32:47], v[228:231], v[84:87], v[32:47]
  ds_read_b64_tr_b16 v[220:221], v241 offset:12288
  ds_read_b64_tr_b16 v[222:223], v241 offset:12800
  s_add_u32 m0, s48, 131072
  s_lshl_b32 s35, s2, 13
  s_add_u32 s35, s35, s48
  buffer_load_dwordx4 v1, s[20:23], s35 offen lds
  s_waitcnt lgkmcnt(8)
  v_mfma_f32_32x32x16_bf16 v[48:63], v[232:235], v[84:87], v[48:63]
  ds_read_b64_tr_b16 v[224:225], v240 offset:6144
  ds_read_b64_tr_b16 v[226:227], v240 offset:6656
  s_add_u32 m0, s6, 1024
  s_add_u32 s35, s37, 8448
  buffer_load_dwordx4 v4, s[20:23], s35 offen lds
  v_mfma_f32_32x32x16_bf16 v[64:79], v[236:239], v[84:87], v[64:79]
  ds_read_b64_tr_b16 v[228:229], v241 offset:6144
  ds_read_b64_tr_b16 v[230:231], v241 offset:6656
  s_waitcnt lgkmcnt(8)
  v_mfma_f32_32x32x16_bf16 v[16:31], v[208:211], v[88:91], v[16:31]
  ds_read_b64_tr_b16 v[232:233], v240 offset:14336
  ds_read_b64_tr_b16 v[234:235], v240 offset:14848
  s_add_u32 m0, s6, 2048
  s_add_u32 s35, s37, 16640
  buffer_load_dwordx4 v3, s[20:23], s35 offen lds
  v_mfma_f32_32x32x16_bf16 v[32:47], v[212:215], v[88:91], v[32:47]
  ds_read_b64_tr_b16 v[236:237], v241 offset:14336
  ds_read_b64_tr_b16 v[238:239], v241 offset:14848
  s_waitcnt lgkmcnt(8)
  v_mfma_f32_32x32x16_bf16 v[48:63], v[216:219], v[88:91], v[48:63]
  s_waitcnt vmcnt(13)
  s_barrier
  ds_read_b64_tr_b16 v[208:209], v240 offset:16384
  ds_read_b64_tr_b16 v[210:211], v240 offset:16896
  s_add_u32 m0, s6, 3072
  s_add_u32 s35, s37, 24832
  buffer_load_dwordx4 v4, s[20:23], s35 offen lds
  v_mfma_f32_32x32x16_bf16 v[64:79], v[220:223], v[88:91], v[64:79]
  ds_read_b64_tr_b16 v[212:213], v241 offset:16384
  ds_read_b64_tr_b16 v[214:215], v241 offset:16896
  s_waitcnt vmcnt(9)
  ds_read_b128 v[96:99], v5 offset:4096
  ds_read_b128 v[100:103], v6 offset:4096
  ds_read_b128 v[104:107], v7 offset:4096
  ds_read_b128 v[108:111], v8 offset:4096
  s_waitcnt lgkmcnt(12)
  v_mfma_f32_32x32x16_bf16 v[16:31], v[224:227], v[92:95], v[16:31]
  ds_read_b64_tr_b16 v[216:217], v240 offset:24576
  ds_read_b64_tr_b16 v[218:219], v240 offset:25088
  s_add_u32 m0, s48, 114688
  s_add_u32 s35, s49, 1572864
  buffer_load_dwordx4 v2, s[52:55], s35 offen lds
  v_lshrrev_b32 v15, 4, v0
  v_bfe_u32 v13, v0, 2, 2
  v_lshl_add_u32 v13, v15, 3, v13
  v_and_b32 v14, 3, v0
  v_mfma_f32_32x32x16_bf16 v[32:47], v[228:231], v[92:95], v[32:47]
  ds_read_b64_tr_b16 v[220:221], v241 offset:24576
  ds_read_b64_tr_b16 v[222:223], v241 offset:25088
  v_lshlrev_b32 v14, 3, v14
  v_lshl_add_u32 v14, v13, 7, v14
  s_lshl_b32 s73, s45, 5
  s_waitcnt lgkmcnt(12)
  v_mfma_f32_32x32x16_bf16 v[48:63], v[232:235], v[92:95], v[48:63]
  ds_read_b64_tr_b16 v[224:225], v240 offset:18432
  ds_read_b64_tr_b16 v[226:227], v240 offset:18944
  s_waitcnt lgkmcnt(6)
  s_add_u32 m0, s6, 4096
  s_add_u32 s35, s37, 384
  buffer_load_dwordx4 v3, s[20:23], s35 offen lds
  s_add_u32 s73, s73, 147456
  v_add_u32 v14, s73, v14
  ds_read_b64_tr_b16 v[176:177], v14 offset:0
  v_mfma_f32_32x32x16_bf16 v[64:79], v[236:239], v[92:95], v[64:79]
  ds_read_b64_tr_b16 v[228:229], v241 offset:18432
  ds_read_b64_tr_b16 v[230:231], v241 offset:18944
  ds_read_b64_tr_b16 v[178:179], v14 offset:512
  ds_read_b64_tr_b16 v[180:181], v14 offset:4096
  ds_read_b64_tr_b16 v[182:183], v14 offset:4608
  s_waitcnt lgkmcnt(15)
  v_mfma_f32_32x32x16_bf16 v[16:31], v[208:211], v[96:99], v[16:31]
  ds_read_b64_tr_b16 v[232:233], v240 offset:26624
  ds_read_b64_tr_b16 v[234:235], v240 offset:27136
  s_add_u32 s35, s72, s28
  s_lshl_b32 s35, s35, 10
  buffer_load_dwordx4 v[204:207], v1, s[24:27], s35 offen
  ds_read_b64_tr_b16 v[184:185], v14 offset:8192
  ds_read_b64_tr_b16 v[186:187], v14 offset:8704
  ds_read_b64_tr_b16 v[188:189], v14 offset:12288
  ds_read_b64_tr_b16 v[190:191], v14 offset:12800
  v_mfma_f32_32x32x16_bf16 v[32:47], v[212:215], v[96:99], v[32:47]
  ds_read_b64_tr_b16 v[236:237], v241 offset:26624
  ds_read_b64_tr_b16 v[238:239], v241 offset:27136
  s_add_u32 m0, s6, 5120
  s_add_u32 s35, s37, 8576
  buffer_load_dwordx4 v4, s[20:23], s35 offen lds
  v_lshlrev_b32 v13, 4, v15
  v_lshlrev_b32 v15, 13, v0
  s_waitcnt lgkmcnt(2)
  v_mfma_f32_16x16x32_bf16 v[248:251], v[176:179], v[192:195], 0
  v_mfma_f32_16x16x32_bf16 v[248:251], v[180:183], v[196:199], v[248:251]
  v_mfma_f32_16x16x32_bf16 v[248:251], v[184:187], v[200:203], v[248:251]
  v_mfma_f32_16x16x32_bf16 v[248:251], v[188:191], v[244:247], v[248:251]
  s_waitcnt lgkmcnt(15)
  v_mfma_f32_32x32x16_bf16 v[48:63], v[216:219], v[96:99], v[48:63]
  ds_read_b64_tr_b16 v[208:209], v240 offset:20480
  ds_read_b64_tr_b16 v[210:211], v240 offset:20992
  v_mov_b32 v252, 0
  s_and_b32 s73, s2, 3
  s_mul_i32 s73, s73, 12288
  v_mfma_f32_32x32x16_bf16 v[64:79], v[220:223], v[96:99], v[64:79]
  ds_read_b64_tr_b16 v[212:213], v241 offset:20480
  ds_read_b64_tr_b16 v[214:215], v241 offset:20992
  s_lshr_b32 s74, s2, 2
  s_lshl_b32 s74, s74, 8
  s_add_u32 s73, s73, s74
  s_waitcnt lgkmcnt(15)
  v_mfma_f32_32x32x16_bf16 v[16:31], v[224:227], v[100:103], v[16:31]
  ds_read_b64_tr_b16 v[216:217], v240 offset:28672
  ds_read_b64_tr_b16 v[218:219], v240 offset:29184
  s_add_u32 m0, s6, 6144
  s_add_u32 s35, s37, 16768
  buffer_load_dwordx4 v3, s[20:23], s35 offen lds
  s_lshl_b32 s74, s28, 6
  s_add_u32 s73, s73, s74
  s_lshl_b32 s44, s2, 7
  s_add_u32 s44, s44, s63
  v_mfma_f32_32x32x16_bf16 v[32:47], v[228:231], v[100:103], v[32:47]
  ds_read_b64_tr_b16 v[220:221], v241 offset:28672
  ds_read_b64_tr_b16 v[222:223], v241 offset:29184
  s_cmp_lt_u32 s2, 192
  s_cselect_b32 s73, s73, 0x10000000
  s_mov_b32 s74, 0
  s_cmp_lt_u32 s2, 64
  s_cselect_b32 s44, s44, 0x10000000
  s_cselect_b32 s74, s74, 32
  s_waitcnt lgkmcnt(8)
  v_mfma_f32_32x32x16_bf16 v[48:63], v[232:235], v[100:103], v[48:63]
  ds_read_b64_tr_b16 v[224:225], v240 offset:22528
  ds_read_b64_tr_b16 v[226:227], v240 offset:23040
  s_cmp_eq_u32 s29, 0
  s_cselect_b32 s73, s73, 0x10000000
  s_mov_b32 exec_lo, 0x10001
  s_mov_b32 exec_hi, 0x10001
  buffer_store_dwordx4 v[248:251], v13, s[64:67], s73 offen sc1
  s_mov_b64 exec, 0xfff
  buffer_store_dword v252, v15, s[76:79], s44 offen sc1
  s_mov_b64 exec, -1
  s_lshl_b32 s74, s74, 7
  v_mfma_f32_32x32x16_bf16 v[64:79], v[236:239], v[100:103], v[64:79]
  ds_read_b64_tr_b16 v[228:229], v241 offset:22528
  ds_read_b64_tr_b16 v[230:231], v241 offset:23040
  s_add_u32 m0, s6, 7168
  s_add_u32 s35, s37, 24960
  buffer_load_dwordx4 v4, s[20:23], s35 offen lds
  s_add_u32 s74, s74, s63
  v_mov_b32 v13, 0
  v_mov_b32 v14, 1
  s_waitcnt lgkmcnt(8)
  v_mfma_f32_32x32x16_bf16 v[16:31], v[208:211], v[104:107], v[16:31]
  ds_read_b64_tr_b16 v[232:233], v240 offset:30720
  ds_read_b64_tr_b16 v[234:235], v240 offset:31232
  v_mfma_f32_32x32x16_bf16 v[32:47], v[212:215], v[104:107], v[32:47]
  ds_read_b64_tr_b16 v[236:237], v241 offset:30720
  ds_read_b64_tr_b16 v[238:239], v241 offset:31232
  s_add_u32 m0, s48, 122880
  s_add_u32 s35, s49, 1572992
  buffer_load_dwordx4 v2, s[52:55], s35 offen lds
  s_waitcnt lgkmcnt(8)
  v_mfma_f32_32x32x16_bf16 v[48:63], v[216:219], v[104:107], v[48:63]
  s_waitcnt vmcnt(15)
  s_barrier
  ds_read_b64_tr_b16 v[208:209], v240 offset:32768
  ds_read_b64_tr_b16 v[210:211], v240 offset:33280
  v_mfma_f32_32x32x16_bf16 v[64:79], v[220:223], v[104:107], v[64:79]
  ds_read_b64_tr_b16 v[212:213], v241 offset:32768
  ds_read_b64_tr_b16 v[214:215], v241 offset:33280
  s_add_u32 m0, s48, 131072
  s_add_u32 s35, s49, 2097152
  buffer_load_dwordx4 v2, s[52:55], s35 offen lds
  s_waitcnt vmcnt(10)
  ds_read_b128 v[112:115], v5 offset:0
  ds_read_b128 v[116:119], v6 offset:0
  ds_read_b128 v[120:123], v7 offset:0
  ds_read_b128 v[124:127], v8 offset:0
  s_waitcnt lgkmcnt(12)
  v_mfma_f32_32x32x16_bf16 v[16:31], v[224:227], v[108:111], v[16:31]
  ds_read_b64_tr_b16 v[216:217], v240 offset:40960
  ds_read_b64_tr_b16 v[218:219], v240 offset:41472
  s_add_u32 m0, s48, 139264
  s_add_u32 s35, s49, 2097280
  buffer_load_dwordx4 v2, s[52:55], s35 offen lds
  v_mfma_f32_32x32x16_bf16 v[32:47], v[228:231], v[108:111], v[32:47]
  ds_read_b64_tr_b16 v[220:221], v241 offset:40960
  ds_read_b64_tr_b16 v[222:223], v241 offset:41472
  s_waitcnt lgkmcnt(12)
  v_mfma_f32_32x32x16_bf16 v[48:63], v[232:235], v[108:111], v[48:63]
  ds_read_b64_tr_b16 v[224:225], v240 offset:34816
  ds_read_b64_tr_b16 v[226:227], v240 offset:35328
  s_waitcnt lgkmcnt(6)
  s_add_u32 m0, s6, 0
  s_add_u32 s35, s37, 512
  buffer_load_dwordx4 v3, s[20:23], s35 offen lds
  v_mfma_f32_32x32x16_bf16 v[64:79], v[236:239], v[108:111], v[64:79]
  ds_read_b64_tr_b16 v[228:229], v241 offset:34816
  ds_read_b64_tr_b16 v[230:231], v241 offset:35328
  s_waitcnt lgkmcnt(12)
  v_mfma_f32_32x32x16_bf16 v[16:31], v[208:211], v[112:115], v[16:31]
  ds_read_b64_tr_b16 v[232:233], v240 offset:43008
  ds_read_b64_tr_b16 v[234:235], v240 offset:43520
  v_mfma_f32_32x32x16_bf16 v[32:47], v[212:215], v[112:115], v[32:47]
  ds_read_b64_tr_b16 v[236:237], v241 offset:43008
  ds_read_b64_tr_b16 v[238:239], v241 offset:43520
  s_add_u32 m0, s6, 1024
  s_add_u32 s35, s37, 8704
  buffer_load_dwordx4 v4, s[20:23], s35 offen lds
  s_waitcnt lgkmcnt(8)
  v_mfma_f32_32x32x16_bf16 v[48:63], v[216:219], v[112:115], v[48:63]
  ds_read_b64_tr_b16 v[208:209], v240 offset:36864
  ds_read_b64_tr_b16 v[210:211], v240 offset:37376
  v_mfma_f32_32x32x16_bf16 v[64:79], v[220:223], v[112:115], v[64:79]
  ds_read_b64_tr_b16 v[212:213], v241 offset:36864
  ds_read_b64_tr_b16 v[214:215], v241 offset:37376
  s_waitcnt lgkmcnt(8)
  v_mfma_f32_32x32x16_bf16 v[16:31], v[224:227], v[116:119], v[16:31]
  ds_read_b64_tr_b16 v[216:217], v240 offset:45056
  ds_read_b64_tr_b16 v[218:219], v240 offset:45568
  s_add_u32 m0, s6, 2048
  s_add_u32 s35, s37, 16896
  buffer_load_dwordx4 v3, s[20:23], s35 offen lds
  v_mfma_f32_32x32x16_bf16 v[32:47], v[228:231], v[116:119], v[32:47]
  ds_read_b64_tr_b16 v[220:221], v241 offset:45056
  ds_read_b64_tr_b16 v[222:223], v241 offset:45568
  s_waitcnt lgkmcnt(8)
  v_mfma_f32_32x32x16_bf16 v[48:63], v[232:235], v[116:119], v[48:63]
  ds_read_b64_tr_b16 v[224:225], v240 offset:38912
  ds_read_b64_tr_b16 v[226:227], v240 offset:39424
  v_mfma_f32_32x32x16_bf16 v[64:79], v[236:239], v[116:119], v[64:79]
  ds_read_b64_tr_b16 v[228:229], v241 offset:38912
  ds_read_b64_tr_b16 v[230:231], v241 offset:39424
  s_add_u32 m0, s6, 3072
  s_add_u32 s35, s37, 25088
  buffer_load_dwordx4 v4, s[20:23], s35 offen lds
  s_waitcnt lgkmcnt(8)
  v_mfma_f32_32x32x16_bf16 v[16:31], v[208:211], v[120:123], v[16:31]
  ds_read_b64_tr_b16 v[232:233], v240 offset:47104
  ds_read_b64_tr_b16 v[234:235], v240 offset:47616
  v_mfma_f32_32x32x16_bf16 v[32:47], v[212:215], v[120:123], v[32:47]
  ds_read_b64_tr_b16 v[236:237], v241 offset:47104
  ds_read_b64_tr_b16 v[238:239], v241 offset:47616
  s_add_u32 m0, s48, 65536
  s_add_u32 s35, s49, 2621440
  buffer_load_dwordx4 v2, s[52:55], s35 offen lds
  s_waitcnt lgkmcnt(8)
  v_mfma_f32_32x32x16_bf16 v[48:63], v[216:219], v[120:123], v[48:63]
  s_waitcnt vmcnt(7)
  s_waitcnt vmcnt(9)
  s_barrier
  ds_read_b64_tr_b16 v[208:209], v240 offset:49152
  ds_read_b64_tr_b16 v[210:211], v240 offset:49664
  s_mov_b64 exec, 1
  buffer_atomic_add v14, v13, s[68:71], s74 offen sc0 sc1
  s_mov_b64 exec, -1
  v_mfma_f32_32x32x16_bf16 v[64:79], v[220:223], v[120:123], v[64:79]
  ds_read_b64_tr_b16 v[212:213], v241 offset:49152
  ds_read_b64_tr_b16 v[214:215], v241 offset:49664
  s_add_u32 m0, s48, 73728
  s_add_u32 s35, s49, 2621568
  buffer_load_dwordx4 v2, s[52:55], s35 offen lds
  s_waitcnt vmcnt(10)
  ds_read_b128 v[128:131], v5 offset:4096
  ds_read_b128 v[132:135], v6 offset:4096
  ds_read_b128 v[136:139], v7 offset:4096
  ds_read_b128 v[140:143], v8 offset:4096
  s_waitcnt lgkmcnt(12)
  v_mfma_f32_32x32x16_bf16 v[16:31], v[224:227], v[124:127], v[16:31]
  ds_read_b64_tr_b16 v[216:217], v240 offset:57344
  ds_read_b64_tr_b16 v[218:219], v240 offset:57856
  s_waitcnt vmcnt(15)
  v_lshlrev_b32 v192, 16, v204
  v_and_b32 v193, 0xffff0000, v204
  v_lshlrev_b32 v194, 16, v205
  v_mfma_f32_32x32x16_bf16 v[32:47], v[228:231], v[124:127], v[32:47]
  ds_read_b64_tr_b16 v[220:221], v241 offset:57344
  ds_read_b64_tr_b16 v[222:223], v241 offset:57856
  v_and_b32 v195, 0xffff0000, v205
  v_lshlrev_b32 v196, 16, v206
  v_and_b32 v197, 0xffff0000, v206
  s_waitcnt lgkmcnt(12)
  v_mfma_f32_32x32x16_bf16 v[48:63], v[232:235], v[124:127], v[48:63]
  ds_read_b64_tr_b16 v[224:225], v240 offset:51200
  ds_read_b64_tr_b16 v[226:227], v240 offset:51712
  s_waitcnt lgkmcnt(6)
  s_add_u32 m0, s6, 4096
  s_add_u32 s35, s37, 640
  buffer_load_dwordx4 v3, s[20:23], s35 offen lds
  v_lshlrev_b32 v198, 16, v207
  v_and_b32 v199, 0xffff0000, v207
  v_add_f32 v200, v192, v193
  v_add_f32 v200, v200, v194
  v_mfma_f32_32x32x16_bf16 v[64:79], v[236:239], v[124:127], v[64:79]
  ds_read_b64_tr_b16 v[228:229], v241 offset:51200
  ds_read_b64_tr_b16 v[230:231], v241 offset:51712
  v_add_f32 v200, v200, v195
  v_add_f32 v200, v200, v196
  v_add_f32 v200, v200, v197
  s_waitcnt lgkmcnt(12)
  v_mfma_f32_32x32x16_bf16 v[16:31], v[208:211], v[128:131], v[16:31]
  ds_read_b64_tr_b16 v[232:233], v240 offset:59392
  ds_read_b64_tr_b16 v[234:235], v240 offset:59904
  v_add_f32 v200, v200, v198
  v_add_f32 v200, v200, v199
  s_nop 1
  v_mfma_f32_32x32x16_bf16 v[32:47], v[212:215], v[128:131], v[32:47]
  ds_read_b64_tr_b16 v[236:237], v241 offset:59392
  ds_read_b64_tr_b16 v[238:239], v241 offset:59904
  s_add_u32 m0, s6, 5120
  s_add_u32 s35, s37, 8832
  buffer_load_dwordx4 v4, s[20:23], s35 offen lds
  v_add_f32_dpp v200, v200, v200 quad_perm:[1,0,3,2] row_mask:0xf bank_mask:0xf
  s_nop 1
  v_add_f32_dpp v200, v200, v200 quad_perm:[2,3,0,1] row_mask:0xf bank_mask:0xf
  s_nop 1
  s_waitcnt lgkmcnt(8)
  v_mfma_f32_32x32x16_bf16 v[48:63], v[216:219], v[128:131], v[48:63]
  ds_read_b64_tr_b16 v[208:209], v240 offset:53248
  ds_read_b64_tr_b16 v[210:211], v240 offset:53760
  v_add_f32_dpp v200, v200, v200 row_half_mirror row_mask:0xf bank_mask:0xf
  s_nop 1
  v_add_f32_dpp v200, v200, v200 row_mirror row_mask:0xf bank_mask:0xf
  v_mfma_f32_32x32x16_bf16 v[64:79], v[220:223], v[128:131], v[64:79]
  ds_read_b64_tr_b16 v[212:213], v241 offset:53248
  ds_read_b64_tr_b16 v[214:215], v241 offset:53760
  v_mov_b32 v201, v200
  s_nop 1
  v_permlane16_swap_b32 v201, v200
  s_nop 0
  s_waitcnt lgkmcnt(8)
  v_mfma_f32_32x32x16_bf16 v[16:31], v[224:227], v[132:135], v[16:31]
  ds_read_b64_tr_b16 v[216:217], v240 offset:61440
  ds_read_b64_tr_b16 v[218:219], v240 offset:61952
  s_add_u32 m0, s6, 6144
  s_add_u32 s35, s37, 17024
  buffer_load_dwordx4 v3, s[20:23], s35 offen lds
  v_add_f32 v200, v200, v201
  v_mov_b32 v201, v200
  s_nop 1
  v_mfma_f32_32x32x16_bf16 v[32:47], v[228:231], v[132:135], v[32:47]
  ds_read_b64_tr_b16 v[220:221], v241 offset:61440
  ds_read_b64_tr_b16 v[222:223], v241 offset:61952
  v_permlane32_swap_b32 v201, v200
  s_nop 0
  v_add_f32 v200, v200, v201
  s_waitcnt lgkmcnt(8)
  v_mfma_f32_32x32x16_bf16 v[48:63], v[232:235], v[132:135], v[48:63]
  ds_read_b64_tr_b16 v[224:225], v240 offset:55296
  ds_read_b64_tr_b16 v[226:227], v240 offset:55808
  v_mul_f32 v200, 0x3b000000, v200
  v_sub_f32 v192, v192, v200
  v_sub_f32 v193, v193, v200
  v_sub_f32 v194, v194, v200
  v_mfma_f32_32x32x16_bf16 v[64:79], v[236:239], v[132:135], v[64:79]
  ds_read_b64_tr_b16 v[228:229], v241 offset:55296
  ds_read_b64_tr_b16 v[230:231], v241 offset:55808
  s_add_u32 m0, s6, 7168
  s_add_u32 s35, s37, 25216
  buffer_load_dwordx4 v4, s[20:23], s35 offen lds
  v_sub_f32 v195, v195, v200
  v_sub_f32 v196, v196, v200
  v_sub_f32 v197, v197, v200
  s_waitcnt lgkmcnt(8)
  v_mfma_f32_32x32x16_bf16 v[16:31], v[208:211], v[136:139], v[16:31]
  ds_read_b64_tr_b16 v[232:233], v240 offset:63488
  ds_read_b64_tr_b16 v[234:235], v240 offset:64000
  s_cmp_ge_u32 s74, 4096
  s_cbranch_scc1 u_na_AM
  s_waitcnt vmcnt(5)
  v_readfirstlane_b32 s33, v14
  s_nop 0
  s_cmp_lg_u32 s33, 63
  s_cbranch_scc1 u_na_AM
  s_mov_b64 exec, 1
  buffer_store_dword v14, v13, s[68:71], s74 offen offset:128 sc1
  s_mov_b64 exec, -1
u_na_AM:
  v_sub_f32 v198, v198, v200
  v_sub_f32 v199, v199, v200
  v_mul_f32 v200, v192, v192
  s_add_u32 m0, s48, 155648
  s_and_b32 s35, s2, 0xf8
  s_lshl_b32 s35, s35, 14
  s_add_u32 s35, s35, s6
  s_and_b32 s36, s2, 7
  s_lshl_b32 s36, s36, 10
  s_add_u32 s35, s35, s36
  s_add_u32 s35, s35, 0
  buffer_load_dwordx4 v1, s[56:59], s35 offen lds
  v_mfma_f32_32x32x16_bf16 v[32:47], v[212:215], v[136:139], v[32:47]
  ds_read_b64_tr_b16 v[236:237], v241 offset:63488
  ds_read_b64_tr_b16 v[238:239], v241 offset:64000
  s_add_u32 m0, s48, 81920
  s_add_u32 s35, s49, 3145728
  buffer_load_dwordx4 v2, s[52:55], s35 offen lds
  v_fmac_f32 v200, v193, v193
  v_fmac_f32 v200, v194, v194
  v_fmac_f32 v200, v195, v195
  v_fmac_f32 v200, v196, v196
  s_waitcnt lgkmcnt(8)
  v_mfma_f32_32x32x16_bf16 v[48:63], v[216:219], v[136:139], v[48:63]
  s_waitcnt vmcnt(13)
  s_barrier
  ds_read_b64_tr_b16 v[208:209], v242 offset:0
  ds_read_b64_tr_b16 v[210:211], v242 offset:512
  v_fmac_f32 v200, v197, v197
  v_fmac_f32 v200, v198, v198
  v_fmac_f32 v200, v199, v199
  v_mfma_f32_32x32x16_bf16 v[64:79], v[220:223], v[136:139], v[64:79]
  ds_read_b64_tr_b16 v[212:213], v243 offset:0
  ds_read_b64_tr_b16 v[214:215], v243 offset:512
  s_add_u32 m0, s48, 90112
  s_add_u32 s35, s49, 3145856
  buffer_load_dwordx4 v2, s[52:55], s35 offen lds
  s_waitcnt vmcnt(10)
  ds_read_b128 v[144:147], v5 offset:0
  ds_read_b128 v[148:151], v6 offset:0
  ds_read_b128 v[152:155], v7 offset:0
  ds_read_b128 v[156:159], v8 offset:0
  s_nop 1
  v_add_f32_dpp v200, v200, v200 quad_perm:[1,0,3,2] row_mask:0xf bank_mask:0xf
  s_nop 1
  v_add_f32_dpp v200, v200, v200 quad_perm:[2,3,0,1] row_mask:0xf bank_mask:0xf
  s_waitcnt lgkmcnt(12)
  v_mfma_f32_32x32x16_bf16 v[16:31], v[224:227], v[140:143], v[16:31]
  ds_read_b64_tr_b16 v[216:217], v242 offset:8192
  ds_read_b64_tr_b16 v[218:219], v242 offset:8704
  s_nop 1
  v_add_f32_dpp v200, v200, v200 row_half_mirror row_mask:0xf bank_mask:0xf
  s_nop 1
  v_mfma_f32_32x32x16_bf16 v[32:47], v[228:231], v[140:143], v[32:47]
  ds_read_b64_tr_b16 v[220:221], v243 offset:8192
  ds_read_b64_tr_b16 v[222:223], v243 offset:8704
  v_add_f32_dpp v200, v200, v200 row_mirror row_mask:0xf bank_mask:0xf
  v_mov_b32 v201, v200
  s_nop 1
  s_waitcnt lgkmcnt(12)
  v_mfma_f32_32x32x16_bf16 v[48:63], v[232:235], v[140:143], v[48:63]
  ds_read_b64_tr_b16 v[224:225], v242 offset:2048
  ds_read_b64_tr_b16 v[226:227], v242 offset:2560
  s_waitcnt lgkmcnt(6)
  s_add_u32 m0, s6, 0
  s_add_u32 s35, s37, 768
  buffer_load_dwordx4 v3, s[20:23], s35 offen lds
  v_permlane16_swap_b32 v201, v200
  s_nop 0
  v_add_f32 v200, v200, v201
  v_mov_b32 v201, v200
  v_mfma_f32_32x32x16_bf16 v[64:79], v[236:239], v[140:143], v[64:79]
  ds_read_b64_tr_b16 v[228:229], v243 offset:2048
  ds_read_b64_tr_b16 v[230:231], v243 offset:2560
  s_nop 1
  v_permlane32_swap_b32 v201, v200
  s_nop 0
  s_waitcnt lgkmcnt(12)
  v_mfma_f32_32x32x16_bf16 v[16:31], v[208:211], v[144:147], v[16:31]
  ds_read_b64_tr_b16 v[232:233], v242 offset:10240
  ds_read_b64_tr_b16 v[234:235], v242 offset:10752
  v_add_f32 v200, v200, v201
  v_mov_b32 v201, 0x3727c5ac
  v_fmac_f32 v201, 0x3b000000, v200
  v_mfma_f32_32x32x16_bf16 v[32:47], v[212:215], v[144:147], v[32:47]
  ds_read_b64_tr_b16 v[236:237], v243 offset:10240
  ds_read_b64_tr_b16 v[238:239], v243 offset:10752
  s_add_u32 m0, s6, 1024
  s_add_u32 s35, s37, 8960
  buffer_load_dwordx4 v4, s[20:23], s35 offen lds
  v_rsq_f32 v200, v201
  s_nop 0
  v_mul_f32 v192, v192, v200
  v_mul_f32 v193, v193, v200
  s_waitcnt lgkmcnt(8)
  v_mfma_f32_32x32x16_bf16 v[48:63], v[216:219], v[144:147], v[48:63]
  ds_read_b64_tr_b16 v[208:209], v242 offset:4096
  ds_read_b64_tr_b16 v[210:211], v242 offset:4608
  v_mul_f32 v194, v194, v200
  v_mul_f32 v195, v195, v200
  v_mul_f32 v196, v196, v200
  v_mfma_f32_32x32x16_bf16 v[64:79], v[220:223], v[144:147], v[64:79]
  ds_read_b64_tr_b16 v[212:213], v243 offset:4096
  ds_read_b64_tr_b16 v[214:215], v243 offset:4608
  v_mul_f32 v197, v197, v200
  v_mul_f32 v198, v198, v200
  v_mul_f32 v199, v199, v200
  v_cvt_pk_bf16_f32 v252, v192, v193
  s_waitcnt lgkmcnt(8)
  v_mfma_f32_32x32x16_bf16 v[16:31], v[224:227], v[148:151], v[16:31]
  ds_read_b64_tr_b16 v[216:217], v242 offset:12288
  ds_read_b64_tr_b16 v[218:219], v242 offset:12800
  s_add_u32 m0, s6, 2048
  s_add_u32 s35, s37, 17152
  buffer_load_dwordx4 v3, s[20:23], s35 offen lds
  v_cvt_pk_bf16_f32 v253, v194, v195
  v_cvt_pk_bf16_f32 v254, v196, v197
  v_cvt_pk_bf16_f32 v255, v198, v199
  v_mfma_f32_32x32x16_bf16 v[32:47], v[228:231], v[148:151], v[32:47]
  ds_read_b64_tr_b16 v[220:221], v243 offset:12288
  ds_read_b64_tr_b16 v[222:223], v243 offset:12800
  v_bfe_u32 v200, v0, 1, 3
  v_xor_b32 v200, s28, v200
  v_lshlrev_b32 v201, 7, v0
  s_waitcnt lgkmcnt(8)
  v_mfma_f32_32x32x16_bf16 v[48:63], v[232:235], v[148:151], v[48:63]
  ds_read_b64_tr_b16 v[224:225], v242 offset:6144
  ds_read_b64_tr_b16 v[226:227], v242 offset:6656
  v_lshl_add_u32 v201, v200, 4, v201
  v_add_u32 v201, 147456, v201
  ds_write_b128 v201, v[252:255]
  s_and_b32 s73, s28, 1
  v_mfma_f32_32x32x16_bf16 v[64:79], v[236:239], v[148:151], v[64:79]
  ds_read_b64_tr_b16 v[228:229], v243 offset:6144
  ds_read_b64_tr_b16 v[230:231], v243 offset:6656
  s_add_u32 m0, s6, 3072
  s_add_u32 s35, s37, 25344
  buffer_load_dwordx4 v4, s[20:23], s35 offen lds
  s_lshl_b32 s73, s73, 6
  v_and_b32 v200, 0x30, v0
  v_or_b32 v200, s73, v200
  s_waitcnt lgkmcnt(9)
  v_mfma_f32_32x32x16_bf16 v[16:31], v[208:211], v[152:155], v[16:31]
  ds_read_b64_tr_b16 v[232:233], v242 offset:14336
  ds_read_b64_tr_b16 v[234:235], v242 offset:14848
  v_xor_b32 v201, v1, v200
  s_add_u32 s73, s48, 147456
  v_add_u32 v201, s73, v201
  buffer_load_dword v14, v13, s[68:71], s63 offen offset:128 sc1
  s_add_u32 m0, s48, 155648
  s_and_b32 s35, s2, 0xf8
  s_lshl_b32 s35, s35, 14
  s_add_u32 s35, s35, s6
  s_and_b32 s36, s2, 7
  s_lshl_b32 s36, s36, 10
  s_add_u32 s35, s35, s36
  s_add_u32 s35, s35, 65536
  buffer_load_dwordx4 v1, s[56:59], s35 offen lds
  v_mfma_f32_32x32x16_bf16 v[32:47], v[212:215], v[152:155], v[32:47]
  ds_read_b64_tr_b16 v[236:237], v243 offset:14336
  ds_read_b64_tr_b16 v[238:239], v243 offset:14848
  s_add_u32 m0, s48, 98304
  s_add_u32 s35, s49, 3670016
  buffer_load_dwordx4 v2, s[52:55], s35 offen lds
  s_waitcnt lgkmcnt(9)
  v_mfma_f32_32x32x16_bf16 v[48:63], v[216:219], v[152:155], v[48:63]
  s_waitcnt vmcnt(14)
  s_waitcnt lgkmcnt(6)
  s_barrier
  ds_read_b64_tr_b16 v[208:209], v240 offset:0
  ds_read_b64_tr_b16 v[210:211], v240 offset:512
  v_mfma_f32_32x32x16_bf16 v[64:79], v[220:223], v[152:155], v[64:79]
  ds_read_b64_tr_b16 v[212:213], v241 offset:0
  ds_read_b64_tr_b16 v[214:215], v241 offset:512
  s_add_u32 m0, s48, 106496
  s_add_u32 s35, s49, 3670144
  buffer_load_dwordx4 v2, s[52:55], s35 offen lds
  s_waitcnt vmcnt(11)
  ds_read_b128 v[160:163], v5 offset:4096
  ds_read_b128 v[164:167], v6 offset:4096
  ds_read_b128 v[168:171], v7 offset:4096
  ds_read_b128 v[172:175], v8 offset:4096
  ds_read_b128 v[252:255], v201
  s_waitcnt lgkmcnt(13)
  v_mfma_f32_32x32x16_bf16 v[16:31], v[224:227], v[156:159], v[16:31]
  ds_read_b64_tr_b16 v[216:217], v240 offset:8192
  ds_read_b64_tr_b16 v[218:219], v240 offset:8704
  v_mfma_f32_32x32x16_bf16 v[32:47], v[228:231], v[156:159], v[32:47]
  ds_read_b64_tr_b16 v[220:221], v241 offset:8192
  ds_read_b64_tr_b16 v[222:223], v241 offset:8704
  s_waitcnt lgkmcnt(13)
  v_mfma_f32_32x32x16_bf16 v[48:63], v[232:235], v[156:159], v[48:63]
  ds_read_b64_tr_b16 v[224:225], v240 offset:2048
  ds_read_b64_tr_b16 v[226:227], v240 offset:2560
  s_waitcnt lgkmcnt(7)
  s_add_u32 m0, s6, 4096
  s_add_u32 s35, s37, 896
  buffer_load_dwordx4 v3, s[20:23], s35 offen lds
  v_mfma_f32_32x32x16_bf16 v[64:79], v[236:239], v[156:159], v[64:79]
  ds_read_b64_tr_b16 v[228:229], v241 offset:2048
  ds_read_b64_tr_b16 v[230:231], v241 offset:2560
  s_waitcnt lgkmcnt(13)
  v_mfma_f32_32x32x16_bf16 v[16:31], v[208:211], v[160:163], v[16:31]
  ds_read_b64_tr_b16 v[232:233], v240 offset:10240
  ds_read_b64_tr_b16 v[234:235], v240 offset:10752
  v_and_b32 v15, 3, v0
  v_mfma_f32_32x32x16_bf16 v[32:47], v[212:215], v[160:163], v[32:47]
  ds_read_b64_tr_b16 v[236:237], v241 offset:10240
  ds_read_b64_tr_b16 v[238:239], v241 offset:10752
  s_add_u32 m0, s6, 5120
  s_add_u32 s35, s37, 9088
  buffer_load_dwordx4 v4, s[20:23], s35 offen lds
  v_mul_u32_u24 v15, 12288, v15
  s_waitcnt lgkmcnt(8)
  v_mfma_f32_32x32x16_bf16 v[48:63], v[216:219], v[160:163], v[48:63]
  ds_read_b64_tr_b16 v[208:209], v240 offset:4096
  ds_read_b64_tr_b16 v[210:211], v240 offset:4608
  v_and_b32 v10, 4, v0
  v_mfma_f32_32x32x16_bf16 v[64:79], v[220:223], v[160:163], v[64:79]
  ds_read_b64_tr_b16 v[212:213], v241 offset:4096
  ds_read_b64_tr_b16 v[214:215], v241 offset:4608
  v_lshl_add_u32 v15, v10, 9, v15
  s_waitcnt lgkmcnt(8)
  v_mfma_f32_32x32x16_bf16 v[16:31], v[224:227], v[164:167], v[16:31]
  ds_read_b64_tr_b16 v[216:217], v240 offset:12288
  ds_read_b64_tr_b16 v[218:219], v240 offset:12800
  s_add_u32 m0, s6, 6144
  s_add_u32 s35, s37, 17280
  buffer_load_dwordx4 v3, s[20:23], s35 offen lds
  v_lshrrev_b32 v10, 3, v0
  v_mfma_f32_32x32x16_bf16 v[32:47], v[228:231], v[164:167], v[32:47]
  ds_read_b64_tr_b16 v[220:221], v241 offset:12288
  ds_read_b64_tr_b16 v[222:223], v241 offset:12800
  v_lshl_add_u32 v15, v10, 5, v15
  s_waitcnt lgkmcnt(8)
  v_mfma_f32_32x32x16_bf16 v[48:63], v[232:235], v[164:167], v[48:63]
  ds_read_b64_tr_b16 v[224:225], v240 offset:6144
  ds_read_b64_tr_b16 v[226:227], v240 offset:6656
  s_lshl_b32 s74, s28, 8
  v_mfma_f32_32x32x16_bf16 v[64:79], v[236:239], v[164:167], v[64:79]
  ds_read_b64_tr_b16 v[228:229], v241 offset:6144
  ds_read_b64_tr_b16 v[230:231], v241 offset:6656
  s_add_u32 m0, s6, 7168
  s_add_u32 s35, s37, 25472
  buffer_load_dwordx4 v4, s[20:23], s35 offen lds
  s_waitcnt lgkmcnt(8)
  v_mfma_f32_32x32x16_bf16 v[16:31], v[208:211], v[168:171], v[16:31]
  ds_read_b64_tr_b16 v[232:233], v240 offset:14336
  ds_read_b64_tr_b16 v[234:235], v240 offset:14848
  v_mfma_f32_32x32x16_bf16 v[32:47], v[212:215], v[168:171], v[32:47]
  ds_read_b64_tr_b16 v[236:237], v241 offset:14336
  ds_read_b64_tr_b16 v[238:239], v241 offset:14848
  s_add_u32 m0, s48, 114688
  s_add_u32 s35, s49, 0
  buffer_load_dwordx4 v2, s[56:59], s35 offen lds
  s_waitcnt lgkmcnt(8)
  v_mfma_f32_32x32x16_bf16 v[48:63], v[216:219], v[168:171], v[48:63]
  s_waitcnt vmcnt(13)
  s_cmp_lg_u32 s28, 0
  s_cbranch_scc1 u_go_PM
  s_waitcnt vmcnt(8)
  v_readfirstlane_b32 s73, v14
  s_add_u32 s73, s73, s63
  s_cmp_lt_u32 s73, 1
  s_cbranch_scc1 u_spin_PM
u_go_PM:
  s_barrier
  ds_read_b64_tr_b16 v[208:209], v240 offset:16384
  ds_read_b64_tr_b16 v[210:211], v240 offset:16896
  buffer_load_dwordx4 v[244:247], v15, s[64:67], s74 offen sc1
  buffer_load_dwordx4 v[248:251], v15, s[64:67], s74 offen offset:16 sc1
  v_mfma_f32_32x32x16_bf16 v[64:79], v[220:223], v[168:171], v[64:79]
  ds_read_b64_tr_b16 v[212:213], v241 offset:16384
  ds_read_b64_tr_b16 v[214:215], v241 offset:16896
  s_add_u32 m0, s48, 122880
  s_add_u32 s35, s49, 524288
  buffer_load_dwordx4 v2, s[56:59], s35 offen lds
  s_waitcnt vmcnt(12)
  ds_read_b128 v[176:179], v5 offset:0
  ds_read_b128 v[180:183], v6 offset:0
  ds_read_b128 v[184:187], v7 offset:0
  ds_read_b128 v[188:191], v8 offset:0
  s_waitcnt lgkmcnt(12)
  v_mfma_f32_32x32x16_bf16 v[16:31], v[224:227], v[172:175], v[16:31]
  ds_read_b64_tr_b16 v[216:217], v240 offset:24576
  ds_read_b64_tr_b16 v[218:219], v240 offset:25088
  s_add_u32 m0, s48, 131072
  s_add_u32 s35, s49, 1048576
  buffer_load_dwordx4 v2, s[56:59], s35 offen lds
  v_mfma_f32_32x32x16_bf16 v[32:47], v[228:231], v[172:175], v[32:47]
  ds_read_b64_tr_b16 v[220:221], v241 offset:24576
  ds_read_b64_tr_b16 v[222:223], v241 offset:25088
  s_waitcnt lgkmcnt(12)
  v_mfma_f32_32x32x16_bf16 v[48:63], v[232:235], v[172:175], v[48:63]
  ds_read_b64_tr_b16 v[224:225], v240 offset:18432
  ds_read_b64_tr_b16 v[226:227], v240 offset:18944
  s_add_u32 m0, s48, 155648
  s_and_b32 s35, s2, 0xf8
  s_lshl_b32 s35, s35, 14
  s_add_u32 s35, s35, s6
  s_and_b32 s36, s2, 7
  s_lshl_b32 s36, s36, 10
  s_add_u32 s35, s35, s36
  s_add_u32 s35, s35, 0
  buffer_load_dwordx4 v1, s[8:11], s35 offen lds
  v_mfma_f32_32x32x16_bf16 v[64:79], v[236:239], v[172:175], v[64:79]
  ds_read_b64_tr_b16 v[228:229], v241 offset:18432
  ds_read_b64_tr_b16 v[230:231], v241 offset:18944
  s_waitcnt lgkmcnt(8)
  s_waitcnt lgkmcnt(12)
  v_mfma_f32_32x32x16_bf16 v[16:31], v[208:211], v[176:179], v[16:31]
  ds_read_b64_tr_b16 v[232:233], v240 offset:26624
  ds_read_b64_tr_b16 v[234:235], v240 offset:27136
  v_mfma_f32_32x32x16_bf16 v[32:47], v[212:215], v[176:179], v[32:47]
  ds_read_b64_tr_b16 v[236:237], v241 offset:26624
  ds_read_b64_tr_b16 v[238:239], v241 offset:27136
  s_waitcnt lgkmcnt(8)
  v_mfma_f32_32x32x16_bf16 v[48:63], v[216:219], v[176:179], v[48:63]
  ds_read_b64_tr_b16 v[208:209], v240 offset:20480
  ds_read_b64_tr_b16 v[210:211], v240 offset:20992
  v_mfma_f32_32x32x16_bf16 v[64:79], v[220:223], v[176:179], v[64:79]
  ds_read_b64_tr_b16 v[212:213], v241 offset:20480
  ds_read_b64_tr_b16 v[214:215], v241 offset:20992
  s_waitcnt lgkmcnt(8)
  v_mfma_f32_32x32x16_bf16 v[16:31], v[224:227], v[180:183], v[16:31]
  ds_read_b64_tr_b16 v[216:217], v240 offset:28672
  ds_read_b64_tr_b16 v[218:219], v240 offset:29184
  s_add_u32 m0, s48, 139264
  s_add_u32 s35, s49, 1572864
  buffer_load_dwordx4 v2, s[56:59], s35 offen lds
  v_mfma_f32_32x32x16_bf16 v[32:47], v[228:231], v[180:183], v[32:47]
  ds_read_b64_tr_b16 v[220:221], v241 offset:28672
  ds_read_b64_tr_b16 v[222:223], v241 offset:29184
  s_waitcnt lgkmcnt(8)
  v_mfma_f32_32x32x16_bf16 v[48:63], v[232:235], v[180:183], v[48:63]
  ds_read_b64_tr_b16 v[224:225], v240 offset:22528
  ds_read_b64_tr_b16 v[226:227], v240 offset:23040
  v_mfma_f32_32x32x16_bf16 v[64:79], v[236:239], v[180:183], v[64:79]
  ds_read_b64_tr_b16 v[228:229], v241 offset:22528
  ds_read_b64_tr_b16 v[230:231], v241 offset:23040
  s_waitcnt lgkmcnt(8)
  v_mfma_f32_32x32x16_bf16 v[16:31], v[208:211], v[184:187], v[16:31]
  ds_read_b64_tr_b16 v[232:233], v240 offset:30720
  ds_read_b64_tr_b16 v[234:235], v240 offset:31232
  s_add_u32 m0, s48, 155648
  s_and_b32 s35, s2, 0xf8
  s_lshl_b32 s35, s35, 14
  s_add_u32 s35, s35, s6
  s_and_b32 s36, s2, 7
  s_lshl_b32 s36, s36, 10
  s_add_u32 s35, s35, s36
  s_add_u32 s35, s35, 65536
  buffer_load_dwordx4 v1, s[8:11], s35 offen lds
  v_mfma_f32_32x32x16_bf16 v[32:47], v[212:215], v[184:187], v[32:47]
  ds_read_b64_tr_b16 v[236:237], v241 offset:30720
  ds_read_b64_tr_b16 v[238:239], v241 offset:31232
  s_waitcnt lgkmcnt(8)
  v_mfma_f32_32x32x16_bf16 v[48:63], v[216:219], v[184:187], v[48:63]
  s_waitcnt vmcnt(12)
  s_barrier
  ds_read_b64_tr_b16 v[208:209], v240 offset:40960
  ds_read_b64_tr_b16 v[210:211], v240 offset:41472
  v_mfma_f32_32x32x16_bf16 v[64:79], v[220:223], v[184:187], v[64:79]
  ds_read_b64_tr_b16 v[212:213], v240 offset:43008
  ds_read_b64_tr_b16 v[214:215], v240 offset:43520
  s_waitcnt vmcnt(8)
  ds_read_b128 v[192:195], v5 offset:4096
  ds_read_b128 v[196:199], v6 offset:4096
  ds_read_b128 v[200:203], v7 offset:4096
  ds_read_b128 v[204:207], v8 offset:4096
  s_waitcnt lgkmcnt(12)
  v_mfma_f32_32x32x16_bf16 v[16:31], v[224:227], v[188:191], v[16:31]
  ds_read_b64_tr_b16 v[216:217], v240 offset:45056
  ds_read_b64_tr_b16 v[218:219], v240 offset:45568
  s_add_u32 m0, s48, 65536
  s_add_u32 s35, s49, 2097152
  buffer_load_dwordx4 v2, s[56:59], s35 offen lds
  v_mfma_f32_32x32x16_bf16 v[32:47], v[228:231], v[188:191], v[32:47]
  ds_read_b64_tr_b16 v[220:221], v240 offset:47104
  ds_read_b64_tr_b16 v[222:223], v240 offset:47616
  s_waitcnt lgkmcnt(12)
  v_mfma_f32_32x32x16_bf16 v[48:63], v[232:235], v[188:191], v[48:63]
  ds_read_b64_tr_b16 v[224:225], v241 offset:40960
  ds_read_b64_tr_b16 v[226:227], v241 offset:41472
  v_mfma_f32_32x32x16_bf16 v[64:79], v[236:239], v[188:191], v[64:79]
  ds_read_b64_tr_b16 v[228:229], v241 offset:43008
  ds_read_b64_tr_b16 v[230:231], v241 offset:43520
  s_waitcnt lgkmcnt(8)
  s_waitcnt lgkmcnt(12)
  v_mfma_f32_32x32x16_bf16 v[48:63], v[208:211], v[192:195], v[48:63]
  ds_read_b64_tr_b16 v[232:233], v241 offset:45056
  ds_read_b64_tr_b16 v[234:235], v241 offset:45568
  v_mfma_f32_32x32x16_bf16 v[48:63], v[212:215], v[196:199], v[48:63]
  ds_read_b64_tr_b16 v[236:237], v241 offset:47104
  ds_read_b64_tr_b16 v[238:239], v241 offset:47616
  s_waitcnt lgkmcnt(8)
  v_mfma_f32_32x32x16_bf16 v[48:63], v[216:219], v[200:203], v[48:63]
  ds_read_b64_tr_b16 v[208:209], v240 offset:32768
  ds_read_b64_tr_b16 v[210:211], v240 offset:33280
  v_subrev_u32 v5, 0x10000, v240
  v_subrev_u32 v6, 0x10000, v241
  v_bfe_u32 v15, v0, 2, 1
  v_cvt_f32_u32 v15, v15
  s_mov_b32 s74, 0x3e0293ee
  s_waitcnt vmcnt(6) lgkmcnt(15)
  v_add_f32_dpp v244, v244, v244 quad_perm:[1,0,3,2] row_mask:0xf bank_mask:0xf
  v_mfma_f32_32x32x16_bf16 v[48:63], v[220:223], v[204:207], v[48:63]
  ds_read_b64_tr_b16 v[212:213], v240 offset:34816
  ds_read_b64_tr_b16 v[214:215], v240 offset:35328
  s_lshl_b32 s51, s60, 7
  s_add_u32 s51, s51, s49
  v_add_f32_dpp v245, v245, v245 quad_perm:[1,0,3,2] row_mask:0xf bank_mask:0xf
  v_add_f32_dpp v246, v246, v246 quad_perm:[1,0,3,2] row_mask:0xf bank_mask:0xf
  v_add_f32_dpp v247, v247, v247 quad_perm:[1,0,3,2] row_mask:0xf bank_mask:0xf
  v_add_f32_dpp v248, v248, v248 quad_perm:[1,0,3,2] row_mask:0xf bank_mask:0xf
  s_waitcnt lgkmcnt(8)
  v_mfma_f32_32x32x16_bf16 v[64:79], v[224:227], v[192:195], v[64:79]
  ds_read_b64_tr_b16 v[216:217], v240 offset:36864
  ds_read_b64_tr_b16 v[218:219], v240 offset:37376
  s_add_u32 m0, s48, 73728
  s_add_u32 s35, s49, 2621440
  buffer_load_dwordx4 v2, s[56:59], s35 offen lds
  v_add_f32_dpp v249, v249, v249 quad_perm:[1,0,3,2] row_mask:0xf bank_mask:0xf
  v_add_f32_dpp v250, v250, v250 quad_perm:[1,0,3,2] row_mask:0xf bank_mask:0xf
  v_add_f32_dpp v251, v251, v251 quad_perm:[1,0,3,2] row_mask:0xf bank_mask:0xf
  v_add_f32_dpp v244, v244, v244 quad_perm:[2,3,0,1] row_mask:0xf bank_mask:0xf
  v_mfma_f32_32x32x16_bf16 v[64:79], v[228:231], v[196:199], v[64:79]
  ds_read_b64_tr_b16 v[220:221], v240 offset:38912
  ds_read_b64_tr_b16 v[222:223], v240 offset:39424
  v_add_f32_dpp v245, v245, v245 quad_perm:[2,3,0,1] row_mask:0xf bank_mask:0xf
  v_add_f32_dpp v246, v246, v246 quad_perm:[2,3,0,1] row_mask:0xf bank_mask:0xf
  v_add_f32_dpp v247, v247, v247 quad_perm:[2,3,0,1] row_mask:0xf bank_mask:0xf
  v_add_f32_dpp v248, v248, v248 quad_perm:[2,3,0,1] row_mask:0xf bank_mask:0xf
  v_add_f32_dpp v249, v249, v249 quad_perm:[2,3,0,1] row_mask:0xf bank_mask:0xf
  s_waitcnt lgkmcnt(8)
  v_mfma_f32_32x32x16_bf16 v[64:79], v[232:235], v[200:203], v[64:79]
  ds_read_b64_tr_b16 v[224:225], v241 offset:32768
  ds_read_b64_tr_b16 v[226:227], v241 offset:33280
  v_cvt_pk_bf16_f32 v48, v48, v49
  v_cvt_pk_bf16_f32 v49, v50, v51
  v_cvt_pk_bf16_f32 v50, v52, v53
  v_cvt_pk_bf16_f32 v51, v54, v55
  v_add_f32_dpp v250, v250, v250 quad_perm:[2,3,0,1] row_mask:0xf bank_mask:0xf
  v_add_f32_dpp v251, v251, v251 quad_perm:[2,3,0,1] row_mask:0xf bank_mask:0xf
  v_cvt_pk_bf16_f32 v9, v244, v245
  v_cvt_pk_bf16_f32 v10, v246, v247
  v_mfma_f32_32x32x16_bf16 v[64:79], v[236:239], v[204:207], v[64:79]
  ds_read_b64_tr_b16 v[228:229], v241 offset:34816
  ds_read_b64_tr_b16 v[230:231], v241 offset:35328
  v_cvt_pk_bf16_f32 v52, v56, v57
  v_cvt_pk_bf16_f32 v53, v58, v59
  v_cvt_pk_bf16_f32 v54, v60, v61
  v_cvt_pk_bf16_f32 v55, v62, v63
  v_cvt_pk_bf16_f32 v11, v248, v249
  v_cvt_pk_bf16_f32 v12, v250, v251
  v_lshlrev_b32 v244, 16, v9
  v_and_b32 v245, 0xffff0000, v9
  s_waitcnt lgkmcnt(8)
  v_mfma_f32_32x32x16_bf16 v[16:31], v[208:211], v[192:195], v[16:31]
  ds_read_b64_tr_b16 v[232:233], v241 offset:36864
  ds_read_b64_tr_b16 v[234:235], v241 offset:37376
  v_lshlrev_b32 v246, 16, v10
  v_and_b32 v247, 0xffff0000, v10
  v_lshlrev_b32 v248, 16, v11
  v_and_b32 v249, 0xffff0000, v11
  v_lshlrev_b32 v250, 16, v12
  v_mfma_f32_32x32x16_bf16 v[16:31], v[212:215], v[196:199], v[16:31]
  ds_read_b64_tr_b16 v[236:237], v241 offset:38912
  ds_read_b64_tr_b16 v[238:239], v241 offset:39424
  v_and_b32 v251, 0xffff0000, v12
  v_add_f32 v244, v244, v15
  v_add_f32 v245, v245, v15
  v_add_f32 v246, v246, v15
  s_waitcnt lgkmcnt(8)
  v_mfma_f32_32x32x16_bf16 v[16:31], v[216:219], v[200:203], v[16:31]
  s_waitcnt vmcnt(6)
  s_barrier
  ds_read_b64_tr_b16 v[208:209], v240 offset:49152
  ds_read_b64_tr_b16 v[210:211], v240 offset:49664
  v_cvt_pk_bf16_f32 v64, v64, v65
  v_cvt_pk_bf16_f32 v65, v66, v67
  v_cvt_pk_bf16_f32 v66, v68, v69
  v_cvt_pk_bf16_f32 v67, v70, v71
  v_add_f32 v247, v247, v15
  v_add_f32 v248, v248, v15
  v_add_f32 v249, v249, v15
  v_add_f32 v250, v250, v15
  v_mfma_f32_32x32x16_bf16 v[16:31], v[220:223], v[204:207], v[16:31]
  ds_read_b64_tr_b16 v[212:213], v240 offset:51200
  ds_read_b64_tr_b16 v[214:215], v240 offset:51712
  s_add_u32 m0, s48, 0
  s_add_u32 s35, s49, 3145728
  buffer_load_dwordx4 v2, s[56:59], s35 offen lds
  v_cvt_pk_bf16_f32 v68, v72, v73
  v_cvt_pk_bf16_f32 v69, v74, v75
  v_cvt_pk_bf16_f32 v70, v76, v77
  v_cvt_pk_bf16_f32 v71, v78, v79
  v_add_f32 v251, v251, v15
  v_cvt_pk_bf16_f32 v244, v244, v245
  v_cvt_pk_bf16_f32 v245, v246, v247
  v_cvt_pk_bf16_f32 v246, v248, v249
  s_waitcnt lgkmcnt(8)
  v_mfma_f32_32x32x16_bf16 v[32:47], v[224:227], v[192:195], v[32:47]
  ds_read_b64_tr_b16 v[216:217], v240 offset:53248
  ds_read_b64_tr_b16 v[218:219], v240 offset:53760
  v_cvt_pk_bf16_f32 v247, v250, v251
  v_mov_b32 v248, v244
  v_mov_b32 v249, v245
  v_mov_b32 v250, v246
  v_mov_b32 v251, v247
  v_mfma_f32_32x32x16_bf16 v[32:47], v[228:231], v[196:199], v[32:47]
  ds_read_b64_tr_b16 v[220:221], v240 offset:55296
  ds_read_b64_tr_b16 v[222:223], v240 offset:55808
  v_mov_b32_dpp v248, v244 row_half_mirror row_mask:0xf bank_mask:0x5
  v_mov_b32_dpp v249, v245 row_half_mirror row_mask:0xf bank_mask:0x5
  v_mov_b32_dpp v250, v246 row_half_mirror row_mask:0xf bank_mask:0x5
  v_mov_b32_dpp v251, v247 row_half_mirror row_mask:0xf bank_mask:0x5
  s_waitcnt lgkmcnt(8)
  v_mfma_f32_32x32x16_bf16 v[32:47], v[232:235], v[200:203], v[32:47]
  ds_read_b64_tr_b16 v[224:225], v241 offset:49152
  ds_read_b64_tr_b16 v[226:227], v241 offset:49664
  v_cvt_pk_bf16_f32 v56, v16, v17
  v_cvt_pk_bf16_f32 v57, v18, v19
  v_cvt_pk_bf16_f32 v58, v20, v21
  v_cvt_pk_bf16_f32 v59, v22, v23
  v_mov_b32_dpp v244, v244 row_half_mirror row_mask:0xf bank_mask:0xa
  v_mov_b32_dpp v245, v245 row_half_mirror row_mask:0xf bank_mask:0xa
  v_mov_b32_dpp v246, v246 row_half_mirror row_mask:0xf bank_mask:0xa
  v_mov_b32_dpp v247, v247 row_half_mirror row_mask:0xf bank_mask:0xa
  v_mfma_f32_32x32x16_bf16 v[32:47], v[236:239], v[204:207], v[32:47]
  ds_read_b64_tr_b16 v[228:229], v241 offset:51200
  ds_read_b64_tr_b16 v[230:231], v241 offset:51712
  v_cvt_pk_bf16_f32 v60, v24, v25
  v_cvt_pk_bf16_f32 v61, v26, v27
  v_cvt_pk_bf16_f32 v62, v28, v29
  v_cvt_pk_bf16_f32 v63, v30, v31
  v_lshlrev_b32 v9, 16, v252
  v_lshlrev_b32 v10, 16, v248
  v_lshlrev_b32 v11, 16, v244
  v_fmac_f32 v11, v9, v10
  v_and_b32 v9, 0xffff0000, v252
  s_waitcnt lgkmcnt(8)
  v_mfma_f32_32x32x16_bf16 v[16:31], v[80:83], v[208:211], 0
  ds_read_b64_tr_b16 v[232:233], v241 offset:53248
  ds_read_b64_tr_b16 v[234:235], v241 offset:53760
  v_and_b32 v10, 0xffff0000, v248
  v_and_b32 v244, 0xffff0000, v244
  v_fmac_f32 v244, v9, v10
  v_mul_f32 v11, s74, v11
  v_mfma_f32_32x32x16_bf16 v[16:31], v[84:87], v[212:215], v[16:31]
  ds_read_b64_tr_b16 v[236:237], v241 offset:55296
  ds_read_b64_tr_b16 v[238:239], v241 offset:55808
  s_add_u32 m0, s48, 8192
  s_add_u32 s35, s49, 3670016
  buffer_load_dwordx4 v2, s[56:59], s35 offen lds
  v_mul_f32 v244, s74, v244
  v_cvt_pk_bf16_f32 v252, v11, v244
  v_lshlrev_b32 v9, 16, v253
  v_lshlrev_b32 v10, 16, v249
  s_waitcnt lgkmcnt(8)
  v_mfma_f32_32x32x16_bf16 v[16:31], v[88:91], v[216:219], v[16:31]
  ds_read_b64_tr_b16 v[208:209], v240 offset:57344
  ds_read_b64_tr_b16 v[210:211], v240 offset:57856
  v_cvt_pk_bf16_f32 v72, v32, v33
  v_cvt_pk_bf16_f32 v73, v34, v35
  v_cvt_pk_bf16_f32 v74, v36, v37
  v_cvt_pk_bf16_f32 v75, v38, v39
  v_lshlrev_b32 v11, 16, v245
  v_fmac_f32 v11, v9, v10
  v_and_b32 v9, 0xffff0000, v253
  v_and_b32 v10, 0xffff0000, v249
  v_and_b32 v245, 0xffff0000, v245
  v_mfma_f32_32x32x16_bf16 v[16:31], v[92:95], v[220:223], v[16:31]
  ds_read_b64_tr_b16 v[212:213], v241 offset:57344
  ds_read_b64_tr_b16 v[214:215], v241 offset:57856
  v_cvt_pk_bf16_f32 v76, v40, v41
  v_cvt_pk_bf16_f32 v77, v42, v43
  v_cvt_pk_bf16_f32 v78, v44, v45
  v_cvt_pk_bf16_f32 v79, v46, v47
  v_fmac_f32 v245, v9, v10
  v_mul_f32 v11, s74, v11
  v_mul_f32 v245, s74, v245
  v_cvt_pk_bf16_f32 v253, v11, v245
  s_waitcnt lgkmcnt(8)
  v_mfma_f32_32x32x16_bf16 v[32:47], v[80:83], v[224:227], 0
  ds_read_b64_tr_b16 v[216:217], v240 offset:59392
  ds_read_b64_tr_b16 v[218:219], v240 offset:59904
  v_lshlrev_b32 v9, 16, v254
  v_lshlrev_b32 v10, 16, v250
  v_lshlrev_b32 v11, 16, v246
  v_fmac_f32 v11, v9, v10
  v_mfma_f32_32x32x16_bf16 v[32:47], v[84:87], v[228:231], v[32:47]
  ds_read_b64_tr_b16 v[220:221], v241 offset:59392
  ds_read_b64_tr_b16 v[222:223], v241 offset:59904
  v_and_b32 v9, 0xffff0000, v254
  v_and_b32 v10, 0xffff0000, v250
  v_and_b32 v246, 0xffff0000, v246
  v_fmac_f32 v246, v9, v10
  s_waitcnt lgkmcnt(8)
  v_mfma_f32_32x32x16_bf16 v[32:47], v[88:91], v[232:235], v[32:47]
  ds_read_b64_tr_b16 v[224:225], v240 offset:61440
  ds_read_b64_tr_b16 v[226:227], v240 offset:61952
  s_add_u32 m0, s48, 16384
  s_add_u32 s35, s49, 128
  buffer_load_dwordx4 v2, s[56:59], s35 offen lds
  v_mul_f32 v11, s74, v11
  v_mul_f32 v246, s74, v246
  v_cvt_pk_bf16_f32 v254, v11, v246
  v_lshlrev_b32 v9, 16, v255
  v_lshlrev_b32 v10, 16, v251
  v_mfma_f32_32x32x16_bf16 v[32:47], v[92:95], v[236:239], v[32:47]
  ds_read_b64_tr_b16 v[228:229], v241 offset:61440
  ds_read_b64_tr_b16 v[230:231], v241 offset:61952
  v_lshlrev_b32 v11, 16, v247
  v_fmac_f32 v11, v9, v10
  v_and_b32 v9, 0xffff0000, v255
  v_and_b32 v10, 0xffff0000, v251
  s_waitcnt lgkmcnt(8)
  v_mfma_f32_32x32x16_bf16 v[16:31], v[96:99], v[208:211], v[16:31]
  ds_read_b64_tr_b16 v[232:233], v240 offset:63488
  ds_read_b64_tr_b16 v[234:235], v240 offset:64000
  v_and_b32 v247, 0xffff0000, v247
  v_fmac_f32 v247, v9, v10
  v_mul_f32 v11, s74, v11
  v_mul_f32 v247, s74, v247
  v_mfma_f32_32x32x16_bf16 v[32:47], v[96:99], v[212:215], v[32:47]
  ds_read_b64_tr_b16 v[236:237], v241 offset:63488
  ds_read_b64_tr_b16 v[238:239], v241 offset:64000
  v_cvt_pk_bf16_f32 v255, v11, v247
  v_lshrrev_b32 v12, 3, v0
  v_lshlrev_b32 v12, 9, v12
  v_and_b32 v15, 7, v0
  v_lshl_add_u32 v12, v15, 4, v12
  s_waitcnt lgkmcnt(8)
  v_mfma_f32_32x32x16_bf16 v[16:31], v[100:103], v[216:219], v[16:31]
  s_waitcnt vmcnt(6)
  s_barrier
  ds_read_b64_tr_b16 v[208:209], v242 offset:0
  ds_read_b64_tr_b16 v[210:211], v242 offset:512
  s_lshr_b32 s74, s72, 5
  s_lshl_b32 s74, s74, 15
  s_and_b32 s44, s72, 31
  s_lshl_b32 s44, s44, 4
  v_mfma_f32_32x32x16_bf16 v[32:47], v[100:103], v[220:223], v[32:47]
  ds_read_b64_tr_b16 v[212:213], v243 offset:0
  ds_read_b64_tr_b16 v[214:215], v243 offset:512
  s_add_u32 s74, s74, s44
  s_lshl_b32 s44, s28, 12
  s_add_u32 s74, s74, s44
  buffer_store_dwordx4 v[252:255], v12, s[16:19], s74 offen sc1
  s_waitcnt lgkmcnt(8)
  v_mfma_f32_32x32x16_bf16 v[16:31], v[104:107], v[224:227], v[16:31]
  ds_read_b64_tr_b16 v[216:217], v242 offset:2048
  ds_read_b64_tr_b16 v[218:219], v242 offset:2560
  s_add_u32 m0, s48, 24576
  s_add_u32 s35, s49, 524416
  buffer_load_dwordx4 v2, s[56:59], s35 offen lds
  s_add_u32 s44, s31, 36
  s_lshl_b32 s44, s44, 8
  s_add_u32 s44, s44, s63
  v_mov_b32 v14, 1
  v_mfma_f32_32x32x16_bf16 v[32:47], v[104:107], v[228:231], v[32:47]
  ds_read_b64_tr_b16 v[220:221], v243 offset:2048
  ds_read_b64_tr_b16 v[222:223], v243 offset:2560
  s_waitcnt lgkmcnt(8)
  v_mfma_f32_32x32x16_bf16 v[16:31], v[108:111], v[232:235], v[16:31]
  ds_read_b64_tr_b16 v[224:225], v242 offset:4096
  ds_read_b64_tr_b16 v[226:227], v242 offset:4608
  v_mfma_f32_32x32x16_bf16 v[32:47], v[108:111], v[236:239], v[32:47]
  ds_read_b64_tr_b16 v[228:229], v243 offset:4096
  ds_read_b64_tr_b16 v[230:231], v243 offset:4608
  s_add_u32 s75, s7, 528384
  buffer_store_dwordx4 v[48:51], v1, s[12:15], s75 offen offset:0 sc1
  s_waitcnt lgkmcnt(8)
  v_mfma_f32_32x32x16_bf16 v[16:31], v[112:115], v[208:211], v[16:31]
  ds_read_b64_tr_b16 v[232:233], v242 offset:6144
  ds_read_b64_tr_b16 v[234:235], v242 offset:6656
  v_mfma_f32_32x32x16_bf16 v[32:47], v[112:115], v[212:215], v[32:47]
  ds_read_b64_tr_b16 v[236:237], v243 offset:6144
  ds_read_b64_tr_b16 v[238:239], v243 offset:6656
  s_add_u32 m0, s48, 32768
  s_add_u32 s35, s49, 1048704
  buffer_load_dwordx4 v2, s[56:59], s35 offen lds
  s_waitcnt lgkmcnt(8)
  v_mfma_f32_32x32x16_bf16 v[16:31], v[116:119], v[216:219], v[16:31]
  ds_read_b64_tr_b16 v[208:209], v242 offset:8192
  ds_read_b64_tr_b16 v[210:211], v242 offset:8704
  v_mfma_f32_32x32x16_bf16 v[32:47], v[116:119], v[220:223], v[32:47]
  ds_read_b64_tr_b16 v[212:213], v243 offset:8192
  ds_read_b64_tr_b16 v[214:215], v243 offset:8704
  s_waitcnt lgkmcnt(8)
  v_mfma_f32_32x32x16_bf16 v[16:31], v[120:123], v[224:227], v[16:31]
  ds_read_b64_tr_b16 v[216:217], v242 offset:10240
  ds_read_b64_tr_b16 v[218:219], v242 offset:10752
  v_mfma_f32_32x32x16_bf16 v[32:47], v[120:123], v[228:231], v[32:47]
  ds_read_b64_tr_b16 v[220:221], v243 offset:10240
  ds_read_b64_tr_b16 v[222:223], v243 offset:10752
  s_waitcnt lgkmcnt(8)
  v_mfma_f32_32x32x16_bf16 v[16:31], v[124:127], v[232:235], v[16:31]
  ds_read_b64_tr_b16 v[224:225], v242 offset:12288
  ds_read_b64_tr_b16 v[226:227], v242 offset:12800
  v_mfma_f32_32x32x16_bf16 v[32:47], v[124:127], v[236:239], v[32:47]
  ds_read_b64_tr_b16 v[228:229], v243 offset:12288
  ds_read_b64_tr_b16 v[230:231], v243 offset:12800
  s_add_u32 m0, s48, 40960
  s_add_u32 s35, s49, 1572992
  buffer_load_dwordx4 v2, s[56:59], s35 offen lds
  s_waitcnt lgkmcnt(8)
  v_mfma_f32_32x32x16_bf16 v[16:31], v[128:131], v[208:211], v[16:31]
  ds_read_b64_tr_b16 v[232:233], v242 offset:14336
  ds_read_b64_tr_b16 v[234:235], v242 offset:14848
  s_add_u32 s75, s7, 528384
  buffer_store_dwordx4 v[52:55], v1, s[12:15], s75 offen offset:1024 sc1
  v_mfma_f32_32x32x16_bf16 v[32:47], v[128:131], v[212:215], v[32:47]
  ds_read_b64_tr_b16 v[236:237], v243 offset:14336
  ds_read_b64_tr_b16 v[238:239], v243 offset:14848
  s_waitcnt lgkmcnt(8)
  v_mfma_f32_32x32x16_bf16 v[16:31], v[132:135], v[216:219], v[16:31]
  s_waitcnt vmcnt(9)
  s_waitcnt vmcnt(5)
  s_barrier
  ds_read_b64_tr_b16 v[208:209], v240 offset:0
  ds_read_b64_tr_b16 v[210:211], v240 offset:512
  s_mov_b64 exec, 1
  buffer_atomic_add v14, v13, s[76:79], s44 offen sc0 sc1
  s_mov_b64 exec, -1
  v_mfma_f32_32x32x16_bf16 v[32:47], v[132:135], v[220:223], v[32:47]
  ds_read_b64_tr_b16 v[212:213], v241 offset:0
  ds_read_b64_tr_b16 v[214:215], v241 offset:512
  s_waitcnt lgkmcnt(8)
  v_mfma_f32_32x32x16_bf16 v[16:31], v[136:139], v[224:227], v[16:31]
  ds_read_b64_tr_b16 v[216:217], v240 offset:2048
  ds_read_b64_tr_b16 v[218:219], v240 offset:2560
  s_add_u32 m0, s48, 49152
  s_add_u32 s35, s49, 2097280
  buffer_load_dwordx4 v2, s[56:59], s35 offen lds
  v_mfma_f32_32x32x16_bf16 v[32:47], v[136:139], v[228:231], v[32:47]
  ds_read_b64_tr_b16 v[220:221], v241 offset:2048
  ds_read_b64_tr_b16 v[222:223], v241 offset:2560
  s_waitcnt lgkmcnt(8)
  v_mfma_f32_32x32x16_bf16 v[16:31], v[140:143], v[232:235], v[16:31]
  ds_read_b64_tr_b16 v[224:225], v240 offset:4096
  ds_read_b64_tr_b16 v[226:227], v240 offset:4608
  v_mfma_f32_32x32x16_bf16 v[32:47], v[140:143], v[236:239], v[32:47]
  ds_read_b64_tr_b16 v[228:229], v241 offset:4096
  ds_read_b64_tr_b16 v[230:231], v241 offset:4608
  s_waitcnt lgkmcnt(8)
  v_mfma_f32_32x32x16_bf16 v[16:31], v[144:147], v[208:211], v[16:31]
  ds_read_b64_tr_b16 v[232:233], v240 offset:6144
  ds_read_b64_tr_b16 v[234:235], v240 offset:6656
  v_mfma_f32_32x32x16_bf16 v[32:47], v[144:147], v[212:215], v[32:47]
  ds_read_b64_tr_b16 v[236:237], v241 offset:6144
  ds_read_b64_tr_b16 v[238:239], v241 offset:6656
  s_waitcnt lgkmcnt(8)
  v_mfma_f32_32x32x16_bf16 v[16:31], v[148:151], v[216:219], v[16:31]
  ds_read_b64_tr_b16 v[208:209], v240 offset:8192
  ds_read_b64_tr_b16 v[210:211], v240 offset:8704
  s_add_u32 m0, s48, 57344
  s_add_u32 s35, s49, 2621568
  buffer_load_dwordx4 v2, s[56:59], s35 offen lds
  s_add_u32 s75, s7, 524288
  buffer_store_dwordx4 v[56:59], v1, s[12:15], s75 offen offset:0 sc1
  v_mfma_f32_32x32x16_bf16 v[32:47], v[148:151], v[220:223], v[32:47]
  ds_read_b64_tr_b16 v[212:213], v241 offset:8192
  ds_read_b64_tr_b16 v[214:215], v241 offset:8704
  s_waitcnt lgkmcnt(8)
  v_mfma_f32_32x32x16_bf16 v[16:31], v[152:155], v[224:227], v[16:31]
  ds_read_b64_tr_b16 v[216:217], v240 offset:10240
  ds_read_b64_tr_b16 v[218:219], v240 offset:10752
  v_mfma_f32_32x32x16_bf16 v[32:47], v[152:155], v[228:231], v[32:47]
  ds_read_b64_tr_b16 v[220:221], v241 offset:10240
  ds_read_b64_tr_b16 v[222:223], v241 offset:10752
  s_waitcnt lgkmcnt(8)
  v_mfma_f32_32x32x16_bf16 v[16:31], v[156:159], v[232:235], v[16:31]
  ds_read_b64_tr_b16 v[224:225], v240 offset:12288
  ds_read_b64_tr_b16 v[226:227], v240 offset:12800
  v_mfma_f32_32x32x16_bf16 v[32:47], v[156:159], v[236:239], v[32:47]
  ds_read_b64_tr_b16 v[228:229], v241 offset:12288
  ds_read_b64_tr_b16 v[230:231], v241 offset:12800
  s_add_u32 m0, s48, 81920
  s_add_u32 s35, s49, 3145856
  buffer_load_dwordx4 v2, s[56:59], s35 offen lds
  s_waitcnt lgkmcnt(8)
  v_mfma_f32_32x32x16_bf16 v[16:31], v[160:163], v[208:211], v[16:31]
  ds_read_b64_tr_b16 v[232:233], v240 offset:14336
  ds_read_b64_tr_b16 v[234:235], v240 offset:14848
  s_cmp_ge_u32 s44, 1048576
  s_cbranch_scc1 u_na_AH
  s_waitcnt vmcnt(4)
  v_readfirstlane_b32 s33, v14
  s_nop 0
  s_cmp_lg_u32 s33, 31
  s_cbranch_scc1 u_na_AH
  s_mov_b64 exec, 1
  buffer_store_dword v14, v13, s[76:79], s44 offen offset:128 sc1
  s_mov_b64 exec, -1
u_na_AH:
  v_mfma_f32_32x32x16_bf16 v[32:47], v[160:163], v[212:215], v[32:47]
  ds_read_b64_tr_b16 v[236:237], v241 offset:14336
  ds_read_b64_tr_b16 v[238:239], v241 offset:14848
  s_waitcnt lgkmcnt(8)
  v_mfma_f32_32x32x16_bf16 v[16:31], v[164:167], v[216:219], v[16:31]
  s_waitcnt vmcnt(12)
  s_barrier
  ds_read_b64_tr_b16 v[208:209], v5 offset:0
  ds_read_b64_tr_b16 v[210:211], v5 offset:512
  v_mfma_f32_32x32x16_bf16 v[32:47], v[164:167], v[220:223], v[32:47]
  ds_read_b64_tr_b16 v[212:213], v6 offset:0
  ds_read_b64_tr_b16 v[214:215], v6 offset:512
  s_waitcnt lgkmcnt(8)
  v_mfma_f32_32x32x16_bf16 v[16:31], v[168:171], v[224:227], v[16:31]
  ds_read_b64_tr_b16 v[216:217], v5 offset:2048
  ds_read_b64_tr_b16 v[218:219], v5 offset:2560
  s_add_u32 s75, s7, 524288
  buffer_store_dwordx4 v[60:63], v1, s[12:15], s75 offen offset:1024 sc1
  v_mfma_f32_32x32x16_bf16 v[32:47], v[168:171], v[228:231], v[32:47]
  ds_read_b64_tr_b16 v[220:221], v6 offset:2048
  ds_read_b64_tr_b16 v[222:223], v6 offset:2560
  s_add_u32 m0, s48, 90112
  s_add_u32 s35, s49, 3670144
  buffer_load_dwordx4 v2, s[56:59], s35 offen lds
  s_waitcnt lgkmcnt(8)
  v_mfma_f32_32x32x16_bf16 v[16:31], v[172:175], v[232:235], v[16:31]
  ds_read_b64_tr_b16 v[224:225], v5 offset:4096
  ds_read_b64_tr_b16 v[226:227], v5 offset:4608
  v_mfma_f32_32x32x16_bf16 v[32:47], v[172:175], v[236:239], v[32:47]
  ds_read_b64_tr_b16 v[228:229], v6 offset:4096
  ds_read_b64_tr_b16 v[230:231], v6 offset:4608
  s_waitcnt lgkmcnt(8)
  v_mfma_f32_32x32x16_bf16 v[16:31], v[176:179], v[208:211], v[16:31]
  ds_read_b64_tr_b16 v[232:233], v5 offset:6144
  ds_read_b64_tr_b16 v[234:235], v5 offset:6656
  v_mfma_f32_32x32x16_bf16 v[32:47], v[176:179], v[212:215], v[32:47]
  ds_read_b64_tr_b16 v[236:237], v6 offset:6144
  ds_read_b64_tr_b16 v[238:239], v6 offset:6656
  s_waitcnt lgkmcnt(8)
  v_mfma_f32_32x32x16_bf16 v[16:31], v[180:183], v[216:219], v[16:31]
  ds_read_b64_tr_b16 v[208:209], v5 offset:8192
  ds_read_b64_tr_b16 v[210:211], v5 offset:8704
  s_add_u32 m0, s48, 131072
  s_add_u32 s35, s51, 0
  buffer_load_dwordx4 v2, s[8:11], s35 offen lds
  v_mfma_f32_32x32x16_bf16 v[32:47], v[180:183], v[220:223], v[32:47]
  ds_read_b64_tr_b16 v[212:213], v6 offset:8192
  ds_read_b64_tr_b16 v[214:215], v6 offset:8704
  s_waitcnt lgkmcnt(8)
  v_mfma_f32_32x32x16_bf16 v[16:31], v[184:187], v[224:227], v[16:31]
  ds_read_b64_tr_b16 v[216:217], v5 offset:10240
  ds_read_b64_tr_b16 v[218:219], v5 offset:10752
  v_mov_b32 v252, v68
  v_mov_b32 v253, v69
  v_mfma_f32_32x32x16_bf16 v[32:47], v[184:187], v[228:231], v[32:47]
  ds_read_b64_tr_b16 v[220:221], v6 offset:10240
  ds_read_b64_tr_b16 v[222:223], v6 offset:10752
  v_mov_b32 v254, v70
  v_mov_b32 v255, v71
  s_waitcnt lgkmcnt(8)
  v_mfma_f32_32x32x16_bf16 v[16:31], v[188:191], v[232:235], v[16:31]
  ds_read_b64_tr_b16 v[224:225], v5 offset:12288
  ds_read_b64_tr_b16 v[226:227], v5 offset:12800
  s_add_u32 s75, s7, 528384
  buffer_store_dwordx4 v[64:67], v1, s[12:15], s75 offen offset:2048 sc1
  v_mfma_f32_32x32x16_bf16 v[32:47], v[188:191], v[236:239], v[32:47]
  ds_read_b64_tr_b16 v[228:229], v6 offset:12288
  ds_read_b64_tr_b16 v[230:231], v6 offset:12800
  s_waitcnt lgkmcnt(8)
  v_mfma_f32_32x32x16_bf16 v[16:31], v[192:195], v[208:211], v[16:31]
  ds_read_b64_tr_b16 v[232:233], v5 offset:14336
  ds_read_b64_tr_b16 v[234:235], v5 offset:14848
  s_add_u32 m0, s48, 139264
  s_add_u32 s35, s51, 128
  buffer_load_dwordx4 v2, s[8:11], s35 offen lds
  v_mov_b32 v248, v72
  v_mov_b32 v249, v73
  v_mfma_f32_32x32x16_bf16 v[32:47], v[192:195], v[212:215], v[32:47]
  ds_read_b64_tr_b16 v[236:237], v6 offset:14336
  ds_read_b64_tr_b16 v[238:239], v6 offset:14848
  v_mov_b32 v250, v74
  v_mov_b32 v251, v75
  s_waitcnt lgkmcnt(8)
  v_mfma_f32_32x32x16_bf16 v[16:31], v[196:199], v[216:219], v[16:31]
  s_waitcnt vmcnt(14)
  s_barrier
  ds_read_b64_tr_b16 v[208:209], v5 offset:16384
  ds_read_b64_tr_b16 v[210:211], v5 offset:16896
  buffer_load_dword v14, v13, s[76:79], s44 offen offset:128 sc1
  v_mfma_f32_32x32x16_bf16 v[32:47], v[196:199], v[220:223], v[32:47]
  ds_read_b64_tr_b16 v[212:213], v6 offset:16384
  ds_read_b64_tr_b16 v[214:215], v6 offset:16896
  s_waitcnt lgkmcnt(8)
  v_mfma_f32_32x32x16_bf16 v[16:31], v[200:203], v[224:227], v[16:31]
  ds_read_b64_tr_b16 v[216:217], v5 offset:18432
  ds_read_b64_tr_b16 v[218:219], v5 offset:18944
  v_mov_b32 v244, v76
  v_mov_b32 v245, v77
  v_mfma_f32_32x32x16_bf16 v[32:47], v[200:203], v[228:231], v[32:47]
  ds_read_b64_tr_b16 v[220:221], v6 offset:18432
  ds_read_b64_tr_b16 v[222:223], v6 offset:18944
  s_add_u32 m0, s48, 65536
  s_add_u32 s35, s51, 524288
  s_and_b32 s35, s35, 0x3fffff
  buffer_load_dwordx4 v2, s[8:11], s35 offen lds
  v_mov_b32 v246, v78
  v_mov_b32 v247, v79
  s_waitcnt lgkmcnt(8)
  v_mfma_f32_32x32x16_bf16 v[16:31], v[204:207], v[232:235], v[16:31]
  ds_read_b64_tr_b16 v[224:225], v5 offset:20480
  ds_read_b64_tr_b16 v[226:227], v5 offset:20992
  v_mfma_f32_32x32x16_bf16 v[32:47], v[204:207], v[236:239], v[32:47]
  ds_read_b64_tr_b16 v[228:229], v6 offset:20480
  ds_read_b64_tr_b16 v[230:231], v6 offset:20992
  s_waitcnt lgkmcnt(8)
  v_mfma_f32_32x32x16_bf16 v[48:63], v[80:83], v[208:211], 0
  ds_read_b64_tr_b16 v[232:233], v5 offset:22528
  ds_read_b64_tr_b16 v[234:235], v5 offset:23040
  s_add_u32 s75, s7, 528384
  buffer_store_dwordx4 v[252:255], v1, s[12:15], s75 offen offset:3072 sc1
  v_mfma_f32_32x32x16_bf16 v[64:79], v[80:83], v[212:215], 0
  ds_read_b64_tr_b16 v[236:237], v6 offset:22528
  ds_read_b64_tr_b16 v[238:239], v6 offset:23040
  s_waitcnt lgkmcnt(8)
  v_mfma_f32_32x32x16_bf16 v[48:63], v[84:87], v[216:219], v[48:63]
  ds_read_b64_tr_b16 v[208:209], v5 offset:24576
  ds_read_b64_tr_b16 v[210:211], v5 offset:25088
  v_cvt_pk_bf16_f32 v16, v16, v17
  v_cvt_pk_bf16_f32 v17, v18, v19
  v_cvt_pk_bf16_f32 v18, v20, v21
  v_mfma_f32_32x32x16_bf16 v[64:79], v[84:87], v[220:223], v[64:79]
  ds_read_b64_tr_b16 v[212:213], v6 offset:24576
  ds_read_b64_tr_b16 v[214:215], v6 offset:25088
  s_add_u32 m0, s48, 73728
  s_add_u32 s35, s51, 524416
  s_and_b32 s35, s35, 0x3fffff
  buffer_load_dwordx4 v2, s[8:11], s35 offen lds
  v_cvt_pk_bf16_f32 v19, v22, v23
  v_cvt_pk_bf16_f32 v20, v24, v25
  v_cvt_pk_bf16_f32 v21, v26, v27
  s_waitcnt lgkmcnt(8)
  v_mfma_f32_32x32x16_bf16 v[48:63], v[88:91], v[224:227], v[48:63]
  ds_read_b64_tr_b16 v[216:217], v5 offset:26624
  ds_read_b64_tr_b16 v[218:219], v5 offset:27136
  v_cvt_pk_bf16_f32 v22, v28, v29
  v_cvt_pk_bf16_f32 v23, v30, v31
  v_mfma_f32_32x32x16_bf16 v[64:79], v[88:91], v[228:231], v[64:79]
  ds_read_b64_tr_b16 v[220:221], v6 offset:26624
  ds_read_b64_tr_b16 v[222:223], v6 offset:27136
  v_cvt_pk_bf16_f32 v32, v32, v33
  v_cvt_pk_bf16_f32 v33, v34, v35
  v_cvt_pk_bf16_f32 v34, v36, v37
  s_waitcnt lgkmcnt(8)
  v_mfma_f32_32x32x16_bf16 v[48:63], v[92:95], v[232:235], v[48:63]
  ds_read_b64_tr_b16 v[224:225], v5 offset:28672
  ds_read_b64_tr_b16 v[226:227], v5 offset:29184
  v_cvt_pk_bf16_f32 v35, v38, v39
  v_cvt_pk_bf16_f32 v36, v40, v41
  v_cvt_pk_bf16_f32 v37, v42, v43
  v_mfma_f32_32x32x16_bf16 v[64:79], v[92:95], v[236:239], v[64:79]
  ds_read_b64_tr_b16 v[228:229], v6 offset:28672
  ds_read_b64_tr_b16 v[230:231], v6 offset:29184
  v_cvt_pk_bf16_f32 v38, v44, v45
  v_cvt_pk_bf16_f32 v39, v46, v47
  s_waitcnt lgkmcnt(8)
  v_mfma_f32_32x32x16_bf16 v[48:63], v[96:99], v[208:211], v[48:63]
  ds_read_b64_tr_b16 v[232:233], v5 offset:30720
  ds_read_b64_tr_b16 v[234:235], v5 offset:31232
  v_mfma_f32_32x32x16_bf16 v[64:79], v[96:99], v[212:215], v[64:79]
  ds_read_b64_tr_b16 v[236:237], v6 offset:30720
  ds_read_b64_tr_b16 v[238:239], v6 offset:31232
  s_add_u32 s75, s7, 524288
  buffer_store_dwordx4 v[248:251], v1, s[12:15], s75 offen offset:2048 sc1
  s_waitcnt lgkmcnt(8)
  v_mfma_f32_32x32x16_bf16 v[48:63], v[100:103], v[216:219], v[48:63]
  s_waitcnt vmcnt(16)
  s_cmp_lg_u32 s28, 0
  s_cbranch_scc1 u_go_PH
  s_waitcnt vmcnt(4)
  v_readfirstlane_b32 s73, v14
  s_add_u32 s73, s73, s63
  s_cmp_lt_u32 s73, 1
  s_cbranch_scc1 u_spin_PH
u_go_PH:
  s_barrier
  ds_read_b64_tr_b16 v[208:209], v5 offset:32768
  ds_read_b64_tr_b16 v[210:211], v5 offset:33280
  v_mfma_f32_32x32x16_bf16 v[64:79], v[100:103], v[220:223], v[64:79]
  ds_read_b64_tr_b16 v[212:213], v6 offset:32768
  ds_read_b64_tr_b16 v[214:215], v6 offset:33280
  s_add_u32 s61, s60, 0
  s_and_b32 s61, s61, 0x7fff
  s_add_u32 s61, s61, s42
  buffer_load_dwordx4 v[80:83], v1, s[16:19], s61 offen offset:0 sc1
  s_waitcnt lgkmcnt(8)
  v_mfma_f32_32x32x16_bf16 v[48:63], v[104:107], v[224:227], v[48:63]
  ds_read_b64_tr_b16 v[216:217], v5 offset:34816
  ds_read_b64_tr_b16 v[218:219], v5 offset:35328
  s_add_u32 m0, s48, 0
  s_add_u32 s35, s51, 1048576
  s_and_b32 s35, s35, 0x3fffff
  buffer_load_dwordx4 v2, s[8:11], s35 offen lds
  v_mfma_f32_32x32x16_bf16 v[64:79], v[104:107], v[228:231], v[64:79]
  ds_read_b64_tr_b16 v[220:221], v6 offset:34816
  ds_read_b64_tr_b16 v[222:223], v6 offset:35328
  s_waitcnt lgkmcnt(8)
  v_mfma_f32_32x32x16_bf16 v[48:63], v[108:111], v[232:235], v[48:63]
  ds_read_b64_tr_b16 v[224:225], v5 offset:36864
  ds_read_b64_tr_b16 v[226:227], v5 offset:37376
  v_mfma_f32_32x32x16_bf16 v[64:79], v[108:111], v[236:239], v[64:79]
  ds_read_b64_tr_b16 v[228:229], v6 offset:36864
  ds_read_b64_tr_b16 v[230:231], v6 offset:37376
  s_waitcnt lgkmcnt(8)
  v_mfma_f32_32x32x16_bf16 v[48:63], v[112:115], v[208:211], v[48:63]
  ds_read_b64_tr_b16 v[232:233], v5 offset:38912
  ds_read_b64_tr_b16 v[234:235], v5 offset:39424
  v_mfma_f32_32x32x16_bf16 v[64:79], v[112:115], v[212:215], v[64:79]
  ds_read_b64_tr_b16 v[236:237], v6 offset:38912
  ds_read_b64_tr_b16 v[238:239], v6 offset:39424
  buffer_load_dwordx4 v[84:87], v1, s[16:19], s61 offen offset:1024 sc1
  s_waitcnt lgkmcnt(8)
  v_mfma_f32_32x32x16_bf16 v[48:63], v[116:119], v[216:219], v[48:63]
  ds_read_b64_tr_b16 v[208:209], v5 offset:40960
  ds_read_b64_tr_b16 v[210:211], v5 offset:41472
  s_add_u32 m0, s48, 8192
  s_add_u32 s35, s51, 1048704
  s_and_b32 s35, s35, 0x3fffff
  buffer_load_dwordx4 v2, s[8:11], s35 offen lds
  v_mfma_f32_32x32x16_bf16 v[64:79], v[116:119], v[220:223], v[64:79]
  ds_read_b64_tr_b16 v[212:213], v6 offset:40960
  ds_read_b64_tr_b16 v[214:215], v6 offset:41472
  s_add_u32 s75, s7, 524288
  buffer_store_dwordx4 v[244:247], v1, s[12:15], s75 offen offset:3072 sc1
  s_waitcnt lgkmcnt(8)
  v_mfma_f32_32x32x16_bf16 v[48:63], v[120:123], v[224:227], v[48:63]
  ds_read_b64_tr_b16 v[216:217], v5 offset:43008
  ds_read_b64_tr_b16 v[218:219], v5 offset:43520
  v_mfma_f32_32x32x16_bf16 v[64:79], v[120:123], v[228:231], v[64:79]
  ds_read_b64_tr_b16 v[220:221], v6 offset:43008
  ds_read_b64_tr_b16 v[222:223], v6 offset:43520
  s_waitcnt lgkmcnt(8)
  v_mfma_f32_32x32x16_bf16 v[48:63], v[124:127], v[232:235], v[48:63]
  ds_read_b64_tr_b16 v[224:225], v5 offset:45056
  ds_read_b64_tr_b16 v[226:227], v5 offset:45568
  v_mfma_f32_32x32x16_bf16 v[64:79], v[124:127], v[236:239], v[64:79]
  ds_read_b64_tr_b16 v[228:229], v6 offset:45056
  ds_read_b64_tr_b16 v[230:231], v6 offset:45568
  buffer_load_dwordx4 v[88:91], v1, s[16:19], s61 offen offset:2048 sc1
  s_waitcnt lgkmcnt(8)
  v_mfma_f32_32x32x16_bf16 v[48:63], v[128:131], v[208:211], v[48:63]
  ds_read_b64_tr_b16 v[232:233], v5 offset:47104
  ds_read_b64_tr_b16 v[234:235], v5 offset:47616
  v_mfma_f32_32x32x16_bf16 v[64:79], v[128:131], v[212:215], v[64:79]
  ds_read_b64_tr_b16 v[236:237], v6 offset:47104
  ds_read_b64_tr_b16 v[238:239], v6 offset:47616
  s_waitcnt lgkmcnt(8)
  v_mfma_f32_32x32x16_bf16 v[48:63], v[132:135], v[216:219], v[48:63]
  s_waitcnt vmcnt(18)
  s_barrier
  ds_read_b64_tr_b16 v[208:209], v5 offset:49152
  ds_read_b64_tr_b16 v[210:211], v5 offset:49664
  v_mfma_f32_32x32x16_bf16 v[64:79], v[132:135], v[220:223], v[64:79]
  ds_read_b64_tr_b16 v[212:213], v6 offset:49152
  ds_read_b64_tr_b16 v[214:215], v6 offset:49664
  s_waitcnt lgkmcnt(8)
  v_mfma_f32_32x32x16_bf16 v[48:63], v[136:139], v[224:227], v[48:63]
  ds_read_b64_tr_b16 v[216:217], v5 offset:51200
  ds_read_b64_tr_b16 v[218:219], v5 offset:51712
  s_add_u32 m0, s48, 16384
  s_add_u32 s35, s51, 1572864
  s_and_b32 s35, s35, 0x3fffff
  buffer_load_dwordx4 v2, s[8:11], s35 offen lds
  v_mfma_f32_32x32x16_bf16 v[64:79], v[136:139], v[228:231], v[64:79]
  ds_read_b64_tr_b16 v[220:221], v6 offset:51200
  ds_read_b64_tr_b16 v[222:223], v6 offset:51712
  s_add_u32 s75, s7, 0
  buffer_store_dwordx4 v[16:19], v1, s[12:15], s75 offen offset:0 sc1
  buffer_load_dwordx4 v[92:95], v1, s[16:19], s61 offen offset:3072 sc1
  s_waitcnt lgkmcnt(8)
  v_mfma_f32_32x32x16_bf16 v[48:63], v[140:143], v[232:235], v[48:63]
  ds_read_b64_tr_b16 v[224:225], v5 offset:53248
  ds_read_b64_tr_b16 v[226:227], v5 offset:53760
  v_mfma_f32_32x32x16_bf16 v[64:79], v[140:143], v[236:239], v[64:79]
  ds_read_b64_tr_b16 v[228:229], v6 offset:53248
  ds_read_b64_tr_b16 v[230:231], v6 offset:53760
  s_waitcnt lgkmcnt(8)
  v_mfma_f32_32x32x16_bf16 v[48:63], v[144:147], v[208:211], v[48:63]
  ds_read_b64_tr_b16 v[232:233], v5 offset:55296
  ds_read_b64_tr_b16 v[234:235], v5 offset:55808
  v_mfma_f32_32x32x16_bf16 v[64:79], v[144:147], v[212:215], v[64:79]
  ds_read_b64_tr_b16 v[236:237], v6 offset:55296
  ds_read_b64_tr_b16 v[238:239], v6 offset:55808
  s_waitcnt lgkmcnt(8)
  v_mfma_f32_32x32x16_bf16 v[48:63], v[148:151], v[216:219], v[48:63]
  ds_read_b64_tr_b16 v[208:209], v5 offset:57344
  ds_read_b64_tr_b16 v[210:211], v5 offset:57856
  s_add_u32 m0, s48, 24576
  s_add_u32 s35, s51, 1572992
  s_and_b32 s35, s35, 0x3fffff
  buffer_load_dwordx4 v2, s[8:11], s35 offen lds
  v_mfma_f32_32x32x16_bf16 v[64:79], v[148:151], v[220:223], v[64:79]
  ds_read_b64_tr_b16 v[212:213], v6 offset:57344
  ds_read_b64_tr_b16 v[214:215], v6 offset:57856
  s_add_u32 s61, s60, 4096
  s_and_b32 s61, s61, 0x7fff
  s_add_u32 s61, s61, s42
  buffer_load_dwordx4 v[96:99], v1, s[16:19], s61 offen offset:0 sc1
  s_waitcnt lgkmcnt(8)
  v_mfma_f32_32x32x16_bf16 v[48:63], v[152:155], v[224:227], v[48:63]
  ds_read_b64_tr_b16 v[216:217], v5 offset:59392
  ds_read_b64_tr_b16 v[218:219], v5 offset:59904
  v_mfma_f32_32x32x16_bf16 v[64:79], v[152:155], v[228:231], v[64:79]
  ds_read_b64_tr_b16 v[220:221], v6 offset:59392
  ds_read_b64_tr_b16 v[222:223], v6 offset:59904
  s_waitcnt lgkmcnt(8)
  v_mfma_f32_32x32x16_bf16 v[48:63], v[156:159], v[232:235], v[48:63]
  ds_read_b64_tr_b16 v[224:225], v5 offset:61440
  ds_read_b64_tr_b16 v[226:227], v5 offset:61952
  v_mfma_f32_32x32x16_bf16 v[64:79], v[156:159], v[236:239], v[64:79]
  ds_read_b64_tr_b16 v[228:229], v6 offset:61440
  ds_read_b64_tr_b16 v[230:231], v6 offset:61952
  s_add_u32 s75, s7, 0
  buffer_store_dwordx4 v[20:23], v1, s[12:15], s75 offen offset:1024 sc1
  s_waitcnt lgkmcnt(8)
  v_mfma_f32_32x32x16_bf16 v[48:63], v[160:163], v[208:211], v[48:63]
  ds_read_b64_tr_b16 v[232:233], v5 offset:63488
  ds_read_b64_tr_b16 v[234:235], v5 offset:64000
  v_mfma_f32_32x32x16_bf16 v[64:79], v[160:163], v[212:215], v[64:79]
  ds_read_b64_tr_b16 v[236:237], v6 offset:63488
  ds_read_b64_tr_b16 v[238:239], v6 offset:64000
  buffer_load_dwordx4 v[100:103], v1, s[16:19], s61 offen offset:1024 sc1
  s_waitcnt lgkmcnt(8)
  v_mfma_f32_32x32x16_bf16 v[48:63], v[164:167], v[216:219], v[48:63]
  s_waitcnt vmcnt(21)
  s_barrier
  ds_read_b64_tr_b16 v[208:209], v240 offset:16384
  ds_read_b64_tr_b16 v[210:211], v240 offset:16896
  v_mfma_f32_32x32x16_bf16 v[64:79], v[164:167], v[220:223], v[64:79]
  ds_read_b64_tr_b16 v[212:213], v241 offset:16384
  ds_read_b64_tr_b16 v[214:215], v241 offset:16896
  s_waitcnt lgkmcnt(8)
  v_mfma_f32_32x32x16_bf16 v[48:63], v[168:171], v[224:227], v[48:63]
  ds_read_b64_tr_b16 v[216:217], v240 offset:18432
  ds_read_b64_tr_b16 v[218:219], v240 offset:18944
  s_add_u32 m0, s48, 32768
  s_add_u32 s35, s51, 2097152
  s_and_b32 s35, s35, 0x3fffff
  buffer_load_dwordx4 v2, s[8:11], s35 offen lds
  v_mfma_f32_32x32x16_bf16 v[64:79], v[168:171], v[228:231], v[64:79]
  ds_read_b64_tr_b16 v[220:221], v241 offset:18432
  ds_read_b64_tr_b16 v[222:223], v241 offset:18944
  s_waitcnt lgkmcnt(8)
  v_mfma_f32_32x32x16_bf16 v[48:63], v[172:175], v[232:235], v[48:63]
  ds_read_b64_tr_b16 v[224:225], v240 offset:20480
  ds_read_b64_tr_b16 v[226:227], v240 offset:20992
  v_mfma_f32_32x32x16_bf16 v[64:79], v[172:175], v[236:239], v[64:79]
  ds_read_b64_tr_b16 v[228:229], v241 offset:20480
  ds_read_b64_tr_b16 v[230:231], v241 offset:20992
  buffer_load_dwordx4 v[104:107], v1, s[16:19], s61 offen offset:2048 sc1
  s_waitcnt lgkmcnt(8)
  v_mfma_f32_32x32x16_bf16 v[48:63], v[176:179], v[208:211], v[48:63]
  ds_read_b64_tr_b16 v[232:233], v240 offset:22528
  ds_read_b64_tr_b16 v[234:235], v240 offset:23040
  v_mfma_f32_32x32x16_bf16 v[64:79], v[176:179], v[212:215], v[64:79]
  ds_read_b64_tr_b16 v[236:237], v241 offset:22528
  ds_read_b64_tr_b16 v[238:239], v241 offset:23040
  s_add_u32 s75, s7, 0
  buffer_store_dwordx4 v[32:35], v1, s[12:15], s75 offen offset:2048 sc1
  s_waitcnt lgkmcnt(8)
  v_mfma_f32_32x32x16_bf16 v[48:63], v[180:183], v[216:219], v[48:63]
  ds_read_b64_tr_b16 v[208:209], v240 offset:24576
  ds_read_b64_tr_b16 v[210:211], v240 offset:25088
  s_add_u32 m0, s48, 40960
  s_add_u32 s35, s51, 2097280
  s_and_b32 s35, s35, 0x3fffff
  buffer_load_dwordx4 v2, s[8:11], s35 offen lds
  v_mfma_f32_32x32x16_bf16 v[64:79], v[180:183], v[220:223], v[64:79]
  ds_read_b64_tr_b16 v[212:213], v241 offset:24576
  ds_read_b64_tr_b16 v[214:215], v241 offset:25088
  s_waitcnt lgkmcnt(8)
  v_mfma_f32_32x32x16_bf16 v[48:63], v[184:187], v[224:227], v[48:63]
  ds_read_b64_tr_b16 v[216:217], v240 offset:26624
  ds_read_b64_tr_b16 v[218:219], v240 offset:27136
  v_mfma_f32_32x32x16_bf16 v[64:79], v[184:187], v[228:231], v[64:79]
  ds_read_b64_tr_b16 v[220:221], v241 offset:26624
  ds_read_b64_tr_b16 v[222:223], v241 offset:27136
  buffer_load_dwordx4 v[108:111], v1, s[16:19], s61 offen offset:3072 sc1
  s_waitcnt lgkmcnt(8)
  v_mfma_f32_32x32x16_bf16 v[48:63], v[188:191], v[232:235], v[48:63]
  ds_read_b64_tr_b16 v[224:225], v240 offset:28672
  ds_read_b64_tr_b16 v[226:227], v240 offset:29184
  v_mfma_f32_32x32x16_bf16 v[64:79], v[188:191], v[236:239], v[64:79]
  ds_read_b64_tr_b16 v[228:229], v241 offset:28672
  ds_read_b64_tr_b16 v[230:231], v241 offset:29184
  s_waitcnt lgkmcnt(8)
  v_mfma_f32_32x32x16_bf16 v[48:63], v[192:195], v[208:211], v[48:63]
  ds_read_b64_tr_b16 v[232:233], v240 offset:30720
  ds_read_b64_tr_b16 v[234:235], v240 offset:31232
  v_mfma_f32_32x32x16_bf16 v[64:79], v[192:195], v[212:215], v[64:79]
  ds_read_b64_tr_b16 v[236:237], v241 offset:30720
  ds_read_b64_tr_b16 v[238:239], v241 offset:31232
  s_waitcnt lgkmcnt(8)
  v_mfma_f32_32x32x16_bf16 v[48:63], v[196:199], v[216:219], v[48:63]
  s_waitcnt vmcnt(23)
  s_barrier
  ds_read_b64_tr_b16 v[208:209], v242 offset:0
  ds_read_b64_tr_b16 v[210:211], v242 offset:512
  v_mfma_f32_32x32x16_bf16 v[64:79], v[196:199], v[220:223], v[64:79]
  ds_read_b64_tr_b16 v[212:213], v243 offset:0
  ds_read_b64_tr_b16 v[214:215], v243 offset:512
  s_add_u32 s75, s7, 0
  buffer_store_dwordx4 v[36:39], v1, s[12:15], s75 offen offset:3072 sc1
  s_waitcnt lgkmcnt(8)
  v_mfma_f32_32x32x16_bf16 v[48:63], v[200:203], v[224:227], v[48:63]
  ds_read_b64_tr_b16 v[216:217], v242 offset:2048
  ds_read_b64_tr_b16 v[218:219], v242 offset:2560
  s_add_u32 m0, s48, 98304
  s_add_u32 s35, s51, 3145728
  s_and_b32 s35, s35, 0x3fffff
  buffer_load_dwordx4 v2, s[8:11], s35 offen lds
  s_add_u32 s61, s60, 8192
  s_and_b32 s61, s61, 0x7fff
  s_add_u32 s61, s61, s42
  buffer_load_dwordx4 v[112:115], v1, s[16:19], s61 offen offset:0 sc1
  v_mfma_f32_32x32x16_bf16 v[64:79], v[200:203], v[228:231], v[64:79]
  ds_read_b64_tr_b16 v[220:221], v243 offset:2048
  ds_read_b64_tr_b16 v[222:223], v243 offset:2560
  s_waitcnt lgkmcnt(8)
  v_mfma_f32_32x32x16_bf16 v[48:63], v[204:207], v[232:235], v[48:63]
  ds_read_b64_tr_b16 v[224:225], v242 offset:4096
  ds_read_b64_tr_b16 v[226:227], v242 offset:4608
  v_mfma_f32_32x32x16_bf16 v[64:79], v[204:207], v[236:239], v[64:79]
  ds_read_b64_tr_b16 v[228:229], v243 offset:4096
  ds_read_b64_tr_b16 v[230:231], v243 offset:4608
  buffer_load_dwordx4 v[116:119], v1, s[16:19], s61 offen offset:1024 sc1
  s_waitcnt vmcnt(13)
  s_waitcnt lgkmcnt(8)
  v_mfma_f32_32x32x16_bf16 v[16:31], v[208:211], v[80:83], 0
  ds_read_b64_tr_b16 v[232:233], v242 offset:6144
  ds_read_b64_tr_b16 v[234:235], v242 offset:6656
  v_mfma_f32_32x32x16_bf16 v[32:47], v[212:215], v[80:83], 0
  ds_read_b64_tr_b16 v[236:237], v243 offset:6144
  ds_read_b64_tr_b16 v[238:239], v243 offset:6656
  s_waitcnt lgkmcnt(8)
  v_mfma_f32_32x32x16_bf16 v[16:31], v[216:219], v[84:87], v[16:31]
  ds_read_b64_tr_b16 v[208:209], v242 offset:8192
  ds_read_b64_tr_b16 v[210:211], v242 offset:8704
  s_add_u32 m0, s48, 106496
  s_add_u32 s35, s51, 3145856
  s_and_b32 s35, s35, 0x3fffff
  buffer_load_dwordx4 v2, s[8:11], s35 offen lds
  v_cvt_pk_bf16_f32 v244, v48, v49
  v_cvt_pk_bf16_f32 v245, v50, v51
  v_cvt_pk_bf16_f32 v246, v52, v53
  buffer_load_dwordx4 v[120:123], v1, s[16:19], s61 offen offset:2048 sc1
  v_mfma_f32_32x32x16_bf16 v[32:47], v[220:223], v[84:87], v[32:47]
  ds_read_b64_tr_b16 v[212:213], v243 offset:8192
  ds_read_b64_tr_b16 v[214:215], v243 offset:8704
  v_cvt_pk_bf16_f32 v247, v54, v55
  v_cvt_pk_bf16_f32 v248, v56, v57
  v_cvt_pk_bf16_f32 v249, v58, v59
  s_waitcnt lgkmcnt(8)
  v_mfma_f32_32x32x16_bf16 v[16:31], v[224:227], v[88:91], v[16:31]
  ds_read_b64_tr_b16 v[216:217], v242 offset:10240
  ds_read_b64_tr_b16 v[218:219], v242 offset:10752
  v_cvt_pk_bf16_f32 v250, v60, v61
  v_cvt_pk_bf16_f32 v251, v62, v63
  v_mfma_f32_32x32x16_bf16 v[32:47], v[228:231], v[88:91], v[32:47]
  ds_read_b64_tr_b16 v[220:221], v243 offset:10240
  ds_read_b64_tr_b16 v[222:223], v243 offset:10752
  v_cvt_pk_bf16_f32 v252, v64, v65
  v_cvt_pk_bf16_f32 v253, v66, v67
  v_cvt_pk_bf16_f32 v254, v68, v69
  buffer_load_dwordx4 v[124:127], v1, s[16:19], s61 offen offset:3072 sc1
  s_waitcnt lgkmcnt(8)
  v_mfma_f32_32x32x16_bf16 v[16:31], v[232:235], v[92:95], v[16:31]
  ds_read_b64_tr_b16 v[224:225], v242 offset:12288
  ds_read_b64_tr_b16 v[226:227], v242 offset:12800
  s_add_u32 s75, s7, 4096
  buffer_store_dwordx4 v[244:247], v1, s[12:15], s75 offen offset:0 sc1
  v_cvt_pk_bf16_f32 v255, v70, v71
  v_cvt_pk_bf16_f32 v8, v72, v73
  v_cvt_pk_bf16_f32 v9, v74, v75
  v_mfma_f32_32x32x16_bf16 v[32:47], v[236:239], v[92:95], v[32:47]
  ds_read_b64_tr_b16 v[228:229], v243 offset:12288
  ds_read_b64_tr_b16 v[230:231], v243 offset:12800
  v_cvt_pk_bf16_f32 v10, v76, v77
  v_cvt_pk_bf16_f32 v11, v78, v79
  s_waitcnt lgkmcnt(8)
  v_mfma_f32_32x32x16_bf16 v[48:63], v[208:211], v[80:83], 0
  ds_read_b64_tr_b16 v[232:233], v242 offset:14336
  ds_read_b64_tr_b16 v[234:235], v242 offset:14848
  s_add_u32 s61, s60, 12288
  s_and_b32 s61, s61, 0x7fff
  s_add_u32 s61, s61, s42
  buffer_load_dwordx4 v[128:131], v1, s[16:19], s61 offen offset:0 sc1
  v_mfma_f32_32x32x16_bf16 v[64:79], v[212:215], v[80:83], 0
  ds_read_b64_tr_b16 v[236:237], v243 offset:14336
  ds_read_b64_tr_b16 v[238:239], v243 offset:14848
  s_waitcnt lgkmcnt(8)
  v_mfma_f32_32x32x16_bf16 v[48:63], v[216:219], v[84:87], v[48:63]
  s_waitcnt vmcnt(28)
  s_barrier
  ds_read_b64_tr_b16 v[208:209], v240 offset:0
  ds_read_b64_tr_b16 v[210:211], v240 offset:512
  v_mfma_f32_32x32x16_bf16 v[64:79], v[220:223], v[84:87], v[64:79]
  ds_read_b64_tr_b16 v[212:213], v241 offset:0
  ds_read_b64_tr_b16 v[214:215], v241 offset:512
  buffer_load_dwordx4 v[132:135], v1, s[16:19], s61 offen offset:1024 sc1
  s_waitcnt lgkmcnt(8)
  v_mfma_f32_32x32x16_bf16 v[48:63], v[224:227], v[88:91], v[48:63]
  ds_read_b64_tr_b16 v[216:217], v240 offset:8192
  ds_read_b64_tr_b16 v[218:219], v240 offset:8704
  s_add_u32 m0, s48, 81920
  s_add_u32 s35, s51, 2621440
  s_and_b32 s35, s35, 0x3fffff
  buffer_load_dwordx4 v2, s[8:11], s35 offen lds
  v_mfma_f32_32x32x16_bf16 v[64:79], v[228:231], v[88:91], v[64:79]
  ds_read_b64_tr_b16 v[220:221], v241 offset:8192
  ds_read_b64_tr_b16 v[222:223], v241 offset:8704
  s_waitcnt lgkmcnt(8)
  v_mfma_f32_32x32x16_bf16 v[48:63], v[232:235], v[92:95], v[48:63]
  ds_read_b64_tr_b16 v[224:225], v240 offset:2048
  ds_read_b64_tr_b16 v[226:227], v240 offset:2560
  buffer_load_dwordx4 v[136:139], v1, s[16:19], s61 offen offset:2048 sc1
  v_mfma_f32_32x32x16_bf16 v[64:79], v[236:239], v[92:95], v[64:79]
  ds_read_b64_tr_b16 v[228:229], v241 offset:2048
  ds_read_b64_tr_b16 v[230:231], v241 offset:2560
  s_waitcnt vmcnt(12)
  s_waitcnt lgkmcnt(8)
  v_mfma_f32_32x32x16_bf16 v[16:31], v[208:211], v[96:99], v[16:31]
  ds_read_b64_tr_b16 v[232:233], v240 offset:10240
  ds_read_b64_tr_b16 v[234:235], v240 offset:10752
  s_add_u32 s75, s7, 4096
  buffer_store_dwordx4 v[248:251], v1, s[12:15], s75 offen offset:1024 sc1
  v_mfma_f32_32x32x16_bf16 v[32:47], v[212:215], v[96:99], v[32:47]
  ds_read_b64_tr_b16 v[236:237], v241 offset:10240
  ds_read_b64_tr_b16 v[238:239], v241 offset:10752
  buffer_load_dwordx4 v[140:143], v1, s[16:19], s61 offen offset:3072 sc1
  s_waitcnt lgkmcnt(8)
  v_mfma_f32_32x32x16_bf16 v[48:63], v[216:219], v[96:99], v[48:63]
  ds_read_b64_tr_b16 v[208:209], v240 offset:4096
  ds_read_b64_tr_b16 v[210:211], v240 offset:4608
  s_add_u32 m0, s48, 90112
  s_add_u32 s35, s51, 2621568
  s_and_b32 s35, s35, 0x3fffff
  buffer_load_dwordx4 v2, s[8:11], s35 offen lds
  v_mfma_f32_32x32x16_bf16 v[64:79], v[220:223], v[96:99], v[64:79]
  ds_read_b64_tr_b16 v[212:213], v241 offset:4096
  ds_read_b64_tr_b16 v[214:215], v241 offset:4608
  s_waitcnt lgkmcnt(8)
  v_mfma_f32_32x32x16_bf16 v[16:31], v[224:227], v[100:103], v[16:31]
  ds_read_b64_tr_b16 v[216:217], v240 offset:12288
  ds_read_b64_tr_b16 v[218:219], v240 offset:12800
  s_add_u32 s61, s60, 16384
  s_and_b32 s61, s61, 0x7fff
  s_add_u32 s61, s61, s42
  buffer_load_dwordx4 v[144:147], v1, s[16:19], s61 offen offset:0 sc1
  v_mfma_f32_32x32x16_bf16 v[32:47], v[228:231], v[100:103], v[32:47]
  ds_read_b64_tr_b16 v[220:221], v241 offset:12288
  ds_read_b64_tr_b16 v[222:223], v241 offset:12800
  s_waitcnt lgkmcnt(8)
  v_mfma_f32_32x32x16_bf16 v[48:63], v[232:235], v[100:103], v[48:63]
  ds_read_b64_tr_b16 v[224:225], v240 offset:6144
  ds_read_b64_tr_b16 v[226:227], v240 offset:6656
  v_mfma_f32_32x32x16_bf16 v[64:79], v[236:239], v[100:103], v[64:79]
  ds_read_b64_tr_b16 v[228:229], v241 offset:6144
  ds_read_b64_tr_b16 v[230:231], v241 offset:6656
  buffer_load_dwordx4 v[148:151], v1, s[16:19], s61 offen offset:1024 sc1
  s_waitcnt lgkmcnt(8)
  v_mfma_f32_32x32x16_bf16 v[16:31], v[208:211], v[104:107], v[16:31]
  ds_read_b64_tr_b16 v[232:233], v240 offset:14336
  ds_read_b64_tr_b16 v[234:235], v240 offset:14848
  v_mfma_f32_32x32x16_bf16 v[32:47], v[212:215], v[104:107], v[32:47]
  ds_read_b64_tr_b16 v[236:237], v241 offset:14336
  ds_read_b64_tr_b16 v[238:239], v241 offset:14848
  s_waitcnt lgkmcnt(8)
  v_mfma_f32_32x32x16_bf16 v[48:63], v[216:219], v[104:107], v[48:63]
  s_waitcnt vmcnt(31)
  s_barrier
  ds_read_b64_tr_b16 v[208:209], v5 offset:0
  ds_read_b64_tr_b16 v[210:211], v5 offset:512
  s_add_u32 s75, s7, 4096
  buffer_store_dwordx4 v[252:255], v1, s[12:15], s75 offen offset:2048 sc1
  buffer_load_dwordx4 v[152:155], v1, s[16:19], s61 offen offset:2048 sc1
  v_mfma_f32_32x32x16_bf16 v[64:79], v[220:223], v[104:107], v[64:79]
  ds_read_b64_tr_b16 v[212:213], v6 offset:0
  ds_read_b64_tr_b16 v[214:215], v6 offset:512
  s_waitcnt lgkmcnt(8)
  v_mfma_f32_32x32x16_bf16 v[16:31], v[224:227], v[108:111], v[16:31]
  ds_read_b64_tr_b16 v[216:217], v5 offset:8192
  ds_read_b64_tr_b16 v[218:219], v5 offset:8704
  s_add_u32 m0, s48, 114688
  s_add_u32 s35, s51, 3670016
  s_and_b32 s35, s35, 0x3fffff
  buffer_load_dwordx4 v2, s[8:11], s35 offen lds
  v_mfma_f32_32x32x16_bf16 v[32:47], v[228:231], v[108:111], v[32:47]
  ds_read_b64_tr_b16 v[220:221], v6 offset:8192
  ds_read_b64_tr_b16 v[222:223], v6 offset:8704
  buffer_load_dwordx4 v[156:159], v1, s[16:19], s61 offen offset:3072 sc1
  s_waitcnt lgkmcnt(8)
  v_mfma_f32_32x32x16_bf16 v[48:63], v[232:235], v[108:111], v[48:63]
  ds_read_b64_tr_b16 v[224:225], v5 offset:2048
  ds_read_b64_tr_b16 v[226:227], v5 offset:2560
  v_mfma_f32_32x32x16_bf16 v[64:79], v[236:239], v[108:111], v[64:79]
  ds_read_b64_tr_b16 v[228:229], v6 offset:2048
  ds_read_b64_tr_b16 v[230:231], v6 offset:2560
  s_waitcnt vmcnt(14)
  s_waitcnt lgkmcnt(8)
  v_mfma_f32_32x32x16_bf16 v[16:31], v[208:211], v[112:115], v[16:31]
  ds_read_b64_tr_b16 v[232:233], v5 offset:10240
  ds_read_b64_tr_b16 v[234:235], v5 offset:10752
  s_add_u32 s61, s60, 20480
  s_and_b32 s61, s61, 0x7fff
  s_add_u32 s61, s61, s42
  buffer_load_dwordx4 v[160:163], v1, s[16:19], s61 offen offset:0 sc1
  v_mfma_f32_32x32x16_bf16 v[32:47], v[212:215], v[112:115], v[32:47]
  ds_read_b64_tr_b16 v[236:237], v6 offset:10240
  ds_read_b64_tr_b16 v[238:239], v6 offset:10752
  s_waitcnt lgkmcnt(8)
  v_mfma_f32_32x32x16_bf16 v[48:63], v[216:219], v[112:115], v[48:63]
  ds_read_b64_tr_b16 v[208:209], v5 offset:4096
  ds_read_b64_tr_b16 v[210:211], v5 offset:4608
  s_add_u32 m0, s48, 122880
  s_add_u32 s35, s51, 3670144
  s_and_b32 s35, s35, 0x3fffff
  buffer_load_dwordx4 v2, s[8:11], s35 offen lds
  v_mfma_f32_32x32x16_bf16 v[64:79], v[220:223], v[112:115], v[64:79]
  ds_read_b64_tr_b16 v[212:213], v6 offset:4096
  ds_read_b64_tr_b16 v[214:215], v6 offset:4608
  buffer_load_dwordx4 v[164:167], v1, s[16:19], s61 offen offset:1024 sc1
  s_waitcnt lgkmcnt(8)
  v_mfma_f32_32x32x16_bf16 v[16:31], v[224:227], v[116:119], v[16:31]
  ds_read_b64_tr_b16 v[216:217], v5 offset:12288
  ds_read_b64_tr_b16 v[218:219], v5 offset:12800
  s_add_u32 s75, s7, 4096
  buffer_store_dwordx4 v[8:11], v1, s[12:15], s75 offen offset:3072 sc1
  v_mfma_f32_32x32x16_bf16 v[32:47], v[228:231], v[116:119], v[32:47]
  ds_read_b64_tr_b16 v[220:221], v6 offset:12288
  ds_read_b64_tr_b16 v[222:223], v6 offset:12800
  s_waitcnt lgkmcnt(8)
  v_mfma_f32_32x32x16_bf16 v[48:63], v[232:235], v[116:119], v[48:63]
  ds_read_b64_tr_b16 v[224:225], v5 offset:6144
  ds_read_b64_tr_b16 v[226:227], v5 offset:6656
  buffer_load_dwordx4 v[168:171], v1, s[16:19], s61 offen offset:2048 sc1
  v_mfma_f32_32x32x16_bf16 v[64:79], v[236:239], v[116:119], v[64:79]
  ds_read_b64_tr_b16 v[228:229], v6 offset:6144
  ds_read_b64_tr_b16 v[230:231], v6 offset:6656
  s_waitcnt lgkmcnt(8)
  v_mfma_f32_32x32x16_bf16 v[16:31], v[208:211], v[120:123], v[16:31]
  ds_read_b64_tr_b16 v[232:233], v5 offset:14336
  ds_read_b64_tr_b16 v[234:235], v5 offset:14848
  v_and_b32 v10, 31, v0
  v_lshrrev_b32 v11, 5, v0
  v_mfma_f32_32x32x16_bf16 v[32:47], v[212:215], v[120:123], v[32:47]
  ds_read_b64_tr_b16 v[236:237], v6 offset:14336
  ds_read_b64_tr_b16 v[238:239], v6 offset:14848
  buffer_load_dwordx4 v[172:175], v1, s[16:19], s61 offen offset:3072 sc1
  v_lshlrev_b32 v11, 2, v11
  s_waitcnt lgkmcnt(8)
  v_mfma_f32_32x32x16_bf16 v[48:63], v[216:219], v[120:123], v[48:63]
  s_waitcnt vmcnt(35)
  s_barrier
  ds_read_b64_tr_b16 v[208:209], v5 offset:16384
  ds_read_b64_tr_b16 v[210:211], v5 offset:16896
  v_sub_u32 v10, v10, v11
  v_mfma_f32_32x32x16_bf16 v[64:79], v[220:223], v[120:123], v[64:79]
  ds_read_b64_tr_b16 v[212:213], v6 offset:16384
  ds_read_b64_tr_b16 v[214:215], v6 offset:16896
  v_lshrrev_b32 v11, 3, v0
  s_waitcnt lgkmcnt(8)
  v_mfma_f32_32x32x16_bf16 v[16:31], v[224:227], v[124:127], v[16:31]
  ds_read_b64_tr_b16 v[216:217], v5 offset:24576
  ds_read_b64_tr_b16 v[218:219], v5 offset:25088
  s_add_u32 s61, s60, 24576
  s_and_b32 s61, s61, 0x7fff
  s_add_u32 s61, s61, s42
  buffer_load_dwordx4 v[176:179], v1, s[16:19], s61 offen offset:0 sc1
  v_and_b32 v9, 0x7f, v2
  v_lshl_add_u32 v9, v11, 10, v9
  v_mfma_f32_32x32x16_bf16 v[32:47], v[228:231], v[124:127], v[32:47]
  ds_read_b64_tr_b16 v[220:221], v6 offset:24576
  ds_read_b64_tr_b16 v[222:223], v6 offset:25088
  v_mov_b32 v11, 0xff800000
  s_waitcnt lgkmcnt(8)
  v_mfma_f32_32x32x16_bf16 v[48:63], v[232:235], v[124:127], v[48:63]
  ds_read_b64_tr_b16 v[224:225], v5 offset:18432
  ds_read_b64_tr_b16 v[226:227], v5 offset:18944
  s_load_dwordx2 s[64:65], s[0:1], 40
  v_mfma_f32_32x32x16_bf16 v[64:79], v[236:239], v[124:127], v[64:79]
  ds_read_b64_tr_b16 v[228:229], v6 offset:18432
  ds_read_b64_tr_b16 v[230:231], v6 offset:18944
  buffer_load_dwordx4 v[180:183], v1, s[16:19], s61 offen offset:1024 sc1
  s_load_dwordx4 s[80:83], s[0:1], 56
  s_waitcnt vmcnt(15)
  s_waitcnt lgkmcnt(8)
  v_mfma_f32_32x32x16_bf16 v[16:31], v[208:211], v[128:131], v[16:31]
  ds_read_b64_tr_b16 v[232:233], v5 offset:26624
  ds_read_b64_tr_b16 v[234:235], v5 offset:27136
  s_load_dwordx2 s[84:85], s[0:1], 72
  s_mov_b32 s66, 4194304
  v_mfma_f32_32x32x16_bf16 v[32:47], v[212:215], v[128:131], v[32:47]
  ds_read_b64_tr_b16 v[236:237], v6 offset:26624
  ds_read_b64_tr_b16 v[238:239], v6 offset:27136
  s_mov_b32 s67, 0x20000
  s_waitcnt lgkmcnt(8)
  v_mfma_f32_32x32x16_bf16 v[48:63], v[216:219], v[128:131], v[48:63]
  ds_read_b64_tr_b16 v[208:209], v5 offset:20480
  ds_read_b64_tr_b16 v[210:211], v5 offset:20992
  buffer_load_dwordx4 v[184:187], v1, s[16:19], s61 offen offset:2048 sc1
  s_lshr_b32 s62, s30, 2
  v_mfma_f32_32x32x16_bf16 v[64:79], v[220:223], v[128:131], v[64:79]
  ds_read_b64_tr_b16 v[212:213], v6 offset:20480
  ds_read_b64_tr_b16 v[214:215], v6 offset:20992
  s_lshl_b32 s62, s62, 19
  s_waitcnt lgkmcnt(8)
  v_mfma_f32_32x32x16_bf16 v[16:31], v[224:227], v[132:135], v[16:31]
  ds_read_b64_tr_b16 v[216:217], v5 offset:28672
  ds_read_b64_tr_b16 v[218:219], v5 offset:29184
  s_and_b32 s33, s30, 3
  s_lshl_b32 s33, s33, 8
  v_mfma_f32_32x32x16_bf16 v[32:47], v[228:231], v[132:135], v[32:47]
  ds_read_b64_tr_b16 v[220:221], v6 offset:28672
  ds_read_b64_tr_b16 v[222:223], v6 offset:29184
  buffer_load_dwordx4 v[188:191], v1, s[16:19], s61 offen offset:3072 sc1
  s_add_u32 s62, s62, s33
  s_waitcnt lgkmcnt(8)
  v_mfma_f32_32x32x16_bf16 v[48:63], v[232:235], v[132:135], v[48:63]
  ds_read_b64_tr_b16 v[224:225], v5 offset:22528
  ds_read_b64_tr_b16 v[226:227], v5 offset:23040
  s_lshl_b32 s33, s45, 15
  v_mfma_f32_32x32x16_bf16 v[64:79], v[236:239], v[132:135], v[64:79]
  ds_read_b64_tr_b16 v[228:229], v6 offset:22528
  ds_read_b64_tr_b16 v[230:231], v6 offset:23040
  s_add_u32 s62, s62, s33
  s_waitcnt lgkmcnt(8)
  v_mfma_f32_32x32x16_bf16 v[16:31], v[208:211], v[136:139], v[16:31]
  ds_read_b64_tr_b16 v[232:233], v5 offset:30720
  ds_read_b64_tr_b16 v[234:235], v5 offset:31232
  s_add_u32 s61, s60, 28672
  s_and_b32 s61, s61, 0x7fff
  s_add_u32 s61, s61, s42
  buffer_load_dwordx4 v[192:195], v1, s[16:19], s61 offen offset:0 sc1
  v_mov_b32 v7, 139264
  s_mov_b32 s41, 0x44800000
  v_mfma_f32_32x32x16_bf16 v[32:47], v[212:215], v[136:139], v[32:47]
  ds_read_b64_tr_b16 v[236:237], v6 offset:30720
  ds_read_b64_tr_b16 v[238:239], v6 offset:31232
  s_mov_b32 s51, 0x4e800000
  s_waitcnt lgkmcnt(8)
  v_mfma_f32_32x32x16_bf16 v[48:63], v[216:219], v[136:139], v[48:63]
  s_waitcnt vmcnt(33)
  s_barrier
  ds_read_b64_tr_b16 v[208:209], v5 offset:32768
  ds_read_b64_tr_b16 v[210:211], v5 offset:33280
  s_mov_b32 s50, 0
  v_mfma_f32_32x32x16_bf16 v[64:79], v[220:223], v[136:139], v[64:79]
  ds_read_b64_tr_b16 v[212:213], v6 offset:32768
  ds_read_b64_tr_b16 v[214:215], v6 offset:33280
  buffer_load_dwordx4 v[196:199], v1, s[16:19], s61 offen offset:1024 sc1
  s_mov_b32 s72, 0
  s_waitcnt lgkmcnt(8)
  v_mfma_f32_32x32x16_bf16 v[16:31], v[224:227], v[140:143], v[16:31]
  ds_read_b64_tr_b16 v[216:217], v5 offset:40960
  ds_read_b64_tr_b16 v[218:219], v5 offset:41472
  s_and_b32 s75, s30, 15
  s_lshl_b32 s75, s75, 2
  v_mfma_f32_32x32x16_bf16 v[32:47], v[228:231], v[140:143], v[32:47]
  ds_read_b64_tr_b16 v[220:221], v6 offset:40960
  ds_read_b64_tr_b16 v[222:223], v6 offset:41472
  s_add_u32 s75, s75, s45
  s_waitcnt lgkmcnt(8)
  v_mfma_f32_32x32x16_bf16 v[48:63], v[232:235], v[140:143], v[48:63]
  ds_read_b64_tr_b16 v[224:225], v5 offset:34816
  ds_read_b64_tr_b16 v[226:227], v5 offset:35328
  buffer_load_dwordx4 v[200:203], v1, s[16:19], s61 offen offset:2048 sc1
  s_mul_i32 s75, s75, 53248
  v_mfma_f32_32x32x16_bf16 v[64:79], v[236:239], v[140:143], v[64:79]
  ds_read_b64_tr_b16 v[228:229], v6 offset:34816
  ds_read_b64_tr_b16 v[230:231], v6 offset:35328
  s_sub_u32 s33, 7, s31
  s_waitcnt vmcnt(13)
  s_waitcnt lgkmcnt(8)
  v_mfma_f32_32x32x16_bf16 v[16:31], v[208:211], v[144:147], v[16:31]
  ds_read_b64_tr_b16 v[232:233], v5 offset:43008
  ds_read_b64_tr_b16 v[234:235], v5 offset:43520
  s_cmp_lt_u32 s30, 16
  s_cselect_b32 s33, s31, s33
  s_mul_i32 s33, s33, 3407872
  v_mfma_f32_32x32x16_bf16 v[32:47], v[212:215], v[144:147], v[32:47]
  ds_read_b64_tr_b16 v[236:237], v6 offset:43008
  ds_read_b64_tr_b16 v[238:239], v6 offset:43520
  buffer_load_dwordx4 v[204:207], v1, s[16:19], s61 offen offset:3072 sc1
  s_add_u32 s75, s75, s33
  s_waitcnt lgkmcnt(8)
  v_mfma_f32_32x32x16_bf16 v[48:63], v[216:219], v[144:147], v[48:63]
  ds_read_b64_tr_b16 v[208:209], v5 offset:36864
  ds_read_b64_tr_b16 v[210:211], v5 offset:37376
  s_add_u32 s75, s75, 67108864
  v_mfma_f32_32x32x16_bf16 v[64:79], v[220:223], v[144:147], v[64:79]
  ds_read_b64_tr_b16 v[212:213], v6 offset:36864
  ds_read_b64_tr_b16 v[214:215], v6 offset:37376
  s_add_u32 s68, s4, s75
  s_addc_u32 s69, s5, 0
  s_waitcnt lgkmcnt(8)
  v_mfma_f32_32x32x16_bf16 v[16:31], v[224:227], v[148:151], v[16:31]
  ds_read_b64_tr_b16 v[216:217], v5 offset:45056
  ds_read_b64_tr_b16 v[218:219], v5 offset:45568
  s_mov_b32 s70, 53248
  s_cmp_ge_u32 s31, 4
  s_cselect_b32 s75, 0, 0x10000000
  v_mfma_f32_32x32x16_bf16 v[32:47], v[228:231], v[148:151], v[32:47]
  ds_read_b64_tr_b16 v[220:221], v6 offset:45056
  ds_read_b64_tr_b16 v[222:223], v6 offset:45568
  s_sub_u32 s75, s75, 6144
  s_waitcnt lgkmcnt(8)
  v_mfma_f32_32x32x16_bf16 v[48:63], v[232:235], v[148:151], v[48:63]
  ds_read_b64_tr_b16 v[224:225], v5 offset:38912
  ds_read_b64_tr_b16 v[226:227], v5 offset:39424
  s_add_u32 s44, s30, 112
  s_lshl_b32 s44, s44, 7
  s_add_u32 s44, s44, s63
  v_mov_b32 v14, 1
  v_mov_b32 v244, -1
  v_mfma_f32_32x32x16_bf16 v[64:79], v[236:239], v[148:151], v[64:79]
  ds_read_b64_tr_b16 v[228:229], v6 offset:38912
  ds_read_b64_tr_b16 v[230:231], v6 offset:39424
  v_mov_b32 v245, -1
  s_waitcnt lgkmcnt(8)
  v_mfma_f32_32x32x16_bf16 v[16:31], v[208:211], v[152:155], v[16:31]
  ds_read_b64_tr_b16 v[232:233], v5 offset:47104
  ds_read_b64_tr_b16 v[234:235], v5 offset:47616
  v_mov_b32 v246, -1
  v_mov_b32 v247, -1
  v_mfma_f32_32x32x16_bf16 v[32:47], v[212:215], v[152:155], v[32:47]
  ds_read_b64_tr_b16 v[236:237], v6 offset:47104
  ds_read_b64_tr_b16 v[238:239], v6 offset:47616
  v_mov_b32 v248, 0
  s_waitcnt lgkmcnt(8)
  v_mfma_f32_32x32x16_bf16 v[48:63], v[216:219], v[152:155], v[48:63]
  s_waitcnt vmcnt(20)
  s_waitcnt vmcnt(10)
  s_barrier
  ds_read_b64_tr_b16 v[208:209], v240 offset:16384
  ds_read_b64_tr_b16 v[210:211], v240 offset:16896
  s_mov_b64 exec, 1
  buffer_atomic_add v14, v13, s[76:79], s44 offen sc1
  s_mov_b64 exec, -1
  v_mov_b32 v249, 1
  v_mfma_f32_32x32x16_bf16 v[64:79], v[220:223], v[152:155], v[64:79]
  ds_read_b64_tr_b16 v[212:213], v241 offset:16384
  ds_read_b64_tr_b16 v[214:215], v241 offset:16896
  s_lshr_b32 s74, s30, 2
  s_waitcnt lgkmcnt(8)
  v_mfma_f32_32x32x16_bf16 v[16:31], v[224:227], v[156:159], v[16:31]
  ds_read_b64_tr_b16 v[216:217], v240 offset:24576
  ds_read_b64_tr_b16 v[218:219], v240 offset:25088
  s_lshl_b32 s74, s74, 6
  s_add_u32 s74, s74, s32
  v_mfma_f32_32x32x16_bf16 v[32:47], v[228:231], v[156:159], v[32:47]
  ds_read_b64_tr_b16 v[220:221], v241 offset:24576
  ds_read_b64_tr_b16 v[222:223], v241 offset:25088
  s_add_u32 s74, s74, 256
  s_waitcnt lgkmcnt(8)
  v_mfma_f32_32x32x16_bf16 v[48:63], v[232:235], v[156:159], v[48:63]
  ds_read_b64_tr_b16 v[224:225], v240 offset:18432
  ds_read_b64_tr_b16 v[226:227], v240 offset:18944
  s_lshl_b32 s74, s74, 7
  v_mfma_f32_32x32x16_bf16 v[64:79], v[236:239], v[156:159], v[64:79]
  ds_read_b64_tr_b16 v[228:229], v241 offset:18432
  ds_read_b64_tr_b16 v[230:231], v241 offset:18944
  s_sub_u32 s43, s32, 1
  s_waitcnt vmcnt(9)
  s_waitcnt lgkmcnt(8)
  v_mfma_f32_32x32x16_bf16 v[16:31], v[208:211], v[160:163], v[16:31]
  ds_read_b64_tr_b16 v[232:233], v240 offset:26624
  ds_read_b64_tr_b16 v[234:235], v240 offset:27136
  s_lshr_b32 s43, s43, 1
  s_cmp_eq_u32 s32, 0
  s_cselect_b32 s43, 0, s43
  v_mfma_f32_32x32x16_bf16 v[32:47], v[212:215], v[160:163], v[32:47]
  ds_read_b64_tr_b16 v[236:237], v241 offset:26624
  ds_read_b64_tr_b16 v[238:239], v241 offset:27136
  s_add_u32 s20, s4, 33554432
  s_addc_u32 s21, s5, 0
  s_waitcnt lgkmcnt(8)
  v_mfma_f32_32x32x16_bf16 v[48:63], v[216:219], v[160:163], v[48:63]
  ds_read_b64_tr_b16 v[208:209], v240 offset:20480
  ds_read_b64_tr_b16 v[210:211], v240 offset:20992
  s_mov_b32 s22, 16777216
  v_mfma_f32_32x32x16_bf16 v[64:79], v[220:223], v[160:163], v[64:79]
  ds_read_b64_tr_b16 v[212:213], v241 offset:20480
  ds_read_b64_tr_b16 v[214:215], v241 offset:20992
  s_lshl_b32 s38, s45, 12
  s_waitcnt lgkmcnt(8)
  v_mfma_f32_32x32x16_bf16 v[16:31], v[224:227], v[164:167], v[16:31]
  ds_read_b64_tr_b16 v[216:217], v240 offset:28672
  ds_read_b64_tr_b16 v[218:219], v240 offset:29184
  s_add_u32 s39, s38, 532480
  s_mov_b32 s40, 0
  v_mfma_f32_32x32x16_bf16 v[32:47], v[228:231], v[164:167], v[32:47]
  ds_read_b64_tr_b16 v[220:221], v241 offset:28672
  ds_read_b64_tr_b16 v[222:223], v241 offset:29184
  s_add_u32 s38, s38, 65536
  s_waitcnt lgkmcnt(8)
  v_mfma_f32_32x32x16_bf16 v[48:63], v[232:235], v[164:167], v[48:63]
  ds_read_b64_tr_b16 v[224:225], v240 offset:22528
  ds_read_b64_tr_b16 v[226:227], v240 offset:23040
  s_add_u32 s39, s39, 32768
  v_mfma_f32_32x32x16_bf16 v[64:79], v[236:239], v[164:167], v[64:79]
  ds_read_b64_tr_b16 v[228:229], v241 offset:22528
  ds_read_b64_tr_b16 v[230:231], v241 offset:23040
  s_mov_b32 s40, 2
  s_waitcnt lgkmcnt(8)
  v_mfma_f32_32x32x16_bf16 v[16:31], v[208:211], v[168:171], v[16:31]
  ds_read_b64_tr_b16 v[232:233], v240 offset:30720
  ds_read_b64_tr_b16 v[234:235], v240 offset:31232
  v_mfma_f32_32x32x16_bf16 v[32:47], v[212:215], v[168:171], v[32:47]
  ds_read_b64_tr_b16 v[236:237], v241 offset:30720
  ds_read_b64_tr_b16 v[238:239], v241 offset:31232
  s_waitcnt lgkmcnt(8)
  v_mfma_f32_32x32x16_bf16 v[48:63], v[216:219], v[168:171], v[48:63]
  s_waitcnt vmcnt(31)
  s_barrier
  ds_read_b64_tr_b16 v[208:209], v240 offset:32768
  ds_read_b64_tr_b16 v[210:211], v240 offset:33280
  v_mfma_f32_32x32x16_bf16 v[64:79], v[220:223], v[168:171], v[64:79]
  ds_read_b64_tr_b16 v[212:213], v241 offset:32768
  ds_read_b64_tr_b16 v[214:215], v241 offset:33280
  ds_write_b32 v7, v13
  s_waitcnt lgkmcnt(9)
  v_mfma_f32_32x32x16_bf16 v[16:31], v[224:227], v[172:175], v[16:31]
  ds_read_b64_tr_b16 v[216:217], v240 offset:40960
  ds_read_b64_tr_b16 v[218:219], v240 offset:41472
  buffer_load_dword v14, v13, s[76:79], s44 offen offset:0 sc1
  v_mfma_f32_32x32x16_bf16 v[32:47], v[228:231], v[172:175], v[32:47]
  ds_read_b64_tr_b16 v[220:221], v241 offset:40960
  ds_read_b64_tr_b16 v[222:223], v241 offset:41472
  s_waitcnt lgkmcnt(9)
  v_mfma_f32_32x32x16_bf16 v[48:63], v[232:235], v[172:175], v[48:63]
  ds_read_b64_tr_b16 v[224:225], v240 offset:34816
  ds_read_b64_tr_b16 v[226:227], v240 offset:35328
  v_mfma_f32_32x32x16_bf16 v[64:79], v[236:239], v[172:175], v[64:79]
  ds_read_b64_tr_b16 v[228:229], v241 offset:34816
  ds_read_b64_tr_b16 v[230:231], v241 offset:35328
  s_waitcnt vmcnt(6)
  s_waitcnt lgkmcnt(9)
  v_mfma_f32_32x32x16_bf16 v[16:31], v[208:211], v[176:179], v[16:31]
  ds_read_b64_tr_b16 v[232:233], v240 offset:43008
  ds_read_b64_tr_b16 v[234:235], v240 offset:43520
  v_mfma_f32_32x32x16_bf16 v[32:47], v[212:215], v[176:179], v[32:47]
  ds_read_b64_tr_b16 v[236:237], v241 offset:43008
  ds_read_b64_tr_b16 v[238:239], v241 offset:43520
  s_waitcnt lgkmcnt(8)
  v_mfma_f32_32x32x16_bf16 v[48:63], v[216:219], v[176:179], v[48:63]
  ds_read_b64_tr_b16 v[208:209], v240 offset:36864
  ds_read_b64_tr_b16 v[210:211], v240 offset:37376
  v_mfma_f32_32x32x16_bf16 v[64:79], v[220:223], v[176:179], v[64:79]
  ds_read_b64_tr_b16 v[212:213], v241 offset:36864
  ds_read_b64_tr_b16 v[214:215], v241 offset:37376
  s_waitcnt lgkmcnt(8)
  v_mfma_f32_32x32x16_bf16 v[16:31], v[224:227], v[180:183], v[16:31]
  ds_read_b64_tr_b16 v[216:217], v240 offset:45056
  ds_read_b64_tr_b16 v[218:219], v240 offset:45568
  v_mfma_f32_32x32x16_bf16 v[32:47], v[228:231], v[180:183], v[32:47]
  ds_read_b64_tr_b16 v[220:221], v241 offset:45056
  ds_read_b64_tr_b16 v[222:223], v241 offset:45568
  s_waitcnt lgkmcnt(8)
  v_mfma_f32_32x32x16_bf16 v[48:63], v[232:235], v[180:183], v[48:63]
  ds_read_b64_tr_b16 v[224:225], v240 offset:38912
  ds_read_b64_tr_b16 v[226:227], v240 offset:39424
  v_mfma_f32_32x32x16_bf16 v[64:79], v[236:239], v[180:183], v[64:79]
  ds_read_b64_tr_b16 v[228:229], v241 offset:38912
  ds_read_b64_tr_b16 v[230:231], v241 offset:39424
  s_waitcnt lgkmcnt(8)
  v_mfma_f32_32x32x16_bf16 v[16:31], v[208:211], v[184:187], v[16:31]
  ds_read_b64_tr_b16 v[232:233], v240 offset:47104
  ds_read_b64_tr_b16 v[234:235], v240 offset:47616
  v_mfma_f32_32x32x16_bf16 v[32:47], v[212:215], v[184:187], v[32:47]
  ds_read_b64_tr_b16 v[236:237], v241 offset:47104
  ds_read_b64_tr_b16 v[238:239], v241 offset:47616
  s_waitcnt lgkmcnt(8)
  v_mfma_f32_32x32x16_bf16 v[48:63], v[216:219], v[184:187], v[48:63]
  s_waitcnt vmcnt(14)
  s_waitcnt vmcnt(0)
  v_readfirstlane_b32 s73, v14
  s_add_u32 s73, s73, s63
  s_cmp_lt_u32 s73, 8
  s_cbranch_scc1 u_spin_PK
u_go_PK:
  s_barrier
  ds_read_b64_tr_b16 v[208:209], v240 offset:49152
  ds_read_b64_tr_b16 v[210:211], v240 offset:49664
  s_add_u32 m0, s48, 131072
  s_add_u32 s35, s48, 524288
  buffer_load_dwordx4 v1, s[12:15], s35 offen sc1 lds
  s_lshl_b32 s61, s48, 1
  v_mfma_f32_32x32x16_bf16 v[64:79], v[220:223], v[184:187], v[64:79]
  ds_read_b64_tr_b16 v[212:213], v241 offset:49152
  ds_read_b64_tr_b16 v[214:215], v241 offset:49664
  s_add_u32 m0, s61, 0
  s_add_u32 s35, s61, 532480
  buffer_load_dwordx4 v1, s[12:15], s35 offen offset:0 sc1 lds
  s_waitcnt lgkmcnt(8)
  v_mfma_f32_32x32x16_bf16 v[16:31], v[224:227], v[188:191], v[16:31]
  ds_read_b64_tr_b16 v[216:217], v240 offset:51200
  ds_read_b64_tr_b16 v[218:219], v240 offset:51712
  v_and_b32 v4, 32, v0
  v_mfma_f32_32x32x16_bf16 v[32:47], v[228:231], v[188:191], v[32:47]
  ds_read_b64_tr_b16 v[220:221], v241 offset:51200
  ds_read_b64_tr_b16 v[222:223], v241 offset:51712
  v_lshlrev_b32 v4, 4, v4
  buffer_load_dwordx4 v1, s[12:15], s35 offen offset:1024 sc1 lds
  s_waitcnt lgkmcnt(8)
  v_mfma_f32_32x32x16_bf16 v[48:63], v[232:235], v[188:191], v[48:63]
  ds_read_b64_tr_b16 v[224:225], v240 offset:53248
  ds_read_b64_tr_b16 v[226:227], v240 offset:53760
  v_sub_u32 v3, v240, v4
  v_mfma_f32_32x32x16_bf16 v[64:79], v[236:239], v[188:191], v[64:79]
  ds_read_b64_tr_b16 v[228:229], v241 offset:53248
  ds_read_b64_tr_b16 v[230:231], v241 offset:53760
  s_and_b32 s73, s34, 2
  s_add_u32 m0, s61, 16384
  s_add_u32 s35, s61, 0
  buffer_load_dwordx4 v1, s[12:15], s35 offen offset:0 sc1 lds
  s_waitcnt lgkmcnt(8)
  v_mfma_f32_32x32x16_bf16 v[16:31], v[208:211], v[192:195], v[16:31]
  ds_read_b64_tr_b16 v[232:233], v240 offset:55296
  ds_read_b64_tr_b16 v[234:235], v240 offset:55808
  s_lshl_b32 s73, s73, 15
  v_mfma_f32_32x32x16_bf16 v[32:47], v[212:215], v[192:195], v[32:47]
  ds_read_b64_tr_b16 v[236:237], v241 offset:55296
  ds_read_b64_tr_b16 v[238:239], v241 offset:55808
  v_xor_b32 v5, s73, v3
  buffer_load_dwordx4 v1, s[12:15], s35 offen offset:1024 sc1 lds
  s_waitcnt lgkmcnt(8)
  v_mfma_f32_32x32x16_bf16 v[16:31], v[216:219], v[196:199], v[16:31]
  ds_read_b64_tr_b16 v[208:209], v240 offset:57344
  ds_read_b64_tr_b16 v[210:211], v240 offset:57856
  v_xor_b32 v3, 0x10000, v5
  s_add_u32 m0, s61, 32768
  s_add_u32 s35, s61, 548864
  buffer_load_dwordx4 v1, s[12:15], s35 offen offset:0 sc1 lds
  v_mfma_f32_32x32x16_bf16 v[32:47], v[220:223], v[196:199], v[32:47]
  ds_read_b64_tr_b16 v[212:213], v241 offset:57344
  ds_read_b64_tr_b16 v[214:215], v241 offset:57856
  v_xor_b32 v4, 64, v3
  s_waitcnt lgkmcnt(8)
  v_mfma_f32_32x32x16_bf16 v[16:31], v[224:227], v[200:203], v[16:31]
  ds_read_b64_tr_b16 v[216:217], v240 offset:59392
  ds_read_b64_tr_b16 v[218:219], v240 offset:59904
  v_xor_b32 v6, 64, v5
  buffer_load_dwordx4 v1, s[12:15], s35 offen offset:1024 sc1 lds
  v_mfma_f32_32x32x16_bf16 v[32:47], v[228:231], v[200:203], v[32:47]
  ds_read_b64_tr_b16 v[220:221], v241 offset:59392
  ds_read_b64_tr_b16 v[222:223], v241 offset:59904
  s_mov_b32 s73, 0
  s_waitcnt lgkmcnt(8)
  v_mfma_f32_32x32x16_bf16 v[16:31], v[232:235], v[204:207], v[16:31]
  ds_read_b64_tr_b16 v[224:225], v240 offset:61440
  ds_read_b64_tr_b16 v[226:227], v240 offset:61952
  s_add_u32 m0, s61, 49152
  s_add_u32 s35, s61, 16384
  buffer_load_dwordx4 v1, s[12:15], s35 offen offset:0 sc1 lds
  v_mfma_f32_32x32x16_bf16 v[32:47], v[236:239], v[204:207], v[32:47]
  ds_read_b64_tr_b16 v[228:229], v241 offset:61440
  ds_read_b64_tr_b16 v[230:231], v241 offset:61952
  s_waitcnt lgkmcnt(8)
  v_mfma_f32_32x32x16_bf16 v[48:63], v[208:211], v[192:195], v[48:63]
  ds_read_b64_tr_b16 v[232:233], v240 offset:63488
  ds_read_b64_tr_b16 v[234:235], v240 offset:64000
  buffer_load_dwordx4 v1, s[12:15], s35 offen offset:1024 sc1 lds
  v_mfma_f32_32x32x16_bf16 v[64:79], v[212:215], v[192:195], v[64:79]
  ds_read_b64_tr_b16 v[236:237], v241 offset:63488
  ds_read_b64_tr_b16 v[238:239], v241 offset:64000
  s_waitcnt lgkmcnt(8)
  v_mfma_f32_32x32x16_bf16 v[48:63], v[216:219], v[196:199], v[48:63]
  v_cvt_pk_bf16_f32 v80, v16, v17
  v_cvt_pk_bf16_f32 v81, v18, v19
  v_cvt_pk_bf16_f32 v82, v20, v21
  s_cmp_eq_u32 s29, 0
  s_cbranch_scc1 k2_nodma_1
  s_call_b64 s[46:47], k2_stage
k2_nodma_1:
  v_mfma_f32_32x32x16_bf16 v[64:79], v[220:223], v[196:199], v[64:79]
  v_cvt_pk_bf16_f32 v83, v22, v23
  v_cvt_pk_bf16_f32 v84, v24, v25
  v_cvt_pk_bf16_f32 v85, v26, v27
  s_waitcnt lgkmcnt(4)
  v_mfma_f32_32x32x16_bf16 v[48:63], v[224:227], v[200:203], v[48:63]
  v_cvt_pk_bf16_f32 v86, v28, v29
  v_cvt_pk_bf16_f32 v87, v30, v31
  v_mfma_f32_32x32x16_bf16 v[64:79], v[228:231], v[200:203], v[64:79]
  v_cvt_pk_bf16_f32 v88, v32, v33
  v_cvt_pk_bf16_f32 v89, v34, v35
  v_cvt_pk_bf16_f32 v90, v36, v37
  s_waitcnt lgkmcnt(0)
  v_mfma_f32_32x32x16_bf16 v[48:63], v[232:235], v[204:207], v[48:63]
  v_cvt_pk_bf16_f32 v91, v38, v39
  v_cvt_pk_bf16_f32 v92, v40, v41
  v_cvt_pk_bf16_f32 v93, v42, v43
  v_mfma_f32_32x32x16_bf16 v[64:79], v[236:239], v[204:207], v[64:79]
  v_cvt_pk_bf16_f32 v94, v44, v45
  v_cvt_pk_bf16_f32 v95, v46, v47
  s_waitcnt lgkmcnt(0)
  s_nop 4
  v_cvt_pk_bf16_f32 v96, v48, v49
  v_cvt_pk_bf16_f32 v97, v50, v51
  v_cvt_pk_bf16_f32 v98, v52, v53
  v_cvt_pk_bf16_f32 v99, v54, v55
  v_cvt_pk_bf16_f32 v100, v56, v57
  v_cvt_pk_bf16_f32 v101, v58, v59
  v_cvt_pk_bf16_f32 v102, v60, v61
  v_cvt_pk_bf16_f32 v103, v62, v63
  v_cvt_pk_bf16_f32 v104, v64, v65
  v_cvt_pk_bf16_f32 v105, v66, v67
  v_cvt_pk_bf16_f32 v106, v68, v69
  v_cvt_pk_bf16_f32 v107, v70, v71
  v_cvt_pk_bf16_f32 v108, v72, v73
  v_cvt_pk_bf16_f32 v109, v74, v75
  v_cvt_pk_bf16_f32 v110, v76, v77
  v_cvt_pk_bf16_f32 v111, v78, v79
  s_waitcnt vmcnt(12)
  s_cmp_lg_u32 s29, 0
  s_cbranch_scc1 k2_att0
  s_waitcnt vmcnt(4)
k2_att0:
  s_barrier
k2_att:
  v_add_u32 v8, 131072, v1
  ds_read_b128 v[176:179], v8 offset:0
  ds_read_b128 v[180:183], v8 offset:1024
  ds_read_b128 v[184:187], v8 offset:2048
  ds_read_b128 v[188:191], v8 offset:3072
  ds_read_b128 v[192:195], v8 offset:4096
  ds_read_b128 v[196:199], v8 offset:5120
  ds_read_b128 v[200:203], v8 offset:6144
  ds_read_b128 v[204:207], v8 offset:7168
  s_mov_b32 s33, s32
  s_mov_b64 s[60:61], 0
  v_mov_b32 v160, 0
  v_mov_b32 v161, 0
  v_mov_b32 v162, 0
  v_mov_b32 v163, 0
  v_mov_b32 v164, 0
  v_mov_b32 v165, 0
  v_mov_b32 v166, 0
  v_mov_b32 v167, 0
  v_mov_b32 v168, 0
  v_mov_b32 v169, 0
  v_mov_b32 v170, 0
  v_mov_b32 v171, 0
  v_mov_b32 v172, 0
  v_mov_b32 v173, 0
  v_mov_b32 v174, 0
  v_mov_b32 v175, 0
  s_cmp_lg_u32 s33, 0
  s_cbranch_scc1 k2_nomask0
  v_cmp_gt_i32 s[52:53], 0, v10
  v_cmp_gt_i32 s[54:55], 1, v10
  v_cmp_gt_i32 s[56:57], 2, v10
  v_cmp_gt_i32 s[58:59], 3, v10
  v_cndmask_b32 v160, v160, v11, s[52:53]
  v_cndmask_b32 v161, v161, v11, s[54:55]
  v_cndmask_b32 v162, v162, v11, s[56:57]
  v_cndmask_b32 v163, v163, v11, s[58:59]
  v_cmp_gt_i32 s[52:53], 8, v10
  v_cmp_gt_i32 s[54:55], 9, v10
  v_cmp_gt_i32 s[56:57], 10, v10
  v_cmp_gt_i32 s[58:59], 11, v10
  v_cndmask_b32 v164, v164, v11, s[52:53]
  v_cndmask_b32 v165, v165, v11, s[54:55]
  v_cndmask_b32 v166, v166, v11, s[56:57]
  v_cndmask_b32 v167, v167, v11, s[58:59]
  v_cmp_gt_i32 s[52:53], 16, v10
  v_cmp_gt_i32 s[54:55], 17, v10
  v_cmp_gt_i32 s[56:57], 18, v10
  v_cmp_gt_i32 s[58:59], 19, v10
  v_cndmask_b32 v168, v168, v11, s[52:53]
  v_cndmask_b32 v169, v169, v11, s[54:55]
  v_cndmask_b32 v170, v170, v11, s[56:57]
  v_cndmask_b32 v171, v171, v11, s[58:59]
  v_cmp_gt_i32 s[52:53], 24, v10
  v_cmp_gt_i32 s[54:55], 25, v10
  v_cmp_gt_i32 s[56:57], 26, v10
  v_cmp_gt_i32 s[58:59], 27, v10
  v_cndmask_b32 v172, v172, v11, s[52:53]
  v_cndmask_b32 v173, v173, v11, s[54:55]
  v_cndmask_b32 v174, v174, v11, s[56:57]
  v_cndmask_b32 v175, v175, v11, s[58:59]
k2_nomask0:
  s_nop 1
  s_waitcnt lgkmcnt(7)
  v_mfma_f32_32x32x16_bf16 v[112:127], v[176:179], v[80:83], v[160:175]
  v_mov_b32 v16, 0
  v_mov_b32 v17, 0
  v_mov_b32 v18, 0
  v_mov_b32 v19, 0
  v_mov_b32 v20, 0
  v_mov_b32 v21, 0
  v_mov_b32 v22, 0
  s_waitcnt lgkmcnt(6)
  v_mfma_f32_32x32x16_bf16 v[112:127], v[180:183], v[84:87], v[112:127]
  v_mov_b32 v23, 0
  v_mov_b32 v24, 0
  v_mov_b32 v25, 0
  v_mov_b32 v26, 0
  v_mov_b32 v27, 0
  v_mov_b32 v28, 0
  v_mov_b32 v29, 0
  s_waitcnt lgkmcnt(5)
  v_mfma_f32_32x32x16_bf16 v[112:127], v[184:187], v[88:91], v[112:127]
  v_mov_b32 v30, 0
  v_mov_b32 v31, 0
  v_mov_b32 v32, 0
  v_mov_b32 v33, 0
  v_mov_b32 v34, 0
  v_mov_b32 v35, 0
  v_mov_b32 v36, 0
  s_waitcnt lgkmcnt(4)
  v_mfma_f32_32x32x16_bf16 v[112:127], v[188:191], v[92:95], v[112:127]
  v_mov_b32 v37, 0
  v_mov_b32 v38, 0
  v_mov_b32 v39, 0
  v_mov_b32 v40, 0
  v_mov_b32 v41, 0
  v_mov_b32 v42, 0
  v_mov_b32 v43, 0
  s_waitcnt lgkmcnt(3)
  v_mfma_f32_32x32x16_bf16 v[112:127], v[192:195], v[96:99], v[112:127]
  v_mov_b32 v44, 0
  v_mov_b32 v45, 0
  v_mov_b32 v46, 0
  v_mov_b32 v47, 0
  v_mov_b32 v48, 0
  v_mov_b32 v49, 0
  v_mov_b32 v50, 0
  s_waitcnt lgkmcnt(2)
  v_mfma_f32_32x32x16_bf16 v[112:127], v[196:199], v[100:103], v[112:127]
  v_mov_b32 v51, 0
  v_mov_b32 v52, 0
  v_mov_b32 v53, 0
  v_mov_b32 v54, 0
  v_mov_b32 v55, 0
  v_mov_b32 v56, 0
  v_mov_b32 v57, 0
  s_waitcnt lgkmcnt(1)
  v_mfma_f32_32x32x16_bf16 v[112:127], v[200:203], v[104:107], v[112:127]
  v_mov_b32 v58, 0
  v_mov_b32 v59, 0
  v_mov_b32 v60, 0
  v_mov_b32 v61, 0
  v_mov_b32 v62, 0
  v_mov_b32 v63, 0
  v_mov_b32 v64, 0
  s_waitcnt lgkmcnt(0)
  v_mfma_f32_32x32x16_bf16 v[112:127], v[204:207], v[108:111], v[112:127]
  v_mov_b32 v65, 0
  v_mov_b32 v66, 0
  v_mov_b32 v67, 0
  v_mov_b32 v68, 0
  v_mov_b32 v69, 0
  v_mov_b32 v70, 0
  v_mov_b32 v71, 0
  v_mov_b32 v72, 0
  v_mov_b32 v73, 0
  v_mov_b32 v74, 0
  v_mov_b32 v75, 0
  v_mov_b32 v76, 0
  v_mov_b32 v77, 0
  v_mov_b32 v78, 0
  v_mov_b32 v79, 0
  v_mov_b32 v12, 0
  v_mov_b32 v8, v1
  s_mov_b32 s37, 0
  ds_read_b128 v[176:179], v8 offset:0
  ds_read_b128 v[180:183], v8 offset:1024
  ds_read_b128 v[184:187], v8 offset:2048
  ds_read_b128 v[188:191], v8 offset:3072
  ds_read_b128 v[192:195], v8 offset:4096
  ds_read_b128 v[196:199], v8 offset:5120
  v_max3_f32 v14, v112, v113, v114
  v_max3_f32 v14, v14, v115, v116
  v_max3_f32 v14, v14, v117, v118
  v_max3_f32 v14, v14, v119, v120
  v_max3_f32 v14, v14, v121, v122
  v_max3_f32 v14, v14, v123, v124
  v_max3_f32 v14, v14, v125, v126
  v_max_f32 v14, v14, v127
  v_mov_b32 v15, v14
  s_nop 1
  v_permlane32_swap_b32 v15, v14
  s_nop 0
  v_max_f32 v14, v14, v15
  v_sub_f32 v160, v160, v14
  v_sub_f32 v161, v161, v14
  v_sub_f32 v162, v162, v14
  v_sub_f32 v163, v163, v14
  v_sub_f32 v164, v164, v14
  v_sub_f32 v165, v165, v14
  v_sub_f32 v166, v166, v14
  v_sub_f32 v167, v167, v14
  v_sub_f32 v168, v168, v14
  v_sub_f32 v169, v169, v14
  v_sub_f32 v170, v170, v14
  v_sub_f32 v171, v171, v14
  v_sub_f32 v172, v172, v14
  v_sub_f32 v173, v173, v14
  v_sub_f32 v174, v174, v14
  v_sub_f32 v175, v175, v14
  v_sub_f32 v112, v112, v14
  v_sub_f32 v113, v113, v14
  v_sub_f32 v114, v114, v14
  v_sub_f32 v115, v115, v14
  v_sub_f32 v116, v116, v14
  v_sub_f32 v117, v117, v14
  v_sub_f32 v118, v118, v14
  v_sub_f32 v119, v119, v14
  v_sub_f32 v120, v120, v14
  v_sub_f32 v121, v121, v14
  v_sub_f32 v122, v122, v14
  v_sub_f32 v123, v123, v14
  v_sub_f32 v124, v124, v14
  v_sub_f32 v125, v125, v14
  v_sub_f32 v126, v126, v14
  v_sub_f32 v127, v127, v14
  v_exp_f32 v208, v112
  v_exp_f32 v209, v113
  v_exp_f32 v210, v114
  v_add_f32 v13, v208, v209
  v_cvt_pk_bf16_f32 v144, v208, v209
  v_exp_f32 v211, v115
  v_add_f32 v13, v13, v210
  s_cmp_eq_u32 s43, 0
  s_cbranch_scc1 k2_loop
  s_lshl_b32 s35, s43, 1
  s_sub_u32 s33, s33, s35
  s_mov_b32 s44, s43
  s_cmp_lg_u32 s29, 0
  s_cbranch_scc1 k2_fast1
  s_waitcnt vmcnt(0)
  s_branch k2_fast0
.p2align 6
k2_fast0:
  s_waitcnt lgkmcnt(4)
  v_mfma_f32_32x32x16_bf16 v[128:143], v[176:179], v[80:83], v[160:175]
  ds_read_b128 v[200:203], v8 offset:6144
  v_exp_f32 v208, v116
  v_add_f32 v13, v13, v211
  v_cvt_pk_bf16_f32 v145, v210, v211
  v_mfma_f32_32x32x16_bf16 v[128:143], v[180:183], v[84:87], v[128:143]
  ds_read_b128 v[204:207], v8 offset:7168
  v_exp_f32 v209, v117
  v_add_f32 v13, v13, v208
  s_waitcnt lgkmcnt(4)
  v_mfma_f32_32x32x16_bf16 v[128:143], v[184:187], v[88:91], v[128:143]
  ds_read_b128 v[176:179], v8 offset:16384
  v_exp_f32 v210, v118
  v_add_f32 v13, v13, v209
  v_cvt_pk_bf16_f32 v146, v208, v209
  v_mfma_f32_32x32x16_bf16 v[128:143], v[188:191], v[92:95], v[128:143]
  ds_read_b128 v[180:183], v8 offset:18432
  v_exp_f32 v211, v119
  v_add_f32 v13, v13, v210
  s_waitcnt lgkmcnt(4)
  v_mfma_f32_32x32x16_bf16 v[128:143], v[192:195], v[96:99], v[128:143]
  ds_read_b128 v[184:187], v8 offset:20480
  v_add_f32 v13, v13, v211
  v_cvt_pk_bf16_f32 v147, v210, v211
  v_add_f32 v12, v12, v13
  v_exp_f32 v208, v120
  v_mfma_f32_32x32x16_bf16 v[128:143], v[196:199], v[100:103], v[128:143]
  ds_read_b128 v[188:191], v8 offset:22528
  v_exp_f32 v209, v121
  s_add_u32 s37, s37, 32768
  s_and_b32 s37, s37, 0x1ffff
  s_waitcnt lgkmcnt(4)
  v_mfma_f32_32x32x16_bf16 v[128:143], v[200:203], v[104:107], v[128:143]
  ds_read_b128 v[192:195], v8 offset:17408
  v_exp_f32 v210, v122
  v_add_f32 v13, v208, v209
  v_cvt_pk_bf16_f32 v148, v208, v209
  v_mfma_f32_32x32x16_bf16 v[128:143], v[204:207], v[108:111], v[128:143]
  ds_read_b128 v[196:199], v8 offset:19456
  v_exp_f32 v211, v123
  v_add_f32 v13, v13, v210
  s_waitcnt lgkmcnt(4)
  v_mfma_f32_32x32x16_bf16 v[16:31], v[176:179], v[144:147], v[16:31]
  ds_read_b128 v[200:203], v8 offset:21504
  v_exp_f32 v208, v124
  v_add_f32 v13, v13, v211
  v_cvt_pk_bf16_f32 v149, v210, v211
  v_mfma_f32_32x32x16_bf16 v[32:47], v[180:183], v[144:147], v[32:47]
  ds_read_b128 v[204:207], v8 offset:23552
  v_exp_f32 v209, v125
  v_add_f32 v13, v13, v208
  s_waitcnt lgkmcnt(4)
  v_mfma_f32_32x32x16_bf16 v[48:63], v[184:187], v[144:147], v[48:63]
  ds_read_b128 v[176:179], v8 offset:8192
  v_exp_f32 v210, v126
  v_add_f32 v13, v13, v209
  v_cvt_pk_bf16_f32 v150, v208, v209
  v_exp_f32 v211, v127
  v_mfma_f32_32x32x16_bf16 v[64:79], v[188:191], v[144:147], v[64:79]
  ds_read_b128 v[180:183], v8 offset:9216
  v_add_f32 v13, v13, v210
  v_add_f32 v13, v13, v211
  v_cvt_pk_bf16_f32 v151, v210, v211
  v_add_f32 v12, v12, v13
  s_waitcnt lgkmcnt(4)
  v_mfma_f32_32x32x16_bf16 v[16:31], v[192:195], v[148:151], v[16:31]
  ds_read_b128 v[184:187], v8 offset:10240
  v_exp_f32 v208, v128
  v_mfma_f32_32x32x16_bf16 v[32:47], v[196:199], v[148:151], v[32:47]
  ds_read_b128 v[188:191], v8 offset:11264
  v_exp_f32 v209, v129
  s_waitcnt lgkmcnt(4)
  v_mfma_f32_32x32x16_bf16 v[48:63], v[200:203], v[148:151], v[48:63]
  ds_read_b128 v[192:195], v8 offset:12288
  v_exp_f32 v210, v130
  v_add_f32 v13, v208, v209
  v_cvt_pk_bf16_f32 v152, v208, v209
  v_mfma_f32_32x32x16_bf16 v[64:79], v[204:207], v[148:151], v[64:79]
  ds_read_b128 v[196:199], v8 offset:13312
  v_exp_f32 v211, v131
  v_add_f32 v13, v13, v210
  s_waitcnt lgkmcnt(4)
  v_mfma_f32_32x32x16_bf16 v[112:127], v[176:179], v[80:83], v[160:175]
  ds_read_b128 v[200:203], v8 offset:14336
  v_exp_f32 v208, v132
  v_add_f32 v13, v13, v211
  v_cvt_pk_bf16_f32 v153, v210, v211
  v_mfma_f32_32x32x16_bf16 v[112:127], v[180:183], v[84:87], v[112:127]
  ds_read_b128 v[204:207], v8 offset:15360
  v_exp_f32 v209, v133
  v_add_f32 v13, v13, v208
  s_waitcnt lgkmcnt(4)
  v_mfma_f32_32x32x16_bf16 v[112:127], v[184:187], v[88:91], v[112:127]
  ds_read_b128 v[176:179], v8 offset:24576
  v_exp_f32 v210, v134
  v_add_f32 v13, v13, v209
  v_cvt_pk_bf16_f32 v154, v208, v209
  v_mfma_f32_32x32x16_bf16 v[112:127], v[188:191], v[92:95], v[112:127]
  ds_read_b128 v[180:183], v8 offset:26624
  v_exp_f32 v211, v135
  v_add_f32 v13, v13, v210
  s_waitcnt lgkmcnt(4)
  v_mfma_f32_32x32x16_bf16 v[112:127], v[192:195], v[96:99], v[112:127]
  ds_read_b128 v[184:187], v8 offset:28672
  v_add_f32 v13, v13, v211
  v_cvt_pk_bf16_f32 v155, v210, v211
  v_add_f32 v12, v12, v13
  v_exp_f32 v208, v136
  v_mfma_f32_32x32x16_bf16 v[112:127], v[196:199], v[100:103], v[112:127]
  ds_read_b128 v[188:191], v8 offset:30720
  v_exp_f32 v209, v137
  v_exp_f32 v210, v138
  v_add_f32 v13, v208, v209
  v_cvt_pk_bf16_f32 v156, v208, v209
  s_waitcnt lgkmcnt(4)
  v_mfma_f32_32x32x16_bf16 v[112:127], v[200:203], v[104:107], v[112:127]
  ds_read_b128 v[192:195], v8 offset:25600
  v_exp_f32 v211, v139
  v_add_f32 v13, v13, v210
  v_mfma_f32_32x32x16_bf16 v[112:127], v[204:207], v[108:111], v[112:127]
  ds_read_b128 v[196:199], v8 offset:27648
  v_exp_f32 v208, v140
  v_add_f32 v13, v13, v211
  v_cvt_pk_bf16_f32 v157, v210, v211
  s_waitcnt lgkmcnt(4)
  v_mfma_f32_32x32x16_bf16 v[16:31], v[176:179], v[152:155], v[16:31]
  ds_read_b128 v[200:203], v8 offset:29696
  v_exp_f32 v209, v141
  v_add_f32 v13, v13, v208
  v_mfma_f32_32x32x16_bf16 v[32:47], v[180:183], v[152:155], v[32:47]
  ds_read_b128 v[204:207], v8 offset:31744
  v_exp_f32 v210, v142
  v_add_f32 v13, v13, v209
  v_cvt_pk_bf16_f32 v158, v208, v209
  v_add_u32 v8, s37, v1
  s_waitcnt lgkmcnt(4)
  v_mfma_f32_32x32x16_bf16 v[48:63], v[184:187], v[152:155], v[48:63]
  s_barrier
  ds_read_b128 v[176:179], v8 offset:0
  v_mfma_f32_32x32x16_bf16 v[64:79], v[188:191], v[152:155], v[64:79]
  ds_read_b128 v[180:183], v8 offset:1024
  v_exp_f32 v211, v143
  v_add_f32 v13, v13, v210
  s_nop 0
  v_add_f32 v13, v13, v211
  v_cvt_pk_bf16_f32 v159, v210, v211
  v_add_f32 v12, v12, v13
  s_waitcnt lgkmcnt(4)
  v_mfma_f32_32x32x16_bf16 v[16:31], v[192:195], v[156:159], v[16:31]
  ds_read_b128 v[184:187], v8 offset:2048
  v_exp_f32 v208, v112
  v_exp_f32 v209, v113
  v_mfma_f32_32x32x16_bf16 v[32:47], v[196:199], v[156:159], v[32:47]
  ds_read_b128 v[188:191], v8 offset:3072
  v_exp_f32 v210, v114
  v_add_f32 v13, v208, v209
  v_cvt_pk_bf16_f32 v144, v208, v209
  s_waitcnt lgkmcnt(4)
  v_mfma_f32_32x32x16_bf16 v[48:63], v[200:203], v[156:159], v[48:63]
  ds_read_b128 v[192:195], v8 offset:4096
  v_exp_f32 v211, v115
  v_add_f32 v13, v13, v210
  s_sub_u32 s44, s44, 1
  s_cmp_lg_u32 s44, 0
  v_mfma_f32_32x32x16_bf16 v[64:79], v[204:207], v[156:159], v[64:79]
  ds_read_b128 v[196:199], v8 offset:5120
  s_cbranch_scc1 k2_fast0
  v_cmp_nge_f32 s[60:61], s51, v12
  s_branch k2_loop
.p2align 6
k2_fast1:
  s_waitcnt lgkmcnt(4)
  v_mfma_f32_32x32x16_bf16 v[128:143], v[176:179], v[80:83], v[160:175]
  ds_read_b128 v[200:203], v8 offset:6144
  v_exp_f32 v208, v116
  v_add_f32 v13, v13, v211
  v_cvt_pk_bf16_f32 v145, v210, v211
  v_mfma_f32_32x32x16_bf16 v[128:143], v[180:183], v[84:87], v[128:143]
  ds_read_b128 v[204:207], v8 offset:7168
  v_exp_f32 v209, v117
  v_add_f32 v13, v13, v208
  s_waitcnt lgkmcnt(4)
  v_mfma_f32_32x32x16_bf16 v[128:143], v[184:187], v[88:91], v[128:143]
  ds_read_b128 v[176:179], v8 offset:16384
  v_exp_f32 v210, v118
  v_add_f32 v13, v13, v209
  v_cvt_pk_bf16_f32 v146, v208, v209
  v_mfma_f32_32x32x16_bf16 v[128:143], v[188:191], v[92:95], v[128:143]
  ds_read_b128 v[180:183], v8 offset:18432
  v_exp_f32 v211, v119
  v_add_f32 v13, v13, v210
  s_waitcnt lgkmcnt(4)
  v_mfma_f32_32x32x16_bf16 v[128:143], v[192:195], v[96:99], v[128:143]
  ds_read_b128 v[184:187], v8 offset:20480
  v_add_f32 v13, v13, v211
  v_cvt_pk_bf16_f32 v147, v210, v211
  v_add_f32 v12, v12, v13
  v_exp_f32 v208, v120
  v_mfma_f32_32x32x16_bf16 v[128:143], v[196:199], v[100:103], v[128:143]
  ds_read_b128 v[188:191], v8 offset:22528
  v_exp_f32 v209, v121
  s_add_u32 s37, s37, 32768
  s_and_b32 s37, s37, 0x1ffff
  s_waitcnt lgkmcnt(4)
  v_mfma_f32_32x32x16_bf16 v[128:143], v[200:203], v[104:107], v[128:143]
  ds_read_b128 v[192:195], v8 offset:17408
  v_exp_f32 v210, v122
  v_add_f32 v13, v208, v209
  v_cvt_pk_bf16_f32 v148, v208, v209
  v_mfma_f32_32x32x16_bf16 v[128:143], v[204:207], v[108:111], v[128:143]
  ds_read_b128 v[196:199], v8 offset:19456
  v_exp_f32 v211, v123
  v_add_f32 v13, v13, v210
  s_waitcnt lgkmcnt(4)
  v_mfma_f32_32x32x16_bf16 v[16:31], v[176:179], v[144:147], v[16:31]
  ds_read_b128 v[200:203], v8 offset:21504
  v_exp_f32 v208, v124
  v_add_f32 v13, v13, v211
  v_cvt_pk_bf16_f32 v149, v210, v211
  v_mfma_f32_32x32x16_bf16 v[32:47], v[180:183], v[144:147], v[32:47]
  ds_read_b128 v[204:207], v8 offset:23552
  v_exp_f32 v209, v125
  v_add_f32 v13, v13, v208
  s_waitcnt lgkmcnt(4)
  v_mfma_f32_32x32x16_bf16 v[48:63], v[184:187], v[144:147], v[48:63]
  ds_read_b128 v[176:179], v8 offset:8192
  v_exp_f32 v210, v126
  v_add_f32 v13, v13, v209
  v_cvt_pk_bf16_f32 v150, v208, v209
  v_exp_f32 v211, v127
  v_mfma_f32_32x32x16_bf16 v[64:79], v[188:191], v[144:147], v[64:79]
  ds_read_b128 v[180:183], v8 offset:9216
  v_add_f32 v13, v13, v210
  v_add_f32 v13, v13, v211
  v_cvt_pk_bf16_f32 v151, v210, v211
  v_add_f32 v12, v12, v13
  s_waitcnt lgkmcnt(4)
  v_mfma_f32_32x32x16_bf16 v[16:31], v[192:195], v[148:151], v[16:31]
  ds_read_b128 v[184:187], v8 offset:10240
  v_exp_f32 v208, v128
  v_mfma_f32_32x32x16_bf16 v[32:47], v[196:199], v[148:151], v[32:47]
  ds_read_b128 v[188:191], v8 offset:11264
  v_exp_f32 v209, v129
  s_waitcnt lgkmcnt(4)
  v_mfma_f32_32x32x16_bf16 v[48:63], v[200:203], v[148:151], v[48:63]
  ds_read_b128 v[192:195], v8 offset:12288
  v_exp_f32 v210, v130
  v_add_f32 v13, v208, v209
  v_cvt_pk_bf16_f32 v152, v208, v209
  v_mfma_f32_32x32x16_bf16 v[64:79], v[204:207], v[148:151], v[64:79]
  ds_read_b128 v[196:199], v8 offset:13312
  v_exp_f32 v211, v131
  v_add_f32 v13, v13, v210
  s_waitcnt lgkmcnt(4)
  v_mfma_f32_32x32x16_bf16 v[112:127], v[176:179], v[80:83], v[160:175]
  ds_read_b128 v[200:203], v8 offset:14336
  v_exp_f32 v208, v132
  v_add_f32 v13, v13, v211
  v_cvt_pk_bf16_f32 v153, v210, v211
  v_mfma_f32_32x32x16_bf16 v[112:127], v[180:183], v[84:87], v[112:127]
  ds_read_b128 v[204:207], v8 offset:15360
  v_exp_f32 v209, v133
  v_add_f32 v13, v13, v208
  s_waitcnt lgkmcnt(4)
  v_mfma_f32_32x32x16_bf16 v[112:127], v[184:187], v[88:91], v[112:127]
  ds_read_b128 v[176:179], v8 offset:24576
  v_exp_f32 v210, v134
  v_add_f32 v13, v13, v209
  v_cvt_pk_bf16_f32 v154, v208, v209
  v_mfma_f32_32x32x16_bf16 v[112:127], v[188:191], v[92:95], v[112:127]
  ds_read_b128 v[180:183], v8 offset:26624
  v_exp_f32 v211, v135
  v_add_f32 v13, v13, v210
  s_waitcnt lgkmcnt(4)
  v_mfma_f32_32x32x16_bf16 v[112:127], v[192:195], v[96:99], v[112:127]
  ds_read_b128 v[184:187], v8 offset:28672
  v_add_f32 v13, v13, v211
  v_cvt_pk_bf16_f32 v155, v210, v211
  v_add_f32 v12, v12, v13
  v_exp_f32 v208, v136
  v_mfma_f32_32x32x16_bf16 v[112:127], v[196:199], v[100:103], v[112:127]
  ds_read_b128 v[188:191], v8 offset:30720
  v_exp_f32 v209, v137
  v_exp_f32 v210, v138
  v_add_f32 v13, v208, v209
  v_cvt_pk_bf16_f32 v156, v208, v209
  s_waitcnt lgkmcnt(4)
  v_mfma_f32_32x32x16_bf16 v[112:127], v[200:203], v[104:107], v[112:127]
  ds_read_b128 v[192:195], v8 offset:25600
  v_exp_f32 v211, v139
  v_add_f32 v13, v13, v210
  v_mfma_f32_32x32x16_bf16 v[112:127], v[204:207], v[108:111], v[112:127]
  ds_read_b128 v[196:199], v8 offset:27648
  v_exp_f32 v208, v140
  v_add_f32 v13, v13, v211
  v_cvt_pk_bf16_f32 v157, v210, v211
  s_waitcnt lgkmcnt(4)
  v_mfma_f32_32x32x16_bf16 v[16:31], v[176:179], v[152:155], v[16:31]
  ds_read_b128 v[200:203], v8 offset:29696
  v_exp_f32 v209, v141
  v_add_f32 v13, v13, v208
  v_mfma_f32_32x32x16_bf16 v[32:47], v[180:183], v[152:155], v[32:47]
  ds_read_b128 v[204:207], v8 offset:31744
  v_exp_f32 v210, v142
  v_add_f32 v13, v13, v209
  v_cvt_pk_bf16_f32 v158, v208, v209
  v_add_u32 v8, s37, v1
  s_waitcnt lgkmcnt(4)
  v_mfma_f32_32x32x16_bf16 v[48:63], v[184:187], v[152:155], v[48:63]
  s_waitcnt vmcnt(8)
  s_barrier
  ds_read_b128 v[176:179], v8 offset:0
  s_cmp_le_u32 s75, 61440
  s_cbranch_scc1 k2_fl_2
k2_fl_2r:
  s_add_u32 s75, s75, 6144
  v_mfma_f32_32x32x16_bf16 v[64:79], v[188:191], v[152:155], v[64:79]
  ds_read_b128 v[180:183], v8 offset:1024
  v_exp_f32 v211, v143
  v_add_f32 v13, v13, v210
  s_nop 0
  v_add_f32 v13, v13, v211
  v_cvt_pk_bf16_f32 v159, v210, v211
  v_add_f32 v12, v12, v13
  s_mov_b32 m0, s38
  s_sub_u32 s36, s39, 532480
  buffer_load_dwordx4 v1, s[12:15], s39 offen offset:0 sc1 lds
  buffer_load_dwordx4 v1, s[12:15], s39 offen offset:1024 sc1 lds
  s_waitcnt lgkmcnt(4)
  v_mfma_f32_32x32x16_bf16 v[16:31], v[192:195], v[156:159], v[16:31]
  ds_read_b128 v[184:187], v8 offset:2048
  v_exp_f32 v208, v112
  v_exp_f32 v209, v113
  buffer_load_dwordx4 v1, s[12:15], s39 offen offset:2048 sc1 lds
  buffer_load_dwordx4 v1, s[12:15], s39 offen offset:3072 sc1 lds
  v_mfma_f32_32x32x16_bf16 v[32:47], v[196:199], v[156:159], v[32:47]
  ds_read_b128 v[188:191], v8 offset:3072
  v_exp_f32 v210, v114
  v_add_f32 v13, v208, v209
  v_cvt_pk_bf16_f32 v144, v208, v209
  s_add_u32 m0, s38, 16384
  s_add_u32 s40, s40, 1
  buffer_load_dwordx4 v1, s[12:15], s36 offen offset:0 sc1 lds
  buffer_load_dwordx4 v1, s[12:15], s36 offen offset:1024 sc1 lds
  s_waitcnt lgkmcnt(4)
  v_mfma_f32_32x32x16_bf16 v[48:63], v[200:203], v[156:159], v[48:63]
  ds_read_b128 v[192:195], v8 offset:4096
  v_exp_f32 v211, v115
  v_add_f32 v13, v13, v210
  buffer_load_dwordx4 v1, s[12:15], s36 offen offset:2048 sc1 lds
  buffer_load_dwordx4 v1, s[12:15], s36 offen offset:3072 sc1 lds
  s_add_u32 s39, s39, 16384
  s_add_u32 s38, s38, 32768
  s_and_b32 s38, s38, 0x1ffff
  s_sub_u32 s44, s44, 1
  s_cmp_lg_u32 s44, 0
  v_mfma_f32_32x32x16_bf16 v[64:79], v[204:207], v[156:159], v[64:79]
  ds_read_b128 v[196:199], v8 offset:5120
  s_cbranch_scc1 k2_fast1
  v_cmp_nge_f32 s[60:61], s51, v12
  s_branch k2_loop
k2_loop:
  s_cmp_lt_u32 s33, 2
  s_cbranch_scc1 k2_special0
k2_back0:
  s_sub_u32 s33, s33, 1
  s_waitcnt lgkmcnt(4)
  v_mfma_f32_32x32x16_bf16 v[128:143], v[176:179], v[80:83], v[160:175]
  ds_read_b128 v[200:203], v8 offset:6144
  v_exp_f32 v208, v116
  v_add_f32 v13, v13, v211
  v_cvt_pk_bf16_f32 v145, v210, v211
  v_mfma_f32_32x32x16_bf16 v[128:143], v[180:183], v[84:87], v[128:143]
  ds_read_b128 v[204:207], v8 offset:7168
  v_exp_f32 v209, v117
  v_add_f32 v13, v13, v208
  s_waitcnt lgkmcnt(4)
  v_mfma_f32_32x32x16_bf16 v[128:143], v[184:187], v[88:91], v[128:143]
  ds_read_b128 v[176:179], v8 offset:16384
  v_exp_f32 v210, v118
  v_add_f32 v13, v13, v209
  v_cvt_pk_bf16_f32 v146, v208, v209
  v_mfma_f32_32x32x16_bf16 v[128:143], v[188:191], v[92:95], v[128:143]
  ds_read_b128 v[180:183], v8 offset:18432
  v_exp_f32 v211, v119
  v_add_f32 v13, v13, v210
  s_waitcnt lgkmcnt(4)
  v_mfma_f32_32x32x16_bf16 v[128:143], v[192:195], v[96:99], v[128:143]
  v_add_f32 v13, v13, v211
  v_cvt_pk_bf16_f32 v147, v210, v211
  v_cmp_lt_f32 vcc, s41, v13
  s_cbranch_vccnz k2_slow_f00
k2_ret_f00:
  v_add_f32 v12, v12, v13
  ds_read_b128 v[184:187], v8 offset:20480
  v_exp_f32 v208, v120
  v_mfma_f32_32x32x16_bf16 v[128:143], v[196:199], v[100:103], v[128:143]
  ds_read_b128 v[188:191], v8 offset:22528
  v_exp_f32 v209, v121
  s_waitcnt lgkmcnt(4)
  v_mfma_f32_32x32x16_bf16 v[128:143], v[200:203], v[104:107], v[128:143]
  ds_read_b128 v[192:195], v8 offset:17408
  v_exp_f32 v210, v122
  v_add_f32 v13, v208, v209
  v_cvt_pk_bf16_f32 v148, v208, v209
  v_mfma_f32_32x32x16_bf16 v[128:143], v[204:207], v[108:111], v[128:143]
  ds_read_b128 v[196:199], v8 offset:19456
  v_exp_f32 v211, v123
  v_add_f32 v13, v13, v210
  s_waitcnt lgkmcnt(4)
  v_mfma_f32_32x32x16_bf16 v[16:31], v[176:179], v[144:147], v[16:31]
  ds_read_b128 v[200:203], v8 offset:21504
  v_exp_f32 v208, v124
  v_add_f32 v13, v13, v211
  v_cvt_pk_bf16_f32 v149, v210, v211
  v_mfma_f32_32x32x16_bf16 v[32:47], v[180:183], v[144:147], v[32:47]
  ds_read_b128 v[204:207], v8 offset:23552
  v_exp_f32 v209, v125
  v_add_f32 v13, v13, v208
  s_waitcnt lgkmcnt(4)
  v_mfma_f32_32x32x16_bf16 v[48:63], v[184:187], v[144:147], v[48:63]
  ds_read_b128 v[176:179], v8 offset:8192
  v_exp_f32 v210, v126
  v_add_f32 v13, v13, v209
  v_cvt_pk_bf16_f32 v150, v208, v209
  v_mfma_f32_32x32x16_bf16 v[64:79], v[188:191], v[144:147], v[64:79]
  ds_read_b128 v[180:183], v8 offset:9216
  v_exp_f32 v211, v127
  v_add_f32 v13, v13, v210
  s_nop 0
  v_add_f32 v13, v13, v211
  v_cvt_pk_bf16_f32 v151, v210, v211
  v_cmp_lt_f32 vcc, s41, v13
  s_cbranch_vccnz k2_slow_f01
k2_ret_f01:
  v_add_f32 v12, v12, v13
  s_waitcnt lgkmcnt(4)
  v_mfma_f32_32x32x16_bf16 v[16:31], v[192:195], v[148:151], v[16:31]
  ds_read_b128 v[184:187], v8 offset:10240
  v_exp_f32 v208, v128
  v_mfma_f32_32x32x16_bf16 v[32:47], v[196:199], v[148:151], v[32:47]
  ds_read_b128 v[188:191], v8 offset:11264
  v_exp_f32 v209, v129
  s_waitcnt lgkmcnt(4)
  v_mfma_f32_32x32x16_bf16 v[48:63], v[200:203], v[148:151], v[48:63]
  ds_read_b128 v[192:195], v8 offset:12288
  v_exp_f32 v210, v130
  v_add_f32 v13, v208, v209
  v_cvt_pk_bf16_f32 v152, v208, v209
  v_mfma_f32_32x32x16_bf16 v[64:79], v[204:207], v[148:151], v[64:79]
  ds_read_b128 v[196:199], v8 offset:13312
  v_exp_f32 v211, v131
  v_add_f32 v13, v13, v210
  s_cmp_lt_u32 s33, 2
  s_cbranch_scc1 k2_special1
k2_back1:
  s_sub_u32 s33, s33, 1
  s_waitcnt lgkmcnt(4)
  v_mfma_f32_32x32x16_bf16 v[112:127], v[176:179], v[80:83], v[160:175]
  ds_read_b128 v[200:203], v8 offset:14336
  v_exp_f32 v208, v132
  v_add_f32 v13, v13, v211
  v_cvt_pk_bf16_f32 v153, v210, v211
  v_mfma_f32_32x32x16_bf16 v[112:127], v[180:183], v[84:87], v[112:127]
  ds_read_b128 v[204:207], v8 offset:15360
  v_exp_f32 v209, v133
  v_add_f32 v13, v13, v208
  s_waitcnt lgkmcnt(4)
  v_mfma_f32_32x32x16_bf16 v[112:127], v[184:187], v[88:91], v[112:127]
  ds_read_b128 v[176:179], v8 offset:24576
  v_exp_f32 v210, v134
  v_add_f32 v13, v13, v209
  v_cvt_pk_bf16_f32 v154, v208, v209
  v_mfma_f32_32x32x16_bf16 v[112:127], v[188:191], v[92:95], v[112:127]
  ds_read_b128 v[180:183], v8 offset:26624
  v_exp_f32 v211, v135
  v_add_f32 v13, v13, v210
  s_waitcnt lgkmcnt(4)
  v_mfma_f32_32x32x16_bf16 v[112:127], v[192:195], v[96:99], v[112:127]
  v_add_f32 v13, v13, v211
  v_cvt_pk_bf16_f32 v155, v210, v211
  v_cmp_lt_f32 vcc, s41, v13
  s_cbranch_vccnz k2_slow_f10
k2_ret_f10:
  v_add_f32 v12, v12, v13
  ds_read_b128 v[184:187], v8 offset:28672
  v_exp_f32 v208, v136
  v_mfma_f32_32x32x16_bf16 v[112:127], v[196:199], v[100:103], v[112:127]
  ds_read_b128 v[188:191], v8 offset:30720
  v_exp_f32 v209, v137
  s_waitcnt lgkmcnt(4)
  v_mfma_f32_32x32x16_bf16 v[112:127], v[200:203], v[104:107], v[112:127]
  ds_read_b128 v[192:195], v8 offset:25600
  v_exp_f32 v210, v138
  v_add_f32 v13, v208, v209
  v_cvt_pk_bf16_f32 v156, v208, v209
  v_mfma_f32_32x32x16_bf16 v[112:127], v[204:207], v[108:111], v[112:127]
  ds_read_b128 v[196:199], v8 offset:27648
  v_exp_f32 v211, v139
  v_add_f32 v13, v13, v210
  s_waitcnt lgkmcnt(4)
  v_mfma_f32_32x32x16_bf16 v[16:31], v[176:179], v[152:155], v[16:31]
  ds_read_b128 v[200:203], v8 offset:29696
  v_exp_f32 v208, v140
  v_add_f32 v13, v13, v211
  v_cvt_pk_bf16_f32 v157, v210, v211
  v_mfma_f32_32x32x16_bf16 v[32:47], v[180:183], v[152:155], v[32:47]
  ds_read_b128 v[204:207], v8 offset:31744
  v_exp_f32 v209, v141
  v_add_f32 v13, v13, v208
  s_waitcnt lgkmcnt(4)
  v_mfma_f32_32x32x16_bf16 v[48:63], v[184:187], v[152:155], v[48:63]
  s_waitcnt vmcnt(8)
  s_barrier
  s_add_u32 s37, s37, 32768
  s_and_b32 s37, s37, 0x1ffff
  v_add_u32 v8, s37, v1
  ds_read_b128 v[176:179], v8 offset:0
  v_exp_f32 v210, v142
  v_add_f32 v13, v13, v209
  v_cvt_pk_bf16_f32 v158, v208, v209
  v_mfma_f32_32x32x16_bf16 v[64:79], v[188:191], v[152:155], v[64:79]
  ds_read_b128 v[180:183], v8 offset:1024
  v_exp_f32 v211, v143
  v_add_f32 v13, v13, v210
  s_nop 0
  v_add_f32 v13, v13, v211
  v_cvt_pk_bf16_f32 v159, v210, v211
  v_cmp_lt_f32 vcc, s41, v13
  s_cbranch_vccnz k2_slow_f11
k2_ret_f11:
  v_add_f32 v12, v12, v13
  s_waitcnt lgkmcnt(4)
  v_mfma_f32_32x32x16_bf16 v[16:31], v[192:195], v[156:159], v[16:31]
  ds_read_b128 v[184:187], v8 offset:2048
  v_exp_f32 v208, v112
  s_cmp_eq_u32 s29, 0
  s_cbranch_scc1 k2_nodma_3
  s_call_b64 s[46:47], k2_stage
k2_nodma_3:
  v_mfma_f32_32x32x16_bf16 v[32:47], v[196:199], v[156:159], v[32:47]
  ds_read_b128 v[188:191], v8 offset:3072
  v_exp_f32 v209, v113
  s_waitcnt lgkmcnt(4)
  v_mfma_f32_32x32x16_bf16 v[48:63], v[200:203], v[156:159], v[48:63]
  ds_read_b128 v[192:195], v8 offset:4096
  v_exp_f32 v210, v114
  v_add_f32 v13, v208, v209
  v_cvt_pk_bf16_f32 v144, v208, v209
  v_mfma_f32_32x32x16_bf16 v[64:79], v[204:207], v[156:159], v[64:79]
  ds_read_b128 v[196:199], v8 offset:5120
  v_exp_f32 v211, v115
  v_add_f32 v13, v13, v210
  s_branch k2_loop
k2_special0:
  s_cmp_eq_u32 s33, 0
  s_cbranch_scc1 k2_tail0
  v_cmp_gt_i32 s[52:53], 0, v10
  v_cmp_gt_i32 s[54:55], 1, v10
  v_cmp_gt_i32 s[56:57], 2, v10
  v_cmp_gt_i32 s[58:59], 3, v10
  v_cndmask_b32 v160, v160, v11, s[52:53]
  v_cndmask_b32 v161, v161, v11, s[54:55]
  v_cndmask_b32 v162, v162, v11, s[56:57]
  v_cndmask_b32 v163, v163, v11, s[58:59]
  v_cmp_gt_i32 s[52:53], 8, v10
  v_cmp_gt_i32 s[54:55], 9, v10
  v_cmp_gt_i32 s[56:57], 10, v10
  v_cmp_gt_i32 s[58:59], 11, v10
  v_cndmask_b32 v164, v164, v11, s[52:53]
  v_cndmask_b32 v165, v165, v11, s[54:55]
  v_cndmask_b32 v166, v166, v11, s[56:57]
  v_cndmask_b32 v167, v167, v11, s[58:59]
  v_cmp_gt_i32 s[52:53], 16, v10
  v_cmp_gt_i32 s[54:55], 17, v10
  v_cmp_gt_i32 s[56:57], 18, v10
  v_cmp_gt_i32 s[58:59], 19, v10
  v_cndmask_b32 v168, v168, v11, s[52:53]
  v_cndmask_b32 v169, v169, v11, s[54:55]
  v_cndmask_b32 v170, v170, v11, s[56:57]
  v_cndmask_b32 v171, v171, v11, s[58:59]
  v_cmp_gt_i32 s[52:53], 24, v10
  v_cmp_gt_i32 s[54:55], 25, v10
  v_cmp_gt_i32 s[56:57], 26, v10
  v_cmp_gt_i32 s[58:59], 27, v10
  v_cndmask_b32 v172, v172, v11, s[52:53]
  v_cndmask_b32 v173, v173, v11, s[54:55]
  v_cndmask_b32 v174, v174, v11, s[56:57]
  v_cndmask_b32 v175, v175, v11, s[58:59]
  s_nop 1
  s_branch k2_back0
k2_special1:
  s_cmp_eq_u32 s33, 0
  s_cbranch_scc1 k2_tail1
  v_cmp_gt_i32 s[52:53], 0, v10
  v_cmp_gt_i32 s[54:55], 1, v10
  v_cmp_gt_i32 s[56:57], 2, v10
  v_cmp_gt_i32 s[58:59], 3, v10
  v_cndmask_b32 v160, v160, v11, s[52:53]
  v_cndmask_b32 v161, v161, v11, s[54:55]
  v_cndmask_b32 v162, v162, v11, s[56:57]
  v_cndmask_b32 v163, v163, v11, s[58:59]
  v_cmp_gt_i32 s[52:53], 8, v10
  v_cmp_gt_i32 s[54:55], 9, v10
  v_cmp_gt_i32 s[56:57], 10, v10
  v_cmp_gt_i32 s[58:59], 11, v10
  v_cndmask_b32 v164, v164, v11, s[52:53]
  v_cndmask_b32 v165, v165, v11, s[54:55]
  v_cndmask_b32 v166, v166, v11, s[56:57]
  v_cndmask_b32 v167, v167, v11, s[58:59]
  v_cmp_gt_i32 s[52:53], 16, v10
  v_cmp_gt_i32 s[54:55], 17, v10
  v_cmp_gt_i32 s[56:57], 18, v10
  v_cmp_gt_i32 s[58:59], 19, v10
  v_cndmask_b32 v168, v168, v11, s[52:53]
  v_cndmask_b32 v169, v169, v11, s[54:55]
  v_cndmask_b32 v170, v170, v11, s[56:57]
  v_cndmask_b32 v171, v171, v11, s[58:59]
  v_cmp_gt_i32 s[52:53], 24, v10
  v_cmp_gt_i32 s[54:55], 25, v10
  v_cmp_gt_i32 s[56:57], 26, v10
  v_cmp_gt_i32 s[58:59], 27, v10
  v_cndmask_b32 v172, v172, v11, s[52:53]
  v_cndmask_b32 v173, v173, v11, s[54:55]
  v_cndmask_b32 v174, v174, v11, s[56:57]
  v_cndmask_b32 v175, v175, v11, s[58:59]
  s_nop 1
  s_branch k2_back1
k2_tail0:
  ds_read_b128 v[176:179], v8 offset:16384
  ds_read_b128 v[180:183], v8 offset:18432
  ds_read_b128 v[184:187], v8 offset:20480
  ds_read_b128 v[188:191], v8 offset:22528
  ds_read_b128 v[192:195], v8 offset:17408
  ds_read_b128 v[196:199], v8 offset:19456
  ds_read_b128 v[200:203], v8 offset:21504
  ds_read_b128 v[204:207], v8 offset:23552
  v_exp_f32 v208, v116
  v_add_f32 v13, v13, v211
  v_cvt_pk_bf16_f32 v145, v210, v211
  v_exp_f32 v209, v117
  v_add_f32 v13, v13, v208
  v_exp_f32 v210, v118
  v_add_f32 v13, v13, v209
  v_cvt_pk_bf16_f32 v146, v208, v209
  v_exp_f32 v211, v119
  v_add_f32 v13, v13, v210
  s_nop 0
  v_add_f32 v13, v13, v211
  v_cvt_pk_bf16_f32 v147, v210, v211
  v_cmp_lt_f32 vcc, s41, v13
  s_cbranch_vccnz k2_slow_t00
k2_ret_t00:
  v_add_f32 v12, v12, v13
  s_waitcnt lgkmcnt(7)
  v_mfma_f32_32x32x16_bf16 v[16:31], v[176:179], v[144:147], v[16:31]
  v_exp_f32 v208, v120
  v_exp_f32 v209, v121
  s_waitcnt lgkmcnt(6)
  v_mfma_f32_32x32x16_bf16 v[32:47], v[180:183], v[144:147], v[32:47]
  v_exp_f32 v210, v122
  v_add_f32 v13, v208, v209
  v_cvt_pk_bf16_f32 v148, v208, v209
  v_exp_f32 v211, v123
  v_add_f32 v13, v13, v210
  s_waitcnt lgkmcnt(5)
  v_mfma_f32_32x32x16_bf16 v[48:63], v[184:187], v[144:147], v[48:63]
  v_exp_f32 v208, v124
  v_add_f32 v13, v13, v211
  v_cvt_pk_bf16_f32 v149, v210, v211
  v_exp_f32 v209, v125
  v_add_f32 v13, v13, v208
  s_waitcnt lgkmcnt(4)
  v_mfma_f32_32x32x16_bf16 v[64:79], v[188:191], v[144:147], v[64:79]
  v_exp_f32 v210, v126
  v_add_f32 v13, v13, v209
  v_cvt_pk_bf16_f32 v150, v208, v209
  v_exp_f32 v211, v127
  v_add_f32 v13, v13, v210
  s_nop 0
  v_add_f32 v13, v13, v211
  v_cvt_pk_bf16_f32 v151, v210, v211
  v_cmp_lt_f32 vcc, s41, v13
  s_cbranch_vccnz k2_slow_t01
k2_ret_t01:
  v_add_f32 v12, v12, v13
  s_waitcnt lgkmcnt(3)
  v_mfma_f32_32x32x16_bf16 v[16:31], v[192:195], v[148:151], v[16:31]
  s_waitcnt lgkmcnt(2)
  v_mfma_f32_32x32x16_bf16 v[32:47], v[196:199], v[148:151], v[32:47]
  s_waitcnt lgkmcnt(1)
  v_mfma_f32_32x32x16_bf16 v[48:63], v[200:203], v[148:151], v[48:63]
  s_waitcnt lgkmcnt(0)
  v_mfma_f32_32x32x16_bf16 v[64:79], v[204:207], v[148:151], v[64:79]
  s_branch k2_done
k2_tail1:
  ds_read_b128 v[176:179], v8 offset:24576
  ds_read_b128 v[180:183], v8 offset:26624
  ds_read_b128 v[184:187], v8 offset:28672
  ds_read_b128 v[188:191], v8 offset:30720
  ds_read_b128 v[192:195], v8 offset:25600
  ds_read_b128 v[196:199], v8 offset:27648
  ds_read_b128 v[200:203], v8 offset:29696
  ds_read_b128 v[204:207], v8 offset:31744
  v_exp_f32 v208, v132
  v_add_f32 v13, v13, v211
  v_cvt_pk_bf16_f32 v153, v210, v211
  v_exp_f32 v209, v133
  v_add_f32 v13, v13, v208
  v_exp_f32 v210, v134
  v_add_f32 v13, v13, v209
  v_cvt_pk_bf16_f32 v154, v208, v209
  v_exp_f32 v211, v135
  v_add_f32 v13, v13, v210
  s_nop 0
  v_add_f32 v13, v13, v211
  v_cvt_pk_bf16_f32 v155, v210, v211
  v_cmp_lt_f32 vcc, s41, v13
  s_cbranch_vccnz k2_slow_t10
k2_ret_t10:
  v_add_f32 v12, v12, v13
  s_waitcnt lgkmcnt(7)
  v_mfma_f32_32x32x16_bf16 v[16:31], v[176:179], v[152:155], v[16:31]
  v_exp_f32 v208, v136
  v_exp_f32 v209, v137
  s_waitcnt lgkmcnt(6)
  v_mfma_f32_32x32x16_bf16 v[32:47], v[180:183], v[152:155], v[32:47]
  v_exp_f32 v210, v138
  v_add_f32 v13, v208, v209
  v_cvt_pk_bf16_f32 v156, v208, v209
  v_exp_f32 v211, v139
  v_add_f32 v13, v13, v210
  s_waitcnt lgkmcnt(5)
  v_mfma_f32_32x32x16_bf16 v[48:63], v[184:187], v[152:155], v[48:63]
  v_exp_f32 v208, v140
  v_add_f32 v13, v13, v211
  v_cvt_pk_bf16_f32 v157, v210, v211
  v_exp_f32 v209, v141
  v_add_f32 v13, v13, v208
  s_waitcnt lgkmcnt(4)
  v_mfma_f32_32x32x16_bf16 v[64:79], v[188:191], v[152:155], v[64:79]
  v_exp_f32 v210, v142
  v_add_f32 v13, v13, v209
  v_cvt_pk_bf16_f32 v158, v208, v209
  v_exp_f32 v211, v143
  v_add_f32 v13, v13, v210
  s_nop 0
  v_add_f32 v13, v13, v211
  v_cvt_pk_bf16_f32 v159, v210, v211
  v_cmp_lt_f32 vcc, s41, v13
  s_cbranch_vccnz k2_slow_t11
k2_ret_t11:
  v_add_f32 v12, v12, v13
  s_waitcnt lgkmcnt(3)
  v_mfma_f32_32x32x16_bf16 v[16:31], v[192:195], v[156:159], v[16:31]
  s_waitcnt lgkmcnt(2)
  v_mfma_f32_32x32x16_bf16 v[32:47], v[196:199], v[156:159], v[32:47]
  s_waitcnt lgkmcnt(1)
  v_mfma_f32_32x32x16_bf16 v[48:63], v[200:203], v[156:159], v[48:63]
  s_waitcnt lgkmcnt(0)
  v_mfma_f32_32x32x16_bf16 v[64:79], v[204:207], v[156:159], v[64:79]
k2_done:
  s_cmp_eq_u64 s[60:61], 0
  s_cbranch_scc1 k2_noflag
  v_mov_b32 v15, 1
  ds_write_b32 v7, v15
k2_noflag:
  s_lshr_b32 s44, s32, 1
  s_add_u32 s44, s44, 1
  s_cmp_ge_u32 s44, s34
  s_cbranch_scc1 k2_epi
  s_waitcnt vmcnt(8)
  s_barrier
  s_cmp_eq_u32 s29, 0
  s_cbranch_scc1 k2_nodma_4
  s_call_b64 s[46:47], k2_stage
k2_nodma_4:
k2_epi:
  v_mov_b32 v15, v12
  s_nop 1
  v_permlane32_swap_b32 v15, v12
  s_nop 0
  v_add_f32 v12, v12, v15
  v_rcp_f32 v12, v12
  s_lshl_b32 s35, s32, 18
  s_lshl_b32 s36, s30, 13
  s_add_u32 s42, s35, s36
  s_add_u32 s49, s42, 4096
  s_nop 2
  v_mul_f32 v16, v16, v12
  v_mul_f32 v17, v17, v12
  v_mul_f32 v18, v18, v12
  v_mul_f32 v19, v19, v12
  v_mul_f32 v20, v20, v12
  v_mul_f32 v21, v21, v12
  v_mul_f32 v22, v22, v12
  v_mul_f32 v23, v23, v12
  v_cvt_pk_bf16_f32 v176, v16, v17
  v_cvt_pk_bf16_f32 v177, v18, v19
  v_cvt_pk_bf16_f32 v178, v20, v21
  v_cvt_pk_bf16_f32 v179, v22, v23
  buffer_store_dwordx4 v[176:179], v1, s[20:23], s42 offen offset:0 sc1
  v_mul_f32 v24, v24, v12
  v_mul_f32 v25, v25, v12
  v_mul_f32 v26, v26, v12
  v_mul_f32 v27, v27, v12
  v_mul_f32 v28, v28, v12
  v_mul_f32 v29, v29, v12
  v_mul_f32 v30, v30, v12
  v_mul_f32 v31, v31, v12
  v_cvt_pk_bf16_f32 v180, v24, v25
  v_cvt_pk_bf16_f32 v181, v26, v27
  v_cvt_pk_bf16_f32 v182, v28, v29
  v_cvt_pk_bf16_f32 v183, v30, v31
  buffer_store_dwordx4 v[180:183], v1, s[20:23], s42 offen offset:1024 sc1
  v_mul_f32 v32, v32, v12
  v_mul_f32 v33, v33, v12
  v_mul_f32 v34, v34, v12
  v_mul_f32 v35, v35, v12
  v_mul_f32 v36, v36, v12
  v_mul_f32 v37, v37, v12
  v_mul_f32 v38, v38, v12
  v_mul_f32 v39, v39, v12
  v_cvt_pk_bf16_f32 v184, v32, v33
  v_cvt_pk_bf16_f32 v185, v34, v35
  v_cvt_pk_bf16_f32 v186, v36, v37
  v_cvt_pk_bf16_f32 v187, v38, v39
  buffer_store_dwordx4 v[184:187], v1, s[20:23], s42 offen offset:2048 sc1
  v_mul_f32 v40, v40, v12
  v_mul_f32 v41, v41, v12
  v_mul_f32 v42, v42, v12
  v_mul_f32 v43, v43, v12
  v_mul_f32 v44, v44, v12
  v_mul_f32 v45, v45, v12
  v_mul_f32 v46, v46, v12
  v_mul_f32 v47, v47, v12
  v_cvt_pk_bf16_f32 v188, v40, v41
  v_cvt_pk_bf16_f32 v189, v42, v43
  v_cvt_pk_bf16_f32 v190, v44, v45
  v_cvt_pk_bf16_f32 v191, v46, v47
  buffer_store_dwordx4 v[188:191], v1, s[20:23], s42 offen offset:3072 sc1
  v_mul_f32 v48, v48, v12
  v_mul_f32 v49, v49, v12
  v_mul_f32 v50, v50, v12
  v_mul_f32 v51, v51, v12
  v_mul_f32 v52, v52, v12
  v_mul_f32 v53, v53, v12
  v_mul_f32 v54, v54, v12
  v_mul_f32 v55, v55, v12
  v_cvt_pk_bf16_f32 v192, v48, v49
  v_cvt_pk_bf16_f32 v193, v50, v51
  v_cvt_pk_bf16_f32 v194, v52, v53
  v_cvt_pk_bf16_f32 v195, v54, v55
  buffer_store_dwordx4 v[192:195], v1, s[20:23], s49 offen offset:0 sc1
  v_mul_f32 v56, v56, v12
  v_mul_f32 v57, v57, v12
  v_mul_f32 v58, v58, v12
  v_mul_f32 v59, v59, v12
  v_mul_f32 v60, v60, v12
  v_mul_f32 v61, v61, v12
  v_mul_f32 v62, v62, v12
  v_mul_f32 v63, v63, v12
  v_cvt_pk_bf16_f32 v196, v56, v57
  v_cvt_pk_bf16_f32 v197, v58, v59
  v_cvt_pk_bf16_f32 v198, v60, v61
  v_cvt_pk_bf16_f32 v199, v62, v63
  buffer_store_dwordx4 v[196:199], v1, s[20:23], s49 offen offset:1024 sc1
  v_mul_f32 v64, v64, v12
  v_mul_f32 v65, v65, v12
  v_mul_f32 v66, v66, v12
  v_mul_f32 v67, v67, v12
  v_mul_f32 v68, v68, v12
  v_mul_f32 v69, v69, v12
  v_mul_f32 v70, v70, v12
  v_mul_f32 v71, v71, v12
  v_cvt_pk_bf16_f32 v200, v64, v65
  v_cvt_pk_bf16_f32 v201, v66, v67
  v_cvt_pk_bf16_f32 v202, v68, v69
  v_cvt_pk_bf16_f32 v203, v70, v71
  buffer_store_dwordx4 v[200:203], v1, s[20:23], s49 offen offset:2048 sc1
  v_mul_f32 v72, v72, v12
  v_mul_f32 v73, v73, v12
  v_mul_f32 v74, v74, v12
  v_mul_f32 v75, v75, v12
  v_mul_f32 v76, v76, v12
  v_mul_f32 v77, v77, v12
  v_mul_f32 v78, v78, v12
  v_mul_f32 v79, v79, v12
  v_cvt_pk_bf16_f32 v204, v72, v73
  v_cvt_pk_bf16_f32 v205, v74, v75
  v_cvt_pk_bf16_f32 v206, v76, v77
  v_cvt_pk_bf16_f32 v207, v78, v79
  buffer_store_dwordx4 v[204:207], v1, s[20:23], s49 offen offset:3072 sc1
  s_and_b32 s42, s42, 0xffff8000
  s_cmp_eq_u32 s29, 0
  s_cbranch_scc1 k2_nopf
  s_lshl_b32 s36, s45, 11
  s_add_u32 s24, s4, 61865984
  s_addc_u32 s25, s5, 0
  s_mov_b32 s26, 49152
  s_mov_b32 s27, 0x20000
  s_add_u32 s35, s36, 4096
  buffer_load_dwordx4 v[208:211], v1, s[24:27], s35 offen offset:0 sc1
  buffer_load_dwordx4 v[224:227], v1, s[24:27], s35 offen offset:1024 sc1
  s_add_u32 s35, s36, 16384
  buffer_load_dwordx4 v[212:215], v1, s[24:27], s35 offen offset:0 sc1
  buffer_load_dwordx4 v[228:231], v1, s[24:27], s35 offen offset:1024 sc1
  s_add_u32 s35, s36, 28672
  buffer_load_dwordx4 v[216:219], v1, s[24:27], s35 offen offset:0 sc1
  buffer_load_dwordx4 v[232:235], v1, s[24:27], s35 offen offset:1024 sc1
  s_add_u32 s35, s36, 40960
  buffer_load_dwordx4 v[220:223], v1, s[24:27], s35 offen offset:0 sc1
  buffer_load_dwordx4 v[236:239], v1, s[24:27], s35 offen offset:1024 sc1
  s_and_b32 s35, s2, 127
  s_lshl_b32 s35, s35, 2
  s_add_u32 s35, s35, s45
  s_lshl_b32 s36, s45, 10
  s_add_u32 m0, s36, 147456
  s_cmp_ge_u32 s2, 128
  s_cbranch_scc1 k2_pf2
  s_mul_i32 s35, s35, 9216
  buffer_load_dwordx4 v1, s[64:67], s35 offen offset:0 lds
  buffer_load_dwordx4 v1, s[64:67], s35 offen offset:1024 lds
  buffer_load_dwordx4 v1, s[64:67], s35 offen offset:2048 lds
  s_add_u32 s35, s35, 3072
  buffer_load_dwordx4 v1, s[64:67], s35 offen offset:0 lds
  buffer_load_dwordx4 v1, s[64:67], s35 offen offset:1024 lds
  buffer_load_dwordx4 v1, s[64:67], s35 offen offset:2048 lds
  s_add_u32 s35, s35, 3072
  buffer_load_dwordx4 v1, s[64:67], s35 offen offset:0 lds
  buffer_load_dwordx4 v1, s[64:67], s35 offen offset:1024 lds
  buffer_load_dwordx4 v1, s[64:67], s35 offen offset:2048 lds
  s_branch k2_nopf
k2_pf2:
  s_mul_i32 s35, s35, 3072
  s_mov_b32 s24, s80
  s_mov_b32 s25, s81
  s_mov_b32 s26, 1409024
  s_mov_b32 s27, 0x20000
  buffer_load_dwordx4 v1, s[24:27], s35 offen offset:0 lds
  buffer_load_dwordx4 v1, s[24:27], s35 offen offset:1024 lds
  buffer_load_dwordx4 v1, s[24:27], s35 offen offset:2048 lds
  s_mov_b32 s24, s82
  s_mov_b32 s25, s83
  s_mov_b32 s26, 1409024
  s_mov_b32 s27, 0x20000
  buffer_load_dwordx4 v1, s[24:27], s35 offen offset:0 lds
  buffer_load_dwordx4 v1, s[24:27], s35 offen offset:1024 lds
  buffer_load_dwordx4 v1, s[24:27], s35 offen offset:2048 lds
  s_mov_b32 s24, s84
  s_mov_b32 s25, s85
  s_mov_b32 s26, 1409024
  s_mov_b32 s27, 0x20000
  buffer_load_dwordx4 v1, s[24:27], s35 offen offset:0 lds
  buffer_load_dwordx4 v1, s[24:27], s35 offen offset:1024 lds
  buffer_load_dwordx4 v1, s[24:27], s35 offen offset:2048 lds
k2_nopf:
  s_cmp_eq_u32 s29, 0
  s_cbranch_scc1 k2_idle
  s_add_u32 s44, s44, 1
  s_cmp_ge_u32 s44, s34
  s_cbranch_scc1 k2_vote
  s_waitcnt vmcnt(33)
  s_barrier
  s_call_b64 s[46:47], k2_stage
  s_add_u32 s44, s44, 1
  s_cmp_ge_u32 s44, s34
  s_cbranch_scc1 k2_vote
  s_waitcnt vmcnt(25)
  s_barrier
  s_cmp_lg_u64 s[60:61], 0
  s_cbranch_scc1 k2_idle_c
  v_mov_b32 v13, 0
  v_mov_b32 v15, 1
  s_mov_b32 s72, 1
  s_mov_b64 exec, 1
  buffer_atomic_add v15, v13, s[76:79], s74 offen sc1
  s_mov_b64 exec, -1
  s_call_b64 s[46:47], k2_stage
  s_add_u32 s44, s44, 1
  s_cmp_ge_u32 s44, s34
  s_cbranch_scc1 k2_vote
  s_waitcnt vmcnt(8)
  s_barrier
k2_ip:
  buffer_load_dword v15, v13, s[76:79], s74 offen sc1
  s_call_b64 s[46:47], k2_stage
  s_add_u32 s44, s44, 1
  s_cmp_ge_u32 s44, s34
  s_cbranch_scc1 k2_vote
  s_waitcnt vmcnt(8)
  s_barrier
  v_readfirstlane_b32 s35, v15
  s_nop 0
  s_cmp_lt_u32 s35, 4
  s_cbranch_scc1 k2_ip
  s_add_u32 s33, s30, 1
  s_and_b32 s33, s33, 3
  s_lshl_b32 s33, s33, 13
  s_add_u32 s33, s33, s42
  buffer_load_dwordx4 v[112:115], v1, s[20:23], s33 offen offset:0 sc1
  buffer_load_dwordx4 v[116:119], v1, s[20:23], s33 offen offset:1024 sc1
  buffer_load_dwordx4 v[120:123], v1, s[20:23], s33 offen offset:2048 sc1
  buffer_load_dwordx4 v[124:127], v1, s[20:23], s33 offen offset:3072 sc1
  s_call_b64 s[46:47], k2_stage
  s_add_u32 s44, s44, 1
  s_cmp_ge_u32 s44, s34
  s_cbranch_scc1 k2_vote
  s_waitcnt vmcnt(8)
  s_barrier
  s_add_u32 s33, s33, 4096
  buffer_load_dwordx4 v[128:131], v1, s[20:23], s33 offen offset:0 sc1
  buffer_load_dwordx4 v[132:135], v1, s[20:23], s33 offen offset:1024 sc1
  buffer_load_dwordx4 v[136:139], v1, s[20:23], s33 offen offset:2048 sc1
  buffer_load_dwordx4 v[140:143], v1, s[20:23], s33 offen offset:3072 sc1
  s_call_b64 s[46:47], k2_stage
  s_add_u32 s44, s44, 1
  s_cmp_ge_u32 s44, s34
  s_cbranch_scc1 k2_vote
  s_waitcnt vmcnt(8)
  s_barrier
  s_add_u32 s33, s30, 2
  s_and_b32 s33, s33, 3
  s_lshl_b32 s33, s33, 13
  s_add_u32 s33, s33, s42
  buffer_load_dwordx4 v[144:147], v1, s[20:23], s33 offen offset:0 sc1
  buffer_load_dwordx4 v[148:151], v1, s[20:23], s33 offen offset:1024 sc1
  buffer_load_dwordx4 v[152:155], v1, s[20:23], s33 offen offset:2048 sc1
  buffer_load_dwordx4 v[156:159], v1, s[20:23], s33 offen offset:3072 sc1
  s_call_b64 s[46:47], k2_stage
  s_add_u32 s44, s44, 1
  s_cmp_ge_u32 s44, s34
  s_cbranch_scc1 k2_vote
  s_waitcnt vmcnt(8)
  s_barrier
  s_add_u32 s33, s33, 4096
  buffer_load_dwordx4 v[160:163], v1, s[20:23], s33 offen offset:0 sc1
  buffer_load_dwordx4 v[164:167], v1, s[20:23], s33 offen offset:1024 sc1
  buffer_load_dwordx4 v[168:171], v1, s[20:23], s33 offen offset:2048 sc1
  buffer_load_dwordx4 v[172:175], v1, s[20:23], s33 offen offset:3072 sc1
  s_call_b64 s[46:47], k2_stage
  s_add_u32 s44, s44, 1
  s_cmp_ge_u32 s44, s34
  s_cbranch_scc1 k2_vote
  s_waitcnt vmcnt(8)
  s_barrier
  s_add_u32 s33, s30, 3
  s_and_b32 s33, s33, 3
  s_lshl_b32 s33, s33, 13
  s_add_u32 s33, s33, s42
  buffer_load_dwordx4 v[80:83], v1, s[20:23], s33 offen offset:0 sc1
  buffer_load_dwordx4 v[84:87], v1, s[20:23], s33 offen offset:1024 sc1
  buffer_load_dwordx4 v[88:91], v1, s[20:23], s33 offen offset:2048 sc1
  buffer_load_dwordx4 v[92:95], v1, s[20:23], s33 offen offset:3072 sc1
  s_call_b64 s[46:47], k2_stage
  s_add_u32 s44, s44, 1
  s_cmp_ge_u32 s44, s34
  s_cbranch_scc1 k2_vote
  s_waitcnt vmcnt(8)
  s_barrier
  s_add_u32 s33, s33, 4096
  buffer_load_dwordx4 v[96:99], v1, s[20:23], s33 offen offset:0 sc1
  buffer_load_dwordx4 v[100:103], v1, s[20:23], s33 offen offset:1024 sc1
  buffer_load_dwordx4 v[104:107], v1, s[20:23], s33 offen offset:2048 sc1
  buffer_load_dwordx4 v[108:111], v1, s[20:23], s33 offen offset:3072 sc1
  s_mov_b32 s73, 1
k2_idle_c:
  s_call_b64 s[46:47], k2_stage
k2_idle:
  s_add_u32 s44, s44, 1
  s_cmp_ge_u32 s44, s34
  s_cbranch_scc1 k2_vote
  s_waitcnt vmcnt(8)
  s_barrier
  s_cmp_eq_u32 s29, 0
  s_cbranch_scc1 k2_nodma_5
  s_call_b64 s[46:47], k2_stage
k2_nodma_5:
  s_branch k2_idle
k2_vote:
  s_cmp_eq_u32 s29, 0
  s_cbranch_scc1 k2_vote0
  s_waitcnt vmcnt(0)
  s_cmp_lg_u32 s50, 0
  s_cbranch_scc1 k2_nofs
  s_cmp_eq_u32 s28, 4
  s_cbranch_scc1 k2_fspin
k2_fgo:
  s_cmp_eq_u32 s45, 2
  s_cselect_b32 s35, 1.0, 0
  s_lshl_b32 s36, s45, 11
  s_add_u32 s36, s36, 155648
  v_add_u32 v250, s36, v1
  v_add_f32 v208, v208, v212
  v_add_f32 v216, v216, v220
  v_add_f32 v209, v209, v213
  v_add_f32 v217, v217, v221
  v_add_f32 v210, v210, v214
  v_add_f32 v218, v218, v222
  v_add_f32 v211, v211, v215
  v_add_f32 v219, v219, v223
  v_add_f32 v208, v208, v216
  v_add_f32 v209, v209, v217
  v_add_f32 v210, v210, v218
  v_add_f32 v211, v211, v219
  v_cvt_pk_bf16_f32 v212, v208, v209
  v_cvt_pk_bf16_f32 v213, v210, v211
  v_lshlrev_b32 v208, 16, v212
  v_and_b32 v209, 0xffff0000, v212
  v_lshlrev_b32 v210, 16, v213
  v_and_b32 v211, 0xffff0000, v213
  v_add_f32 v208, s35, v208
  v_add_f32 v209, s35, v209
  v_add_f32 v210, s35, v210
  v_add_f32 v211, s35, v211
  v_cvt_pk_bf16_f32 v212, v208, v209
  v_cvt_pk_bf16_f32 v213, v210, v211
  v_lshlrev_b32 v208, 16, v212
  v_and_b32 v209, 0xffff0000, v212
  v_lshlrev_b32 v210, 16, v213
  v_and_b32 v211, 0xffff0000, v213
  ds_write_b128 v250, v[208:211] offset:0
  v_add_f32 v224, v224, v228
  v_add_f32 v232, v232, v236
  v_add_f32 v225, v225, v229
  v_add_f32 v233, v233, v237
  v_add_f32 v226, v226, v230
  v_add_f32 v234, v234, v238
  v_add_f32 v227, v227, v231
  v_add_f32 v235, v235, v239
  v_add_f32 v224, v224, v232
  v_add_f32 v225, v225, v233
  v_add_f32 v226, v226, v234
  v_add_f32 v227, v227, v235
  v_cvt_pk_bf16_f32 v228, v224, v225
  v_cvt_pk_bf16_f32 v229, v226, v227
  v_lshlrev_b32 v224, 16, v228
  v_and_b32 v225, 0xffff0000, v228
  v_lshlrev_b32 v226, 16, v229
  v_and_b32 v227, 0xffff0000, v229
  v_add_f32 v224, s35, v224
  v_add_f32 v225, s35, v225
  v_add_f32 v226, s35, v226
  v_add_f32 v227, s35, v227
  v_cvt_pk_bf16_f32 v228, v224, v225
  v_cvt_pk_bf16_f32 v229, v226, v227
  v_lshlrev_b32 v224, 16, v228
  v_and_b32 v225, 0xffff0000, v228
  v_lshlrev_b32 v226, 16, v229
  v_and_b32 v227, 0xffff0000, v229
  ds_write_b128 v250, v[224:227] offset:1024
k2_nofs:
  s_cmp_lg_u64 s[60:61], 0
  s_cbranch_scc1 k2_vote0
  s_cmp_lg_u32 s73, 0
  s_cbranch_scc1 k2_vote0
  s_cmp_lg_u32 s72, 0
  s_cbranch_scc1 k2_sigd0
  v_mov_b32 v13, 0
  v_mov_b32 v15, 1
  s_mov_b32 s72, 1
  s_mov_b64 exec, 1
  buffer_atomic_add v15, v13, s[76:79], s74 offen sc1
  s_mov_b64 exec, -1
k2_sigd0:
  v_mov_b32 v13, 0
  buffer_load_dword v15, v13, s[76:79], s74 offen sc1
  s_waitcnt vmcnt(0)
  v_readfirstlane_b32 s35, v15
  s_nop 0
  s_cmp_lt_u32 s35, 4
  s_cbranch_scc1 k2_vote0
  s_mov_b32 s73, 1
  s_add_u32 s33, s30, 1
  s_and_b32 s33, s33, 3
  s_lshl_b32 s33, s33, 13
  s_add_u32 s33, s33, s42
  buffer_load_dwordx4 v[112:115], v1, s[20:23], s33 offen offset:0 sc1
  buffer_load_dwordx4 v[116:119], v1, s[20:23], s33 offen offset:1024 sc1
  buffer_load_dwordx4 v[120:123], v1, s[20:23], s33 offen offset:2048 sc1
  buffer_load_dwordx4 v[124:127], v1, s[20:23], s33 offen offset:3072 sc1
  s_add_u32 s33, s33, 4096
  buffer_load_dwordx4 v[128:131], v1, s[20:23], s33 offen offset:0 sc1
  buffer_load_dwordx4 v[132:135], v1, s[20:23], s33 offen offset:1024 sc1
  buffer_load_dwordx4 v[136:139], v1, s[20:23], s33 offen offset:2048 sc1
  buffer_load_dwordx4 v[140:143], v1, s[20:23], s33 offen offset:3072 sc1
  s_add_u32 s33, s30, 2
  s_and_b32 s33, s33, 3
  s_lshl_b32 s33, s33, 13
  s_add_u32 s33, s33, s42
  buffer_load_dwordx4 v[144:147], v1, s[20:23], s33 offen offset:0 sc1
  buffer_load_dwordx4 v[148:151], v1, s[20:23], s33 offen offset:1024 sc1
  buffer_load_dwordx4 v[152:155], v1, s[20:23], s33 offen offset:2048 sc1
  buffer_load_dwordx4 v[156:159], v1, s[20:23], s33 offen offset:3072 sc1
  s_add_u32 s33, s33, 4096
  buffer_load_dwordx4 v[160:163], v1, s[20:23], s33 offen offset:0 sc1
  buffer_load_dwordx4 v[164:167], v1, s[20:23], s33 offen offset:1024 sc1
  buffer_load_dwordx4 v[168:171], v1, s[20:23], s33 offen offset:2048 sc1
  buffer_load_dwordx4 v[172:175], v1, s[20:23], s33 offen offset:3072 sc1
  s_add_u32 s33, s30, 3
  s_and_b32 s33, s33, 3
  s_lshl_b32 s33, s33, 13
  s_add_u32 s33, s33, s42
  buffer_load_dwordx4 v[80:83], v1, s[20:23], s33 offen offset:0 sc1
  buffer_load_dwordx4 v[84:87], v1, s[20:23], s33 offen offset:1024 sc1
  buffer_load_dwordx4 v[88:91], v1, s[20:23], s33 offen offset:2048 sc1
  buffer_load_dwordx4 v[92:95], v1, s[20:23], s33 offen offset:3072 sc1
  s_add_u32 s33, s33, 4096
  buffer_load_dwordx4 v[96:99], v1, s[20:23], s33 offen offset:0 sc1
  buffer_load_dwordx4 v[100:103], v1, s[20:23], s33 offen offset:1024 sc1
  buffer_load_dwordx4 v[104:107], v1, s[20:23], s33 offen offset:2048 sc1
  buffer_load_dwordx4 v[108:111], v1, s[20:23], s33 offen offset:3072 sc1
k2_vote0:
  s_waitcnt lgkmcnt(0)
  s_barrier
  s_cmp_lg_u32 s50, 0
  s_cbranch_scc1 k2_p3
  ds_read_b32 v15, v7
  s_waitcnt lgkmcnt(0)
  v_readfirstlane_b32 s35, v15
  s_cmp_eq_u32 s35, 0
  s_cbranch_scc1 k2_p3
  s_mov_b32 s50, 1
  s_mov_b32 s43, 0
  s_waitcnt vmcnt(0)
  s_lshl_b32 s38, s45, 12
  s_add_u32 s39, s38, 532480
  s_mov_b32 s40, 0
  s_cmp_eq_u32 s29, 0
  s_cbranch_scc1 k2_nodma_6
  s_call_b64 s[46:47], k2_stage
k2_nodma_6:
  s_cmp_eq_u32 s29, 0
  s_cbranch_scc1 k2_nodma_7
  s_call_b64 s[46:47], k2_stage
k2_nodma_7:
  s_waitcnt vmcnt(8)
  s_barrier
  s_cmp_eq_u32 s29, 0
  s_cbranch_scc1 k2_nodma_8
  s_call_b64 s[46:47], k2_stage
k2_nodma_8:
  s_mov_b32 s44, 0
  s_cmp_lg_u32 s72, 0
  s_cbranch_scc1 k2_idle
  s_branch k2_att
k2_p3:
  s_cmp_eq_u32 s29, 0
  s_cbranch_scc1 k2_p3g0
  ds_read_b64_tr_b16 v[208:209], v3 offset:0
  ds_read_b64_tr_b16 v[210:211], v3 offset:1024
  ds_read_b64_tr_b16 v[212:213], v3 offset:2048
  ds_read_b64_tr_b16 v[214:215], v3 offset:3072
  ds_read_b64_tr_b16 v[216:217], v3 offset:4096
  ds_read_b64_tr_b16 v[218:219], v3 offset:5120
  ds_read_b64_tr_b16 v[220:221], v3 offset:6144
  ds_read_b64_tr_b16 v[222:223], v3 offset:7168
  ds_read_b64_tr_b16 v[224:225], v3 offset:8192
  ds_read_b64_tr_b16 v[226:227], v3 offset:9216
  ds_read_b64_tr_b16 v[228:229], v3 offset:10240
  ds_read_b64_tr_b16 v[230:231], v3 offset:11264
  s_lshr_b32 s51, s30, 2
  s_lshl_b32 s51, s51, 18
  s_lshl_b32 s36, s28, 15
  s_add_u32 s51, s51, s36
  s_and_b32 s36, s30, 3
  s_lshl_b32 s36, s36, 13
  s_add_u32 s51, s51, s36
  s_mul_i32 s36, s31, 3407872
  s_add_u32 s36, s36, 67108864
  s_add_u32 s24, s4, s36
  s_addc_u32 s25, s5, 0
  s_mov_b32 s26, 3325952
  s_mov_b32 s27, 0x20000
  s_cmp_lg_u32 s73, 0
  s_cbranch_scc1 k2_pre1
  s_branch k2_cspin1
k2_cgo1:
  s_add_u32 s33, s30, 1
  s_and_b32 s33, s33, 3
  s_lshl_b32 s33, s33, 13
  s_add_u32 s33, s33, s42
  buffer_load_dwordx4 v[112:115], v1, s[20:23], s33 offen offset:0 sc1
  buffer_load_dwordx4 v[116:119], v1, s[20:23], s33 offen offset:1024 sc1
  buffer_load_dwordx4 v[120:123], v1, s[20:23], s33 offen offset:2048 sc1
  buffer_load_dwordx4 v[124:127], v1, s[20:23], s33 offen offset:3072 sc1
  s_add_u32 s33, s33, 4096
  buffer_load_dwordx4 v[128:131], v1, s[20:23], s33 offen offset:0 sc1
  buffer_load_dwordx4 v[132:135], v1, s[20:23], s33 offen offset:1024 sc1
  buffer_load_dwordx4 v[136:139], v1, s[20:23], s33 offen offset:2048 sc1
  buffer_load_dwordx4 v[140:143], v1, s[20:23], s33 offen offset:3072 sc1
  s_add_u32 s33, s30, 2
  s_and_b32 s33, s33, 3
  s_lshl_b32 s33, s33, 13
  s_add_u32 s33, s33, s42
  buffer_load_dwordx4 v[144:147], v1, s[20:23], s33 offen offset:0 sc1
  buffer_load_dwordx4 v[148:151], v1, s[20:23], s33 offen offset:1024 sc1
  buffer_load_dwordx4 v[152:155], v1, s[20:23], s33 offen offset:2048 sc1
  buffer_load_dwordx4 v[156:159], v1, s[20:23], s33 offen offset:3072 sc1
  s_add_u32 s33, s33, 4096
  buffer_load_dwordx4 v[160:163], v1, s[20:23], s33 offen offset:0 sc1
  buffer_load_dwordx4 v[164:167], v1, s[20:23], s33 offen offset:1024 sc1
  buffer_load_dwordx4 v[168:171], v1, s[20:23], s33 offen offset:2048 sc1
  buffer_load_dwordx4 v[172:175], v1, s[20:23], s33 offen offset:3072 sc1
  s_add_u32 s33, s30, 3
  s_and_b32 s33, s33, 3
  s_lshl_b32 s33, s33, 13
  s_add_u32 s33, s33, s42
  buffer_load_dwordx4 v[80:83], v1, s[20:23], s33 offen offset:0 sc1
  buffer_load_dwordx4 v[84:87], v1, s[20:23], s33 offen offset:1024 sc1
  buffer_load_dwordx4 v[88:91], v1, s[20:23], s33 offen offset:2048 sc1
  buffer_load_dwordx4 v[92:95], v1, s[20:23], s33 offen offset:3072 sc1
  s_add_u32 s33, s33, 4096
  buffer_load_dwordx4 v[96:99], v1, s[20:23], s33 offen offset:0 sc1
  buffer_load_dwordx4 v[100:103], v1, s[20:23], s33 offen offset:1024 sc1
  buffer_load_dwordx4 v[104:107], v1, s[20:23], s33 offen offset:2048 sc1
  buffer_load_dwordx4 v[108:111], v1, s[20:23], s33 offen offset:3072 sc1
k2_pre1:
  s_waitcnt lgkmcnt(8)
  v_mfma_f32_32x32x16_bf16 v[16:31], v[208:211], v[176:179], 0
  ds_read_b64_tr_b16 v[232:233], v3 offset:12288
  ds_read_b64_tr_b16 v[234:235], v3 offset:13312
  s_sub_u32 s36, s40, s34
  s_lshl_b32 s35, s36, 1
  s_add_u32 s35, s35, s30
  s_and_b32 s35, s35, 3
  s_lshl_b32 s35, s35, 17
  s_lshr_b32 s36, s36, 1
  s_lshl_b32 s36, s36, 7
  s_add_u32 s35, s35, s36
  s_add_u32 m0, s38, 0
  s_add_u32 s36, s35, s62
  buffer_load_dwordx4 v9, s[64:67], s36 offen lds
  v_mfma_f32_32x32x16_bf16 v[16:31], v[212:215], v[180:183], v[16:31]
  ds_read_b64_tr_b16 v[236:237], v3 offset:14336
  ds_read_b64_tr_b16 v[238:239], v3 offset:15360
  s_waitcnt lgkmcnt(8)
  v_mfma_f32_32x32x16_bf16 v[16:31], v[216:219], v[184:187], v[16:31]
  ds_read_b64_tr_b16 v[208:209], v3 offset:16384
  ds_read_b64_tr_b16 v[210:211], v3 offset:17408
  s_add_u32 m0, s38, 1024
  s_add_u32 s36, s35, s62
  s_add_u32 s36, s36, 8192
  buffer_load_dwordx4 v9, s[64:67], s36 offen lds
  v_mfma_f32_32x32x16_bf16 v[16:31], v[220:223], v[188:191], v[16:31]
  ds_read_b64_tr_b16 v[212:213], v3 offset:18432
  ds_read_b64_tr_b16 v[214:215], v3 offset:19456
  s_waitcnt lgkmcnt(8)
  v_mfma_f32_32x32x16_bf16 v[16:31], v[224:227], v[192:195], v[16:31]
  ds_read_b64_tr_b16 v[216:217], v3 offset:20480
  ds_read_b64_tr_b16 v[218:219], v3 offset:21504
  s_add_u32 m0, s38, 2048
  s_add_u32 s36, s35, s62
  s_add_u32 s36, s36, 16384
  buffer_load_dwordx4 v9, s[64:67], s36 offen lds
  v_mfma_f32_32x32x16_bf16 v[16:31], v[228:231], v[196:199], v[16:31]
  ds_read_b64_tr_b16 v[220:221], v3 offset:22528
  ds_read_b64_tr_b16 v[222:223], v3 offset:23552
  s_waitcnt lgkmcnt(8)
  v_mfma_f32_32x32x16_bf16 v[16:31], v[232:235], v[200:203], v[16:31]
  ds_read_b64_tr_b16 v[224:225], v3 offset:24576
  ds_read_b64_tr_b16 v[226:227], v3 offset:25600
  s_add_u32 m0, s38, 3072
  s_add_u32 s36, s35, s62
  s_add_u32 s36, s36, 24576
  buffer_load_dwordx4 v9, s[64:67], s36 offen lds
  v_mfma_f32_32x32x16_bf16 v[16:31], v[236:239], v[204:207], v[16:31]
  ds_read_b64_tr_b16 v[228:229], v3 offset:26624
  ds_read_b64_tr_b16 v[230:231], v3 offset:27648
  s_waitcnt vmcnt(27)
  s_waitcnt lgkmcnt(8)
  v_mfma_f32_32x32x16_bf16 v[16:31], v[208:211], v[112:115], v[16:31]
  ds_read_b64_tr_b16 v[232:233], v3 offset:28672
  ds_read_b64_tr_b16 v[234:235], v3 offset:29696
  s_add_u32 s35, s35, 0x20000
  s_and_b32 s35, s35, 0x7ffff
  s_add_u32 m0, s38, 16384
  s_add_u32 s36, s35, s62
  buffer_load_dwordx4 v9, s[64:67], s36 offen lds
  s_waitcnt vmcnt(27)
  v_mfma_f32_32x32x16_bf16 v[16:31], v[212:215], v[116:119], v[16:31]
  ds_read_b64_tr_b16 v[236:237], v3 offset:30720
  ds_read_b64_tr_b16 v[238:239], v3 offset:31744
  s_waitcnt vmcnt(26)
  s_waitcnt lgkmcnt(8)
  v_mfma_f32_32x32x16_bf16 v[16:31], v[216:219], v[120:123], v[16:31]
  ds_read_b64_tr_b16 v[208:209], v3 offset:32768
  ds_read_b64_tr_b16 v[210:211], v3 offset:33792
  s_add_u32 m0, s38, 17408
  s_add_u32 s36, s35, s62
  s_add_u32 s36, s36, 8192
  buffer_load_dwordx4 v9, s[64:67], s36 offen lds
  s_waitcnt vmcnt(26)
  v_mfma_f32_32x32x16_bf16 v[16:31], v[220:223], v[124:127], v[16:31]
  ds_read_b64_tr_b16 v[212:213], v3 offset:34816
  ds_read_b64_tr_b16 v[214:215], v3 offset:35840
  s_waitcnt vmcnt(25)
  s_waitcnt lgkmcnt(8)
  v_mfma_f32_32x32x16_bf16 v[16:31], v[224:227], v[128:131], v[16:31]
  ds_read_b64_tr_b16 v[216:217], v3 offset:36864
  ds_read_b64_tr_b16 v[218:219], v3 offset:37888
  s_add_u32 m0, s38, 18432
  s_add_u32 s36, s35, s62
  s_add_u32 s36, s36, 16384
  buffer_load_dwordx4 v9, s[64:67], s36 offen lds
  s_waitcnt vmcnt(25)
  v_mfma_f32_32x32x16_bf16 v[16:31], v[228:231], v[132:135], v[16:31]
  ds_read_b64_tr_b16 v[220:221], v3 offset:38912
  ds_read_b64_tr_b16 v[222:223], v3 offset:39936
  s_waitcnt vmcnt(24)
  s_waitcnt lgkmcnt(8)
  v_mfma_f32_32x32x16_bf16 v[16:31], v[232:235], v[136:139], v[16:31]
  ds_read_b64_tr_b16 v[224:225], v3 offset:40960
  ds_read_b64_tr_b16 v[226:227], v3 offset:41984
  s_add_u32 m0, s38, 19456
  s_add_u32 s36, s35, s62
  s_add_u32 s36, s36, 24576
  buffer_load_dwordx4 v9, s[64:67], s36 offen lds
  s_waitcnt vmcnt(24)
  v_mfma_f32_32x32x16_bf16 v[16:31], v[236:239], v[140:143], v[16:31]
  ds_read_b64_tr_b16 v[228:229], v3 offset:43008
  ds_read_b64_tr_b16 v[230:231], v3 offset:44032
  s_waitcnt vmcnt(23)
  s_waitcnt lgkmcnt(8)
  v_mfma_f32_32x32x16_bf16 v[16:31], v[208:211], v[144:147], v[16:31]
  ds_read_b64_tr_b16 v[232:233], v3 offset:45056
  ds_read_b64_tr_b16 v[234:235], v3 offset:46080
  s_add_u32 s40, s40, 1
  s_add_u32 s38, s38, 32768
  s_and_b32 s38, s38, 0x1ffff
  s_sub_u32 s36, s40, s34
  s_lshl_b32 s35, s36, 1
  s_add_u32 s35, s35, s30
  s_and_b32 s35, s35, 3
  s_lshl_b32 s35, s35, 17
  s_lshr_b32 s36, s36, 1
  s_lshl_b32 s36, s36, 7
  s_add_u32 s35, s35, s36
  s_add_u32 m0, s38, 0
  s_add_u32 s36, s35, s62
  buffer_load_dwordx4 v9, s[64:67], s36 offen lds
  s_waitcnt vmcnt(23)
  v_mfma_f32_32x32x16_bf16 v[16:31], v[212:215], v[148:151], v[16:31]
  ds_read_b64_tr_b16 v[236:237], v3 offset:47104
  ds_read_b64_tr_b16 v[238:239], v3 offset:48128
  s_waitcnt vmcnt(22)
  s_waitcnt lgkmcnt(8)
  v_mfma_f32_32x32x16_bf16 v[16:31], v[216:219], v[152:155], v[16:31]
  ds_read_b64_tr_b16 v[208:209], v3 offset:49152
  ds_read_b64_tr_b16 v[210:211], v3 offset:50176
  s_add_u32 m0, s38, 1024
  s_add_u32 s36, s35, s62
  s_add_u32 s36, s36, 8192
  buffer_load_dwordx4 v9, s[64:67], s36 offen lds
  s_waitcnt vmcnt(22)
  v_mfma_f32_32x32x16_bf16 v[16:31], v[220:223], v[156:159], v[16:31]
  ds_read_b64_tr_b16 v[212:213], v3 offset:51200
  ds_read_b64_tr_b16 v[214:215], v3 offset:52224
  s_waitcnt vmcnt(21)
  s_waitcnt lgkmcnt(8)
  v_mfma_f32_32x32x16_bf16 v[16:31], v[224:227], v[160:163], v[16:31]
  ds_read_b64_tr_b16 v[216:217], v3 offset:53248
  ds_read_b64_tr_b16 v[218:219], v3 offset:54272
  s_add_u32 m0, s38, 2048
  s_add_u32 s36, s35, s62
  s_add_u32 s36, s36, 16384
  buffer_load_dwordx4 v9, s[64:67], s36 offen lds
  s_waitcnt vmcnt(21)
  v_mfma_f32_32x32x16_bf16 v[16:31], v[228:231], v[164:167], v[16:31]
  ds_read_b64_tr_b16 v[220:221], v3 offset:55296
  ds_read_b64_tr_b16 v[222:223], v3 offset:56320
  s_waitcnt vmcnt(20)
  s_waitcnt lgkmcnt(8)
  v_mfma_f32_32x32x16_bf16 v[16:31], v[232:235], v[168:171], v[16:31]
  ds_read_b64_tr_b16 v[224:225], v3 offset:57344
  ds_read_b64_tr_b16 v[226:227], v3 offset:58368
  s_add_u32 m0, s38, 3072
  s_add_u32 s36, s35, s62
  s_add_u32 s36, s36, 24576
  buffer_load_dwordx4 v9, s[64:67], s36 offen lds
  s_waitcnt vmcnt(20)
  v_mfma_f32_32x32x16_bf16 v[16:31], v[236:239], v[172:175], v[16:31]
  ds_read_b64_tr_b16 v[228:229], v3 offset:59392
  ds_read_b64_tr_b16 v[230:231], v3 offset:60416
  s_waitcnt vmcnt(19)
  s_waitcnt lgkmcnt(8)
  v_mfma_f32_32x32x16_bf16 v[16:31], v[208:211], v[80:83], v[16:31]
  ds_read_b64_tr_b16 v[232:233], v3 offset:61440
  ds_read_b64_tr_b16 v[234:235], v3 offset:62464
  s_add_u32 s35, s35, 0x20000
  s_and_b32 s35, s35, 0x7ffff
  s_add_u32 m0, s38, 16384
  s_add_u32 s36, s35, s62
  buffer_load_dwordx4 v9, s[64:67], s36 offen lds
  s_waitcnt vmcnt(19)
  v_mfma_f32_32x32x16_bf16 v[16:31], v[212:215], v[84:87], v[16:31]
  ds_read_b64_tr_b16 v[236:237], v3 offset:63488
  ds_read_b64_tr_b16 v[238:239], v3 offset:64512
  s_waitcnt vmcnt(18)
  s_waitcnt lgkmcnt(8)
  v_mfma_f32_32x32x16_bf16 v[16:31], v[216:219], v[88:91], v[16:31]
  ds_read_b64_tr_b16 v[208:209], v4 offset:0
  ds_read_b64_tr_b16 v[210:211], v4 offset:1024
  s_add_u32 m0, s38, 17408
  s_add_u32 s36, s35, s62
  s_add_u32 s36, s36, 8192
  buffer_load_dwordx4 v9, s[64:67], s36 offen lds
  s_waitcnt vmcnt(18)
  v_mfma_f32_32x32x16_bf16 v[16:31], v[220:223], v[92:95], v[16:31]
  ds_read_b64_tr_b16 v[212:213], v4 offset:2048
  ds_read_b64_tr_b16 v[214:215], v4 offset:3072
  s_waitcnt vmcnt(17)
  s_waitcnt lgkmcnt(8)
  v_mfma_f32_32x32x16_bf16 v[16:31], v[224:227], v[96:99], v[16:31]
  ds_read_b64_tr_b16 v[216:217], v4 offset:4096
  ds_read_b64_tr_b16 v[218:219], v4 offset:5120
  s_add_u32 m0, s38, 18432
  s_add_u32 s36, s35, s62
  s_add_u32 s36, s36, 16384
  buffer_load_dwordx4 v9, s[64:67], s36 offen lds
  s_waitcnt vmcnt(17)
  v_mfma_f32_32x32x16_bf16 v[16:31], v[228:231], v[100:103], v[16:31]
  ds_read_b64_tr_b16 v[220:221], v4 offset:6144
  ds_read_b64_tr_b16 v[222:223], v4 offset:7168
  s_waitcnt vmcnt(16)
  s_waitcnt lgkmcnt(8)
  v_mfma_f32_32x32x16_bf16 v[16:31], v[232:235], v[104:107], v[16:31]
  ds_read_b64_tr_b16 v[224:225], v4 offset:8192
  ds_read_b64_tr_b16 v[226:227], v4 offset:9216
  s_add_u32 m0, s38, 19456
  s_add_u32 s36, s35, s62
  s_add_u32 s36, s36, 24576
  buffer_load_dwordx4 v9, s[64:67], s36 offen lds
  s_add_u32 s40, s40, 1
  s_add_u32 s38, s38, 32768
  s_and_b32 s38, s38, 0x1ffff
  s_waitcnt vmcnt(16)
  v_mfma_f32_32x32x16_bf16 v[16:31], v[236:239], v[108:111], v[16:31]
  ds_read_b64_tr_b16 v[228:229], v4 offset:10240
  ds_read_b64_tr_b16 v[230:231], v4 offset:11264
  s_waitcnt lgkmcnt(8)
  v_mfma_f32_32x32x16_bf16 v[32:47], v[208:211], v[176:179], 0
  ds_read_b64_tr_b16 v[232:233], v4 offset:12288
  ds_read_b64_tr_b16 v[234:235], v4 offset:13312
  v_mfma_f32_32x32x16_bf16 v[32:47], v[212:215], v[180:183], v[32:47]
  ds_read_b64_tr_b16 v[236:237], v4 offset:14336
  ds_read_b64_tr_b16 v[238:239], v4 offset:15360
  s_waitcnt lgkmcnt(8)
  v_mfma_f32_32x32x16_bf16 v[32:47], v[216:219], v[184:187], v[32:47]
  ds_read_b64_tr_b16 v[208:209], v4 offset:16384
  ds_read_b64_tr_b16 v[210:211], v4 offset:17408
  v_mfma_f32_32x32x16_bf16 v[32:47], v[220:223], v[188:191], v[32:47]
  ds_read_b64_tr_b16 v[212:213], v4 offset:18432
  ds_read_b64_tr_b16 v[214:215], v4 offset:19456
  v_cvt_pk_bf16_f32 v16, v16, v17
  s_waitcnt lgkmcnt(8)
  v_mfma_f32_32x32x16_bf16 v[32:47], v[224:227], v[192:195], v[32:47]
  ds_read_b64_tr_b16 v[216:217], v4 offset:20480
  ds_read_b64_tr_b16 v[218:219], v4 offset:21504
  v_cvt_pk_bf16_f32 v17, v18, v19
  v_mfma_f32_32x32x16_bf16 v[32:47], v[228:231], v[196:199], v[32:47]
  ds_read_b64_tr_b16 v[220:221], v4 offset:22528
  ds_read_b64_tr_b16 v[222:223], v4 offset:23552
  v_cvt_pk_bf16_f32 v18, v20, v21
  s_waitcnt lgkmcnt(8)
  v_mfma_f32_32x32x16_bf16 v[32:47], v[232:235], v[200:203], v[32:47]
  ds_read_b64_tr_b16 v[224:225], v4 offset:24576
  ds_read_b64_tr_b16 v[226:227], v4 offset:25600
  v_mfma_f32_32x32x16_bf16 v[32:47], v[236:239], v[204:207], v[32:47]
  ds_read_b64_tr_b16 v[228:229], v4 offset:26624
  ds_read_b64_tr_b16 v[230:231], v4 offset:27648
  v_cvt_pk_bf16_f32 v19, v22, v23
  s_waitcnt lgkmcnt(8)
  v_mfma_f32_32x32x16_bf16 v[32:47], v[208:211], v[112:115], v[32:47]
  ds_read_b64_tr_b16 v[232:233], v4 offset:28672
  ds_read_b64_tr_b16 v[234:235], v4 offset:29696
  buffer_store_dwordx4 v[16:19], v1, s[24:27], s51 offen offset:0 sc1
  v_mfma_f32_32x32x16_bf16 v[32:47], v[212:215], v[116:119], v[32:47]
  ds_read_b64_tr_b16 v[236:237], v4 offset:30720
  ds_read_b64_tr_b16 v[238:239], v4 offset:31744
  s_waitcnt lgkmcnt(8)
  v_mfma_f32_32x32x16_bf16 v[32:47], v[216:219], v[120:123], v[32:47]
  ds_read_b64_tr_b16 v[208:209], v4 offset:32768
  ds_read_b64_tr_b16 v[210:211], v4 offset:33792
  v_cvt_pk_bf16_f32 v24, v24, v25
  v_mfma_f32_32x32x16_bf16 v[32:47], v[220:223], v[124:127], v[32:47]
  ds_read_b64_tr_b16 v[212:213], v4 offset:34816
  ds_read_b64_tr_b16 v[214:215], v4 offset:35840
  v_cvt_pk_bf16_f32 v25, v26, v27
  s_waitcnt lgkmcnt(8)
  v_mfma_f32_32x32x16_bf16 v[32:47], v[224:227], v[128:131], v[32:47]
  ds_read_b64_tr_b16 v[216:217], v4 offset:36864
  ds_read_b64_tr_b16 v[218:219], v4 offset:37888
  v_cvt_pk_bf16_f32 v26, v28, v29
  v_mfma_f32_32x32x16_bf16 v[32:47], v[228:231], v[132:135], v[32:47]
  ds_read_b64_tr_b16 v[220:221], v4 offset:38912
  ds_read_b64_tr_b16 v[222:223], v4 offset:39936
  s_waitcnt lgkmcnt(8)
  v_mfma_f32_32x32x16_bf16 v[32:47], v[232:235], v[136:139], v[32:47]
  ds_read_b64_tr_b16 v[224:225], v4 offset:40960
  ds_read_b64_tr_b16 v[226:227], v4 offset:41984
  v_cvt_pk_bf16_f32 v27, v30, v31
  v_mfma_f32_32x32x16_bf16 v[32:47], v[236:239], v[140:143], v[32:47]
  ds_read_b64_tr_b16 v[228:229], v4 offset:43008
  ds_read_b64_tr_b16 v[230:231], v4 offset:44032
  buffer_store_dwordx4 v[24:27], v1, s[24:27], s51 offen offset:1024 sc1
  s_waitcnt lgkmcnt(8)
  v_mfma_f32_32x32x16_bf16 v[32:47], v[208:211], v[144:147], v[32:47]
  ds_read_b64_tr_b16 v[232:233], v4 offset:45056
  ds_read_b64_tr_b16 v[234:235], v4 offset:46080
  v_mfma_f32_32x32x16_bf16 v[32:47], v[212:215], v[148:151], v[32:47]
  ds_read_b64_tr_b16 v[236:237], v4 offset:47104
  ds_read_b64_tr_b16 v[238:239], v4 offset:48128
  s_waitcnt lgkmcnt(8)
  v_mfma_f32_32x32x16_bf16 v[32:47], v[216:219], v[152:155], v[32:47]
  ds_read_b64_tr_b16 v[208:209], v4 offset:49152
  ds_read_b64_tr_b16 v[210:211], v4 offset:50176
  v_mfma_f32_32x32x16_bf16 v[32:47], v[220:223], v[156:159], v[32:47]
  ds_read_b64_tr_b16 v[212:213], v4 offset:51200
  ds_read_b64_tr_b16 v[214:215], v4 offset:52224
  s_waitcnt lgkmcnt(8)
  v_mfma_f32_32x32x16_bf16 v[32:47], v[224:227], v[160:163], v[32:47]
  ds_read_b64_tr_b16 v[216:217], v4 offset:53248
  ds_read_b64_tr_b16 v[218:219], v4 offset:54272
  v_mfma_f32_32x32x16_bf16 v[32:47], v[228:231], v[164:167], v[32:47]
  ds_read_b64_tr_b16 v[220:221], v4 offset:55296
  ds_read_b64_tr_b16 v[222:223], v4 offset:56320
  s_waitcnt lgkmcnt(8)
  v_mfma_f32_32x32x16_bf16 v[32:47], v[232:235], v[168:171], v[32:47]
  ds_read_b64_tr_b16 v[224:225], v4 offset:57344
  ds_read_b64_tr_b16 v[226:227], v4 offset:58368
  v_mfma_f32_32x32x16_bf16 v[32:47], v[236:239], v[172:175], v[32:47]
  ds_read_b64_tr_b16 v[228:229], v4 offset:59392
  ds_read_b64_tr_b16 v[230:231], v4 offset:60416
  s_waitcnt lgkmcnt(8)
  v_mfma_f32_32x32x16_bf16 v[32:47], v[208:211], v[80:83], v[32:47]
  ds_read_b64_tr_b16 v[232:233], v4 offset:61440
  ds_read_b64_tr_b16 v[234:235], v4 offset:62464
  v_mfma_f32_32x32x16_bf16 v[32:47], v[212:215], v[84:87], v[32:47]
  ds_read_b64_tr_b16 v[236:237], v4 offset:63488
  ds_read_b64_tr_b16 v[238:239], v4 offset:64512
  s_waitcnt lgkmcnt(8)
  v_mfma_f32_32x32x16_bf16 v[32:47], v[216:219], v[88:91], v[32:47]
  s_waitcnt vmcnt(2)
  s_barrier
  ds_read_b64_tr_b16 v[208:209], v5 offset:0
  ds_read_b64_tr_b16 v[210:211], v5 offset:1024
  v_mfma_f32_32x32x16_bf16 v[32:47], v[220:223], v[92:95], v[32:47]
  ds_read_b64_tr_b16 v[212:213], v5 offset:2048
  ds_read_b64_tr_b16 v[214:215], v5 offset:3072
  s_waitcnt lgkmcnt(8)
  v_mfma_f32_32x32x16_bf16 v[32:47], v[224:227], v[96:99], v[32:47]
  ds_read_b64_tr_b16 v[216:217], v5 offset:4096
  ds_read_b64_tr_b16 v[218:219], v5 offset:5120
  v_mfma_f32_32x32x16_bf16 v[32:47], v[228:231], v[100:103], v[32:47]
  ds_read_b64_tr_b16 v[220:221], v5 offset:6144
  ds_read_b64_tr_b16 v[222:223], v5 offset:7168
  s_waitcnt lgkmcnt(8)
  v_mfma_f32_32x32x16_bf16 v[32:47], v[232:235], v[104:107], v[32:47]
  ds_read_b64_tr_b16 v[224:225], v5 offset:8192
  ds_read_b64_tr_b16 v[226:227], v5 offset:9216
  v_mfma_f32_32x32x16_bf16 v[32:47], v[236:239], v[108:111], v[32:47]
  ds_read_b64_tr_b16 v[228:229], v5 offset:10240
  ds_read_b64_tr_b16 v[230:231], v5 offset:11264
  s_waitcnt lgkmcnt(8)
  v_mfma_f32_32x32x16_bf16 v[48:63], v[208:211], v[176:179], 0
  ds_read_b64_tr_b16 v[232:233], v5 offset:12288
  ds_read_b64_tr_b16 v[234:235], v5 offset:13312
  v_mfma_f32_32x32x16_bf16 v[48:63], v[212:215], v[180:183], v[48:63]
  ds_read_b64_tr_b16 v[236:237], v5 offset:14336
  ds_read_b64_tr_b16 v[238:239], v5 offset:15360
  s_waitcnt lgkmcnt(8)
  v_mfma_f32_32x32x16_bf16 v[48:63], v[216:219], v[184:187], v[48:63]
  ds_read_b64_tr_b16 v[208:209], v5 offset:16384
  ds_read_b64_tr_b16 v[210:211], v5 offset:17408
  v_mfma_f32_32x32x16_bf16 v[48:63], v[220:223], v[188:191], v[48:63]
  ds_read_b64_tr_b16 v[212:213], v5 offset:18432
  ds_read_b64_tr_b16 v[214:215], v5 offset:19456
  v_cvt_pk_bf16_f32 v32, v32, v33
  s_waitcnt lgkmcnt(8)
  v_mfma_f32_32x32x16_bf16 v[48:63], v[224:227], v[192:195], v[48:63]
  ds_read_b64_tr_b16 v[216:217], v5 offset:20480
  ds_read_b64_tr_b16 v[218:219], v5 offset:21504
  v_cvt_pk_bf16_f32 v33, v34, v35
  v_mfma_f32_32x32x16_bf16 v[48:63], v[228:231], v[196:199], v[48:63]
  ds_read_b64_tr_b16 v[220:221], v5 offset:22528
  ds_read_b64_tr_b16 v[222:223], v5 offset:23552
  v_cvt_pk_bf16_f32 v34, v36, v37
  s_waitcnt lgkmcnt(8)
  v_mfma_f32_32x32x16_bf16 v[48:63], v[232:235], v[200:203], v[48:63]
  ds_read_b64_tr_b16 v[224:225], v5 offset:24576
  ds_read_b64_tr_b16 v[226:227], v5 offset:25600
  v_mfma_f32_32x32x16_bf16 v[48:63], v[236:239], v[204:207], v[48:63]
  ds_read_b64_tr_b16 v[228:229], v5 offset:26624
  ds_read_b64_tr_b16 v[230:231], v5 offset:27648
  v_cvt_pk_bf16_f32 v35, v38, v39
  s_waitcnt lgkmcnt(8)
  v_mfma_f32_32x32x16_bf16 v[48:63], v[208:211], v[112:115], v[48:63]
  ds_read_b64_tr_b16 v[232:233], v5 offset:28672
  ds_read_b64_tr_b16 v[234:235], v5 offset:29696
  buffer_store_dwordx4 v[32:35], v1, s[24:27], s51 offen offset:2048 sc1
  v_mfma_f32_32x32x16_bf16 v[48:63], v[212:215], v[116:119], v[48:63]
  ds_read_b64_tr_b16 v[236:237], v5 offset:30720
  ds_read_b64_tr_b16 v[238:239], v5 offset:31744
  s_waitcnt lgkmcnt(8)
  v_mfma_f32_32x32x16_bf16 v[48:63], v[216:219], v[120:123], v[48:63]
  ds_read_b64_tr_b16 v[208:209], v5 offset:32768
  ds_read_b64_tr_b16 v[210:211], v5 offset:33792
  v_cvt_pk_bf16_f32 v40, v40, v41
  v_mfma_f32_32x32x16_bf16 v[48:63], v[220:223], v[124:127], v[48:63]
  ds_read_b64_tr_b16 v[212:213], v5 offset:34816
  ds_read_b64_tr_b16 v[214:215], v5 offset:35840
  v_cvt_pk_bf16_f32 v41, v42, v43
  s_waitcnt lgkmcnt(8)
  v_mfma_f32_32x32x16_bf16 v[48:63], v[224:227], v[128:131], v[48:63]
  ds_read_b64_tr_b16 v[216:217], v5 offset:36864
  ds_read_b64_tr_b16 v[218:219], v5 offset:37888
  v_cvt_pk_bf16_f32 v42, v44, v45
  v_mfma_f32_32x32x16_bf16 v[48:63], v[228:231], v[132:135], v[48:63]
  ds_read_b64_tr_b16 v[220:221], v5 offset:38912
  ds_read_b64_tr_b16 v[222:223], v5 offset:39936
  s_waitcnt lgkmcnt(8)
  v_mfma_f32_32x32x16_bf16 v[48:63], v[232:235], v[136:139], v[48:63]
  ds_read_b64_tr_b16 v[224:225], v5 offset:40960
  ds_read_b64_tr_b16 v[226:227], v5 offset:41984
  v_cvt_pk_bf16_f32 v43, v46, v47
  v_mfma_f32_32x32x16_bf16 v[48:63], v[236:239], v[140:143], v[48:63]
  ds_read_b64_tr_b16 v[228:229], v5 offset:43008
  ds_read_b64_tr_b16 v[230:231], v5 offset:44032
  buffer_store_dwordx4 v[40:43], v1, s[24:27], s51 offen offset:3072 sc1
  s_waitcnt lgkmcnt(8)
  v_mfma_f32_32x32x16_bf16 v[48:63], v[208:211], v[144:147], v[48:63]
  ds_read_b64_tr_b16 v[232:233], v5 offset:45056
  ds_read_b64_tr_b16 v[234:235], v5 offset:46080
  v_mfma_f32_32x32x16_bf16 v[48:63], v[212:215], v[148:151], v[48:63]
  ds_read_b64_tr_b16 v[236:237], v5 offset:47104
  ds_read_b64_tr_b16 v[238:239], v5 offset:48128
  s_waitcnt lgkmcnt(8)
  v_mfma_f32_32x32x16_bf16 v[48:63], v[216:219], v[152:155], v[48:63]
  ds_read_b64_tr_b16 v[208:209], v5 offset:49152
  ds_read_b64_tr_b16 v[210:211], v5 offset:50176
  v_mfma_f32_32x32x16_bf16 v[48:63], v[220:223], v[156:159], v[48:63]
  ds_read_b64_tr_b16 v[212:213], v5 offset:51200
  ds_read_b64_tr_b16 v[214:215], v5 offset:52224
  s_waitcnt lgkmcnt(8)
  v_mfma_f32_32x32x16_bf16 v[48:63], v[224:227], v[160:163], v[48:63]
  ds_read_b64_tr_b16 v[216:217], v5 offset:53248
  ds_read_b64_tr_b16 v[218:219], v5 offset:54272
  v_mfma_f32_32x32x16_bf16 v[48:63], v[228:231], v[164:167], v[48:63]
  ds_read_b64_tr_b16 v[220:221], v5 offset:55296
  ds_read_b64_tr_b16 v[222:223], v5 offset:56320
  s_waitcnt lgkmcnt(8)
  v_mfma_f32_32x32x16_bf16 v[48:63], v[232:235], v[168:171], v[48:63]
  ds_read_b64_tr_b16 v[224:225], v5 offset:57344
  ds_read_b64_tr_b16 v[226:227], v5 offset:58368
  v_mfma_f32_32x32x16_bf16 v[48:63], v[236:239], v[172:175], v[48:63]
  ds_read_b64_tr_b16 v[228:229], v5 offset:59392
  ds_read_b64_tr_b16 v[230:231], v5 offset:60416
  s_waitcnt lgkmcnt(8)
  v_mfma_f32_32x32x16_bf16 v[48:63], v[208:211], v[80:83], v[48:63]
  ds_read_b64_tr_b16 v[232:233], v5 offset:61440
  ds_read_b64_tr_b16 v[234:235], v5 offset:62464
  v_mfma_f32_32x32x16_bf16 v[48:63], v[212:215], v[84:87], v[48:63]
  ds_read_b64_tr_b16 v[236:237], v5 offset:63488
  ds_read_b64_tr_b16 v[238:239], v5 offset:64512
  s_waitcnt lgkmcnt(8)
  v_mfma_f32_32x32x16_bf16 v[48:63], v[216:219], v[88:91], v[48:63]
  ds_read_b64_tr_b16 v[208:209], v6 offset:0
  ds_read_b64_tr_b16 v[210:211], v6 offset:1024
  v_mfma_f32_32x32x16_bf16 v[48:63], v[220:223], v[92:95], v[48:63]
  ds_read_b64_tr_b16 v[212:213], v6 offset:2048
  ds_read_b64_tr_b16 v[214:215], v6 offset:3072
  s_waitcnt lgkmcnt(8)
  v_mfma_f32_32x32x16_bf16 v[48:63], v[224:227], v[96:99], v[48:63]
  ds_read_b64_tr_b16 v[216:217], v6 offset:4096
  ds_read_b64_tr_b16 v[218:219], v6 offset:5120
  v_mfma_f32_32x32x16_bf16 v[48:63], v[228:231], v[100:103], v[48:63]
  ds_read_b64_tr_b16 v[220:221], v6 offset:6144
  ds_read_b64_tr_b16 v[222:223], v6 offset:7168
  s_waitcnt lgkmcnt(8)
  v_mfma_f32_32x32x16_bf16 v[48:63], v[232:235], v[104:107], v[48:63]
  ds_read_b64_tr_b16 v[224:225], v6 offset:8192
  ds_read_b64_tr_b16 v[226:227], v6 offset:9216
  v_mfma_f32_32x32x16_bf16 v[48:63], v[236:239], v[108:111], v[48:63]
  ds_read_b64_tr_b16 v[228:229], v6 offset:10240
  ds_read_b64_tr_b16 v[230:231], v6 offset:11264
  s_waitcnt lgkmcnt(8)
  v_mfma_f32_32x32x16_bf16 v[64:79], v[208:211], v[176:179], 0
  ds_read_b64_tr_b16 v[232:233], v6 offset:12288
  ds_read_b64_tr_b16 v[234:235], v6 offset:13312
  v_mfma_f32_32x32x16_bf16 v[64:79], v[212:215], v[180:183], v[64:79]
  ds_read_b64_tr_b16 v[236:237], v6 offset:14336
  ds_read_b64_tr_b16 v[238:239], v6 offset:15360
  s_waitcnt lgkmcnt(8)
  v_mfma_f32_32x32x16_bf16 v[64:79], v[216:219], v[184:187], v[64:79]
  ds_read_b64_tr_b16 v[208:209], v6 offset:16384
  ds_read_b64_tr_b16 v[210:211], v6 offset:17408
  v_mfma_f32_32x32x16_bf16 v[64:79], v[220:223], v[188:191], v[64:79]
  ds_read_b64_tr_b16 v[212:213], v6 offset:18432
  ds_read_b64_tr_b16 v[214:215], v6 offset:19456
  v_cvt_pk_bf16_f32 v48, v48, v49
  s_waitcnt lgkmcnt(8)
  v_mfma_f32_32x32x16_bf16 v[64:79], v[224:227], v[192:195], v[64:79]
  ds_read_b64_tr_b16 v[216:217], v6 offset:20480
  ds_read_b64_tr_b16 v[218:219], v6 offset:21504
  v_cvt_pk_bf16_f32 v49, v50, v51
  v_mfma_f32_32x32x16_bf16 v[64:79], v[228:231], v[196:199], v[64:79]
  ds_read_b64_tr_b16 v[220:221], v6 offset:22528
  ds_read_b64_tr_b16 v[222:223], v6 offset:23552
  v_cvt_pk_bf16_f32 v50, v52, v53
  s_waitcnt lgkmcnt(8)
  v_mfma_f32_32x32x16_bf16 v[64:79], v[232:235], v[200:203], v[64:79]
  ds_read_b64_tr_b16 v[224:225], v6 offset:24576
  ds_read_b64_tr_b16 v[226:227], v6 offset:25600
  v_mfma_f32_32x32x16_bf16 v[64:79], v[236:239], v[204:207], v[64:79]
  ds_read_b64_tr_b16 v[228:229], v6 offset:26624
  ds_read_b64_tr_b16 v[230:231], v6 offset:27648
  v_cvt_pk_bf16_f32 v51, v54, v55
  s_waitcnt lgkmcnt(8)
  v_mfma_f32_32x32x16_bf16 v[64:79], v[208:211], v[112:115], v[64:79]
  ds_read_b64_tr_b16 v[232:233], v6 offset:28672
  ds_read_b64_tr_b16 v[234:235], v6 offset:29696
  s_add_u32 s51, s51, 4096
  buffer_store_dwordx4 v[48:51], v1, s[24:27], s51 offen offset:0 sc1
  v_mfma_f32_32x32x16_bf16 v[64:79], v[212:215], v[116:119], v[64:79]
  ds_read_b64_tr_b16 v[236:237], v6 offset:30720
  ds_read_b64_tr_b16 v[238:239], v6 offset:31744
  s_waitcnt lgkmcnt(8)
  v_mfma_f32_32x32x16_bf16 v[64:79], v[216:219], v[120:123], v[64:79]
  ds_read_b64_tr_b16 v[208:209], v6 offset:32768
  ds_read_b64_tr_b16 v[210:211], v6 offset:33792
  v_cvt_pk_bf16_f32 v56, v56, v57
  v_mfma_f32_32x32x16_bf16 v[64:79], v[220:223], v[124:127], v[64:79]
  ds_read_b64_tr_b16 v[212:213], v6 offset:34816
  ds_read_b64_tr_b16 v[214:215], v6 offset:35840
  v_cvt_pk_bf16_f32 v57, v58, v59
  s_waitcnt lgkmcnt(8)
  v_mfma_f32_32x32x16_bf16 v[64:79], v[224:227], v[128:131], v[64:79]
  ds_read_b64_tr_b16 v[216:217], v6 offset:36864
  ds_read_b64_tr_b16 v[218:219], v6 offset:37888
  v_cvt_pk_bf16_f32 v58, v60, v61
  v_mfma_f32_32x32x16_bf16 v[64:79], v[228:231], v[132:135], v[64:79]
  ds_read_b64_tr_b16 v[220:221], v6 offset:38912
  ds_read_b64_tr_b16 v[222:223], v6 offset:39936
  s_waitcnt lgkmcnt(8)
  v_mfma_f32_32x32x16_bf16 v[64:79], v[232:235], v[136:139], v[64:79]
  ds_read_b64_tr_b16 v[224:225], v6 offset:40960
  ds_read_b64_tr_b16 v[226:227], v6 offset:41984
  v_cvt_pk_bf16_f32 v59, v62, v63
  v_mfma_f32_32x32x16_bf16 v[64:79], v[236:239], v[140:143], v[64:79]
  ds_read_b64_tr_b16 v[228:229], v6 offset:43008
  ds_read_b64_tr_b16 v[230:231], v6 offset:44032
  buffer_store_dwordx4 v[56:59], v1, s[24:27], s51 offen offset:1024 sc1
  s_waitcnt lgkmcnt(8)
  v_mfma_f32_32x32x16_bf16 v[64:79], v[208:211], v[144:147], v[64:79]
  ds_read_b64_tr_b16 v[232:233], v6 offset:45056
  ds_read_b64_tr_b16 v[234:235], v6 offset:46080
  v_mfma_f32_32x32x16_bf16 v[64:79], v[212:215], v[148:151], v[64:79]
  ds_read_b64_tr_b16 v[236:237], v6 offset:47104
  ds_read_b64_tr_b16 v[238:239], v6 offset:48128
  s_waitcnt lgkmcnt(8)
  v_mfma_f32_32x32x16_bf16 v[64:79], v[216:219], v[152:155], v[64:79]
  ds_read_b64_tr_b16 v[208:209], v6 offset:49152
  ds_read_b64_tr_b16 v[210:211], v6 offset:50176
  v_mfma_f32_32x32x16_bf16 v[64:79], v[220:223], v[156:159], v[64:79]
  ds_read_b64_tr_b16 v[212:213], v6 offset:51200
  ds_read_b64_tr_b16 v[214:215], v6 offset:52224
  s_waitcnt lgkmcnt(8)
  v_mfma_f32_32x32x16_bf16 v[64:79], v[224:227], v[160:163], v[64:79]
  ds_read_b64_tr_b16 v[216:217], v6 offset:53248
  ds_read_b64_tr_b16 v[218:219], v6 offset:54272
  v_mfma_f32_32x32x16_bf16 v[64:79], v[228:231], v[164:167], v[64:79]
  ds_read_b64_tr_b16 v[220:221], v6 offset:55296
  ds_read_b64_tr_b16 v[222:223], v6 offset:56320
  s_waitcnt lgkmcnt(8)
  v_mfma_f32_32x32x16_bf16 v[64:79], v[232:235], v[168:171], v[64:79]
  ds_read_b64_tr_b16 v[224:225], v6 offset:57344
  ds_read_b64_tr_b16 v[226:227], v6 offset:58368
  v_mfma_f32_32x32x16_bf16 v[64:79], v[236:239], v[172:175], v[64:79]
  ds_read_b64_tr_b16 v[228:229], v6 offset:59392
  ds_read_b64_tr_b16 v[230:231], v6 offset:60416
  s_waitcnt lgkmcnt(8)
  v_mfma_f32_32x32x16_bf16 v[64:79], v[208:211], v[80:83], v[64:79]
  ds_read_b64_tr_b16 v[232:233], v6 offset:61440
  ds_read_b64_tr_b16 v[234:235], v6 offset:62464
  v_mfma_f32_32x32x16_bf16 v[64:79], v[212:215], v[84:87], v[64:79]
  ds_read_b64_tr_b16 v[236:237], v6 offset:63488
  ds_read_b64_tr_b16 v[238:239], v6 offset:64512
  s_waitcnt lgkmcnt(8)
  v_mfma_f32_32x32x16_bf16 v[64:79], v[216:219], v[88:91], v[64:79]
  v_mfma_f32_32x32x16_bf16 v[64:79], v[220:223], v[92:95], v[64:79]
  s_waitcnt lgkmcnt(4)
  v_mfma_f32_32x32x16_bf16 v[64:79], v[224:227], v[96:99], v[64:79]
  v_mfma_f32_32x32x16_bf16 v[64:79], v[228:231], v[100:103], v[64:79]
  s_waitcnt lgkmcnt(0)
  v_mfma_f32_32x32x16_bf16 v[64:79], v[232:235], v[104:107], v[64:79]
  v_mfma_f32_32x32x16_bf16 v[64:79], v[236:239], v[108:111], v[64:79]
  s_nop 7
  s_nop 3
  v_cvt_pk_bf16_f32 v64, v64, v65
  v_cvt_pk_bf16_f32 v65, v66, v67
  v_cvt_pk_bf16_f32 v66, v68, v69
  v_cvt_pk_bf16_f32 v67, v70, v71
  buffer_store_dwordx4 v[64:67], v1, s[24:27], s51 offen offset:2048 sc1
  v_cvt_pk_bf16_f32 v72, v72, v73
  v_cvt_pk_bf16_f32 v73, v74, v75
  v_cvt_pk_bf16_f32 v74, v76, v77
  v_cvt_pk_bf16_f32 v75, v78, v79
  buffer_store_dwordx4 v[72:75], v1, s[24:27], s51 offen offset:3072 sc1
  s_branch k2_t1
k2_p3g0:
  ds_read_b64_tr_b16 v[208:209], v3 offset:0
  ds_read_b64_tr_b16 v[210:211], v3 offset:1024
  ds_read_b64_tr_b16 v[212:213], v4 offset:0
  ds_read_b64_tr_b16 v[214:215], v4 offset:1024
  ds_read_b64_tr_b16 v[216:217], v3 offset:2048
  ds_read_b64_tr_b16 v[218:219], v3 offset:3072
  ds_read_b64_tr_b16 v[220:221], v4 offset:2048
  ds_read_b64_tr_b16 v[222:223], v4 offset:3072
  ds_read_b64_tr_b16 v[224:225], v3 offset:4096
  ds_read_b64_tr_b16 v[226:227], v3 offset:5120
  ds_read_b64_tr_b16 v[228:229], v4 offset:4096
  ds_read_b64_tr_b16 v[230:231], v4 offset:5120
  s_lshr_b32 s51, s30, 2
  s_lshl_b32 s51, s51, 18
  s_lshl_b32 s36, s28, 15
  s_add_u32 s51, s51, s36
  s_and_b32 s36, s30, 3
  s_lshl_b32 s36, s36, 13
  s_add_u32 s51, s51, s36
  s_mul_i32 s36, s31, 3407872
  s_add_u32 s36, s36, 67108864
  s_add_u32 s24, s4, s36
  s_addc_u32 s25, s5, 0
  s_mov_b32 s26, 3325952
  s_mov_b32 s27, 0x20000
  s_waitcnt lgkmcnt(8)
  v_mfma_f32_32x32x16_bf16 v[16:31], v[208:211], v[176:179], 0
  ds_read_b64_tr_b16 v[232:233], v3 offset:6144
  ds_read_b64_tr_b16 v[234:235], v3 offset:7168
  v_mfma_f32_32x32x16_bf16 v[32:47], v[212:215], v[176:179], 0
  ds_read_b64_tr_b16 v[236:237], v4 offset:6144
  ds_read_b64_tr_b16 v[238:239], v4 offset:7168
  s_waitcnt lgkmcnt(8)
  v_mfma_f32_32x32x16_bf16 v[16:31], v[216:219], v[180:183], v[16:31]
  ds_read_b64_tr_b16 v[208:209], v3 offset:8192
  ds_read_b64_tr_b16 v[210:211], v3 offset:9216
  v_mfma_f32_32x32x16_bf16 v[32:47], v[220:223], v[180:183], v[32:47]
  ds_read_b64_tr_b16 v[212:213], v4 offset:8192
  ds_read_b64_tr_b16 v[214:215], v4 offset:9216
  s_waitcnt lgkmcnt(8)
  v_mfma_f32_32x32x16_bf16 v[16:31], v[224:227], v[184:187], v[16:31]
  ds_read_b64_tr_b16 v[216:217], v3 offset:10240
  ds_read_b64_tr_b16 v[218:219], v3 offset:11264
  v_mfma_f32_32x32x16_bf16 v[32:47], v[228:231], v[184:187], v[32:47]
  ds_read_b64_tr_b16 v[220:221], v4 offset:10240
  ds_read_b64_tr_b16 v[222:223], v4 offset:11264
  s_waitcnt lgkmcnt(8)
  v_mfma_f32_32x32x16_bf16 v[16:31], v[232:235], v[188:191], v[16:31]
  ds_read_b64_tr_b16 v[224:225], v3 offset:12288
  ds_read_b64_tr_b16 v[226:227], v3 offset:13312
  v_mfma_f32_32x32x16_bf16 v[32:47], v[236:239], v[188:191], v[32:47]
  ds_read_b64_tr_b16 v[228:229], v4 offset:12288
  ds_read_b64_tr_b16 v[230:231], v4 offset:13312
  s_waitcnt lgkmcnt(8)
  v_mfma_f32_32x32x16_bf16 v[16:31], v[208:211], v[192:195], v[16:31]
  ds_read_b64_tr_b16 v[232:233], v3 offset:14336
  ds_read_b64_tr_b16 v[234:235], v3 offset:15360
  v_mfma_f32_32x32x16_bf16 v[32:47], v[212:215], v[192:195], v[32:47]
  ds_read_b64_tr_b16 v[236:237], v4 offset:14336
  ds_read_b64_tr_b16 v[238:239], v4 offset:15360
  s_waitcnt lgkmcnt(8)
  v_mfma_f32_32x32x16_bf16 v[16:31], v[216:219], v[196:199], v[16:31]
  ds_read_b64_tr_b16 v[208:209], v3 offset:16384
  ds_read_b64_tr_b16 v[210:211], v3 offset:17408
  v_mfma_f32_32x32x16_bf16 v[32:47], v[220:223], v[196:199], v[32:47]
  ds_read_b64_tr_b16 v[212:213], v4 offset:16384
  ds_read_b64_tr_b16 v[214:215], v4 offset:17408
  s_waitcnt lgkmcnt(8)
  v_mfma_f32_32x32x16_bf16 v[16:31], v[224:227], v[200:203], v[16:31]
  ds_read_b64_tr_b16 v[216:217], v3 offset:18432
  ds_read_b64_tr_b16 v[218:219], v3 offset:19456
  v_mfma_f32_32x32x16_bf16 v[32:47], v[228:231], v[200:203], v[32:47]
  ds_read_b64_tr_b16 v[220:221], v4 offset:18432
  ds_read_b64_tr_b16 v[222:223], v4 offset:19456
  s_waitcnt lgkmcnt(8)
  v_mfma_f32_32x32x16_bf16 v[16:31], v[232:235], v[204:207], v[16:31]
  ds_read_b64_tr_b16 v[224:225], v3 offset:20480
  ds_read_b64_tr_b16 v[226:227], v3 offset:21504
  v_mfma_f32_32x32x16_bf16 v[32:47], v[236:239], v[204:207], v[32:47]
  ds_read_b64_tr_b16 v[228:229], v4 offset:20480
  ds_read_b64_tr_b16 v[230:231], v4 offset:21504
  s_waitcnt vmcnt(0)
  v_mov_b32 v13, 0
  v_mov_b32 v15, 1
  s_mov_b32 s72, 1
  s_mov_b64 exec, 1
  buffer_atomic_add v15, v13, s[76:79], s74 offen sc1
  s_mov_b64 exec, -1
  s_barrier
  buffer_load_dword v15, v13, s[76:79], s74 offen sc1
  s_waitcnt vmcnt(0)
  v_readfirstlane_b32 s35, v15
  s_nop 0
  s_cmp_lt_u32 s35, 4
  s_cbranch_scc1 k2_cspin0
k2_cgo0:
  s_add_u32 s33, s30, 1
  s_and_b32 s33, s33, 3
  s_lshl_b32 s33, s33, 13
  s_add_u32 s33, s33, s42
  buffer_load_dwordx4 v[112:115], v1, s[20:23], s33 offen offset:0 sc1
  buffer_load_dwordx4 v[116:119], v1, s[20:23], s33 offen offset:1024 sc1
  buffer_load_dwordx4 v[120:123], v1, s[20:23], s33 offen offset:2048 sc1
  buffer_load_dwordx4 v[124:127], v1, s[20:23], s33 offen offset:3072 sc1
  s_add_u32 s33, s33, 4096
  buffer_load_dwordx4 v[128:131], v1, s[20:23], s33 offen offset:0 sc1
  buffer_load_dwordx4 v[132:135], v1, s[20:23], s33 offen offset:1024 sc1
  s_waitcnt vmcnt(5)
  s_waitcnt lgkmcnt(8)
  v_mfma_f32_32x32x16_bf16 v[16:31], v[208:211], v[112:115], v[16:31]
  ds_read_b64_tr_b16 v[232:233], v3 offset:22528
  ds_read_b64_tr_b16 v[234:235], v3 offset:23552
  buffer_load_dwordx4 v[136:139], v1, s[20:23], s33 offen offset:2048 sc1
  v_mfma_f32_32x32x16_bf16 v[32:47], v[212:215], v[112:115], v[32:47]
  ds_read_b64_tr_b16 v[236:237], v4 offset:22528
  ds_read_b64_tr_b16 v[238:239], v4 offset:23552
  s_waitcnt vmcnt(5)
  s_waitcnt lgkmcnt(8)
  v_mfma_f32_32x32x16_bf16 v[16:31], v[216:219], v[116:119], v[16:31]
  ds_read_b64_tr_b16 v[208:209], v3 offset:24576
  ds_read_b64_tr_b16 v[210:211], v3 offset:25600
  buffer_load_dwordx4 v[140:143], v1, s[20:23], s33 offen offset:3072 sc1
  v_mfma_f32_32x32x16_bf16 v[32:47], v[220:223], v[116:119], v[32:47]
  ds_read_b64_tr_b16 v[212:213], v4 offset:24576
  ds_read_b64_tr_b16 v[214:215], v4 offset:25600
  s_waitcnt vmcnt(5)
  s_waitcnt lgkmcnt(8)
  v_mfma_f32_32x32x16_bf16 v[16:31], v[224:227], v[120:123], v[16:31]
  ds_read_b64_tr_b16 v[216:217], v3 offset:26624
  ds_read_b64_tr_b16 v[218:219], v3 offset:27648
  s_add_u32 s33, s30, 2
  s_and_b32 s33, s33, 3
  s_lshl_b32 s33, s33, 13
  s_add_u32 s33, s33, s42
  buffer_load_dwordx4 v[144:147], v1, s[20:23], s33 offen offset:0 sc1
  v_mfma_f32_32x32x16_bf16 v[32:47], v[228:231], v[120:123], v[32:47]
  ds_read_b64_tr_b16 v[220:221], v4 offset:26624
  ds_read_b64_tr_b16 v[222:223], v4 offset:27648
  s_waitcnt vmcnt(5)
  s_waitcnt lgkmcnt(8)
  v_mfma_f32_32x32x16_bf16 v[16:31], v[232:235], v[124:127], v[16:31]
  ds_read_b64_tr_b16 v[224:225], v3 offset:28672
  ds_read_b64_tr_b16 v[226:227], v3 offset:29696
  buffer_load_dwordx4 v[148:151], v1, s[20:23], s33 offen offset:1024 sc1
  v_mfma_f32_32x32x16_bf16 v[32:47], v[236:239], v[124:127], v[32:47]
  ds_read_b64_tr_b16 v[228:229], v4 offset:28672
  ds_read_b64_tr_b16 v[230:231], v4 offset:29696
  s_waitcnt vmcnt(5)
  s_waitcnt lgkmcnt(8)
  v_mfma_f32_32x32x16_bf16 v[16:31], v[208:211], v[128:131], v[16:31]
  ds_read_b64_tr_b16 v[232:233], v3 offset:30720
  ds_read_b64_tr_b16 v[234:235], v3 offset:31744
  buffer_load_dwordx4 v[152:155], v1, s[20:23], s33 offen offset:2048 sc1
  v_mfma_f32_32x32x16_bf16 v[32:47], v[212:215], v[128:131], v[32:47]
  ds_read_b64_tr_b16 v[236:237], v4 offset:30720
  ds_read_b64_tr_b16 v[238:239], v4 offset:31744
  s_waitcnt vmcnt(5)
  s_waitcnt lgkmcnt(8)
  v_mfma_f32_32x32x16_bf16 v[16:31], v[216:219], v[132:135], v[16:31]
  ds_read_b64_tr_b16 v[208:209], v3 offset:32768
  ds_read_b64_tr_b16 v[210:211], v3 offset:33792
  buffer_load_dwordx4 v[156:159], v1, s[20:23], s33 offen offset:3072 sc1
  v_mfma_f32_32x32x16_bf16 v[32:47], v[220:223], v[132:135], v[32:47]
  ds_read_b64_tr_b16 v[212:213], v4 offset:32768
  ds_read_b64_tr_b16 v[214:215], v4 offset:33792
  s_waitcnt vmcnt(5)
  s_waitcnt lgkmcnt(8)
  v_mfma_f32_32x32x16_bf16 v[16:31], v[224:227], v[136:139], v[16:31]
  ds_read_b64_tr_b16 v[216:217], v3 offset:34816
  ds_read_b64_tr_b16 v[218:219], v3 offset:35840
  s_add_u32 s33, s33, 4096
  buffer_load_dwordx4 v[160:163], v1, s[20:23], s33 offen offset:0 sc1
  v_mfma_f32_32x32x16_bf16 v[32:47], v[228:231], v[136:139], v[32:47]
  ds_read_b64_tr_b16 v[220:221], v4 offset:34816
  ds_read_b64_tr_b16 v[222:223], v4 offset:35840
  s_waitcnt vmcnt(5)
  s_waitcnt lgkmcnt(8)
  v_mfma_f32_32x32x16_bf16 v[16:31], v[232:235], v[140:143], v[16:31]
  ds_read_b64_tr_b16 v[224:225], v3 offset:36864
  ds_read_b64_tr_b16 v[226:227], v3 offset:37888
  buffer_load_dwordx4 v[164:167], v1, s[20:23], s33 offen offset:1024 sc1
  v_mfma_f32_32x32x16_bf16 v[32:47], v[236:239], v[140:143], v[32:47]
  ds_read_b64_tr_b16 v[228:229], v4 offset:36864
  ds_read_b64_tr_b16 v[230:231], v4 offset:37888
  s_waitcnt vmcnt(5)
  s_waitcnt lgkmcnt(8)
  v_mfma_f32_32x32x16_bf16 v[16:31], v[208:211], v[144:147], v[16:31]
  ds_read_b64_tr_b16 v[232:233], v3 offset:38912
  ds_read_b64_tr_b16 v[234:235], v3 offset:39936
  buffer_load_dwordx4 v[168:171], v1, s[20:23], s33 offen offset:2048 sc1
  v_mfma_f32_32x32x16_bf16 v[32:47], v[212:215], v[144:147], v[32:47]
  ds_read_b64_tr_b16 v[236:237], v4 offset:38912
  ds_read_b64_tr_b16 v[238:239], v4 offset:39936
  s_waitcnt vmcnt(5)
  s_waitcnt lgkmcnt(8)
  v_mfma_f32_32x32x16_bf16 v[16:31], v[216:219], v[148:151], v[16:31]
  ds_read_b64_tr_b16 v[208:209], v3 offset:40960
  ds_read_b64_tr_b16 v[210:211], v3 offset:41984
  buffer_load_dwordx4 v[172:175], v1, s[20:23], s33 offen offset:3072 sc1
  v_mfma_f32_32x32x16_bf16 v[32:47], v[220:223], v[148:151], v[32:47]
  ds_read_b64_tr_b16 v[212:213], v4 offset:40960
  ds_read_b64_tr_b16 v[214:215], v4 offset:41984
  s_waitcnt vmcnt(5)
  s_waitcnt lgkmcnt(8)
  v_mfma_f32_32x32x16_bf16 v[16:31], v[224:227], v[152:155], v[16:31]
  ds_read_b64_tr_b16 v[216:217], v3 offset:43008
  ds_read_b64_tr_b16 v[218:219], v3 offset:44032
  s_add_u32 s33, s30, 3
  s_and_b32 s33, s33, 3
  s_lshl_b32 s33, s33, 13
  s_add_u32 s33, s33, s42
  buffer_load_dwordx4 v[80:83], v1, s[20:23], s33 offen offset:0 sc1
  v_mfma_f32_32x32x16_bf16 v[32:47], v[228:231], v[152:155], v[32:47]
  ds_read_b64_tr_b16 v[220:221], v4 offset:43008
  ds_read_b64_tr_b16 v[222:223], v4 offset:44032
  s_waitcnt vmcnt(5)
  s_waitcnt lgkmcnt(8)
  v_mfma_f32_32x32x16_bf16 v[16:31], v[232:235], v[156:159], v[16:31]
  ds_read_b64_tr_b16 v[224:225], v3 offset:45056
  ds_read_b64_tr_b16 v[226:227], v3 offset:46080
  buffer_load_dwordx4 v[84:87], v1, s[20:23], s33 offen offset:1024 sc1
  v_mfma_f32_32x32x16_bf16 v[32:47], v[236:239], v[156:159], v[32:47]
  ds_read_b64_tr_b16 v[228:229], v4 offset:45056
  ds_read_b64_tr_b16 v[230:231], v4 offset:46080
  s_waitcnt vmcnt(5)
  s_waitcnt lgkmcnt(8)
  v_mfma_f32_32x32x16_bf16 v[16:31], v[208:211], v[160:163], v[16:31]
  ds_read_b64_tr_b16 v[232:233], v3 offset:47104
  ds_read_b64_tr_b16 v[234:235], v3 offset:48128
  buffer_load_dwordx4 v[88:91], v1, s[20:23], s33 offen offset:2048 sc1
  v_mfma_f32_32x32x16_bf16 v[32:47], v[212:215], v[160:163], v[32:47]
  ds_read_b64_tr_b16 v[236:237], v4 offset:47104
  ds_read_b64_tr_b16 v[238:239], v4 offset:48128
  s_waitcnt vmcnt(5)
  s_waitcnt lgkmcnt(8)
  v_mfma_f32_32x32x16_bf16 v[16:31], v[216:219], v[164:167], v[16:31]
  ds_read_b64_tr_b16 v[208:209], v3 offset:49152
  ds_read_b64_tr_b16 v[210:211], v3 offset:50176
  buffer_load_dwordx4 v[92:95], v1, s[20:23], s33 offen offset:3072 sc1
  v_mfma_f32_32x32x16_bf16 v[32:47], v[220:223], v[164:167], v[32:47]
  ds_read_b64_tr_b16 v[212:213], v4 offset:49152
  ds_read_b64_tr_b16 v[214:215], v4 offset:50176
  s_waitcnt vmcnt(5)
  s_waitcnt lgkmcnt(8)
  v_mfma_f32_32x32x16_bf16 v[16:31], v[224:227], v[168:171], v[16:31]
  ds_read_b64_tr_b16 v[216:217], v3 offset:51200
  ds_read_b64_tr_b16 v[218:219], v3 offset:52224
  s_add_u32 s33, s33, 4096
  buffer_load_dwordx4 v[96:99], v1, s[20:23], s33 offen offset:0 sc1
  v_mfma_f32_32x32x16_bf16 v[32:47], v[228:231], v[168:171], v[32:47]
  ds_read_b64_tr_b16 v[220:221], v4 offset:51200
  ds_read_b64_tr_b16 v[222:223], v4 offset:52224
  s_waitcnt vmcnt(5)
  s_waitcnt lgkmcnt(8)
  v_mfma_f32_32x32x16_bf16 v[16:31], v[232:235], v[172:175], v[16:31]
  ds_read_b64_tr_b16 v[224:225], v3 offset:53248
  ds_read_b64_tr_b16 v[226:227], v3 offset:54272
  buffer_load_dwordx4 v[100:103], v1, s[20:23], s33 offen offset:1024 sc1
  v_mfma_f32_32x32x16_bf16 v[32:47], v[236:239], v[172:175], v[32:47]
  ds_read_b64_tr_b16 v[228:229], v4 offset:53248
  ds_read_b64_tr_b16 v[230:231], v4 offset:54272
  s_waitcnt vmcnt(5)
  s_waitcnt lgkmcnt(8)
  v_mfma_f32_32x32x16_bf16 v[16:31], v[208:211], v[80:83], v[16:31]
  ds_read_b64_tr_b16 v[232:233], v3 offset:55296
  ds_read_b64_tr_b16 v[234:235], v3 offset:56320
  buffer_load_dwordx4 v[104:107], v1, s[20:23], s33 offen offset:2048 sc1
  v_mfma_f32_32x32x16_bf16 v[32:47], v[212:215], v[80:83], v[32:47]
  ds_read_b64_tr_b16 v[236:237], v4 offset:55296
  ds_read_b64_tr_b16 v[238:239], v4 offset:56320
  s_waitcnt vmcnt(5)
  s_waitcnt lgkmcnt(8)
  v_mfma_f32_32x32x16_bf16 v[16:31], v[216:219], v[84:87], v[16:31]
  ds_read_b64_tr_b16 v[208:209], v3 offset:57344
  ds_read_b64_tr_b16 v[210:211], v3 offset:58368
  buffer_load_dwordx4 v[108:111], v1, s[20:23], s33 offen offset:3072 sc1
  v_mfma_f32_32x32x16_bf16 v[32:47], v[220:223], v[84:87], v[32:47]
  ds_read_b64_tr_b16 v[212:213], v4 offset:57344
  ds_read_b64_tr_b16 v[214:215], v4 offset:58368
  s_waitcnt vmcnt(5)
  s_waitcnt lgkmcnt(8)
  v_mfma_f32_32x32x16_bf16 v[16:31], v[224:227], v[88:91], v[16:31]
  ds_read_b64_tr_b16 v[216:217], v3 offset:59392
  ds_read_b64_tr_b16 v[218:219], v3 offset:60416
  v_mfma_f32_32x32x16_bf16 v[32:47], v[228:231], v[88:91], v[32:47]
  ds_read_b64_tr_b16 v[220:221], v4 offset:59392
  ds_read_b64_tr_b16 v[222:223], v4 offset:60416
  s_waitcnt vmcnt(4)
  s_waitcnt lgkmcnt(8)
  v_mfma_f32_32x32x16_bf16 v[16:31], v[232:235], v[92:95], v[16:31]
  ds_read_b64_tr_b16 v[224:225], v3 offset:61440
  ds_read_b64_tr_b16 v[226:227], v3 offset:62464
  v_mfma_f32_32x32x16_bf16 v[32:47], v[236:239], v[92:95], v[32:47]
  ds_read_b64_tr_b16 v[228:229], v4 offset:61440
  ds_read_b64_tr_b16 v[230:231], v4 offset:62464
  s_waitcnt vmcnt(3)
  s_waitcnt lgkmcnt(8)
  v_mfma_f32_32x32x16_bf16 v[16:31], v[208:211], v[96:99], v[16:31]
  ds_read_b64_tr_b16 v[232:233], v3 offset:63488
  ds_read_b64_tr_b16 v[234:235], v3 offset:64512
  v_mfma_f32_32x32x16_bf16 v[32:47], v[212:215], v[96:99], v[32:47]
  ds_read_b64_tr_b16 v[236:237], v4 offset:63488
  ds_read_b64_tr_b16 v[238:239], v4 offset:64512
  s_waitcnt vmcnt(2)
  s_waitcnt lgkmcnt(8)
  v_mfma_f32_32x32x16_bf16 v[16:31], v[216:219], v[100:103], v[16:31]
  ds_read_b64_tr_b16 v[208:209], v5 offset:0
  ds_read_b64_tr_b16 v[210:211], v5 offset:1024
  v_mfma_f32_32x32x16_bf16 v[32:47], v[220:223], v[100:103], v[32:47]
  ds_read_b64_tr_b16 v[212:213], v5 offset:2048
  ds_read_b64_tr_b16 v[214:215], v5 offset:3072
  s_waitcnt vmcnt(1)
  s_waitcnt lgkmcnt(8)
  v_mfma_f32_32x32x16_bf16 v[16:31], v[224:227], v[104:107], v[16:31]
  ds_read_b64_tr_b16 v[216:217], v5 offset:4096
  ds_read_b64_tr_b16 v[218:219], v5 offset:5120
  v_mfma_f32_32x32x16_bf16 v[32:47], v[228:231], v[104:107], v[32:47]
  ds_read_b64_tr_b16 v[220:221], v5 offset:6144
  ds_read_b64_tr_b16 v[222:223], v5 offset:7168
  s_waitcnt vmcnt(0)
  s_waitcnt lgkmcnt(8)
  v_mfma_f32_32x32x16_bf16 v[16:31], v[232:235], v[108:111], v[16:31]
  ds_read_b64_tr_b16 v[224:225], v5 offset:8192
  ds_read_b64_tr_b16 v[226:227], v5 offset:9216
  v_mfma_f32_32x32x16_bf16 v[32:47], v[236:239], v[108:111], v[32:47]
  ds_read_b64_tr_b16 v[228:229], v5 offset:10240
  ds_read_b64_tr_b16 v[230:231], v5 offset:11264
  s_waitcnt lgkmcnt(8)
  v_mfma_f32_32x32x16_bf16 v[48:63], v[208:211], v[176:179], 0
  ds_read_b64_tr_b16 v[232:233], v5 offset:12288
  ds_read_b64_tr_b16 v[234:235], v5 offset:13312
  v_mfma_f32_32x32x16_bf16 v[48:63], v[212:215], v[180:183], v[48:63]
  ds_read_b64_tr_b16 v[236:237], v5 offset:14336
  ds_read_b64_tr_b16 v[238:239], v5 offset:15360
  s_waitcnt lgkmcnt(8)
  v_mfma_f32_32x32x16_bf16 v[48:63], v[216:219], v[184:187], v[48:63]
  ds_read_b64_tr_b16 v[208:209], v5 offset:16384
  ds_read_b64_tr_b16 v[210:211], v5 offset:17408
  v_cvt_pk_bf16_f32 v16, v16, v17
  v_mfma_f32_32x32x16_bf16 v[48:63], v[220:223], v[188:191], v[48:63]
  ds_read_b64_tr_b16 v[212:213], v5 offset:18432
  ds_read_b64_tr_b16 v[214:215], v5 offset:19456
  v_cvt_pk_bf16_f32 v17, v18, v19
  s_waitcnt lgkmcnt(8)
  v_mfma_f32_32x32x16_bf16 v[48:63], v[224:227], v[192:195], v[48:63]
  ds_read_b64_tr_b16 v[216:217], v5 offset:20480
  ds_read_b64_tr_b16 v[218:219], v5 offset:21504
  v_cvt_pk_bf16_f32 v18, v20, v21
  v_mfma_f32_32x32x16_bf16 v[48:63], v[228:231], v[196:199], v[48:63]
  ds_read_b64_tr_b16 v[220:221], v5 offset:22528
  ds_read_b64_tr_b16 v[222:223], v5 offset:23552
  s_waitcnt lgkmcnt(8)
  v_mfma_f32_32x32x16_bf16 v[48:63], v[232:235], v[200:203], v[48:63]
  ds_read_b64_tr_b16 v[224:225], v5 offset:24576
  ds_read_b64_tr_b16 v[226:227], v5 offset:25600
  v_cvt_pk_bf16_f32 v19, v22, v23
  v_mfma_f32_32x32x16_bf16 v[48:63], v[236:239], v[204:207], v[48:63]
  ds_read_b64_tr_b16 v[228:229], v5 offset:26624
  ds_read_b64_tr_b16 v[230:231], v5 offset:27648
  buffer_store_dwordx4 v[16:19], v1, s[24:27], s51 offen offset:0 sc1
  s_waitcnt lgkmcnt(8)
  v_mfma_f32_32x32x16_bf16 v[48:63], v[208:211], v[112:115], v[48:63]
  ds_read_b64_tr_b16 v[232:233], v5 offset:28672
  ds_read_b64_tr_b16 v[234:235], v5 offset:29696
  v_mfma_f32_32x32x16_bf16 v[48:63], v[212:215], v[116:119], v[48:63]
  ds_read_b64_tr_b16 v[236:237], v5 offset:30720
  ds_read_b64_tr_b16 v[238:239], v5 offset:31744
  v_cvt_pk_bf16_f32 v24, v24, v25
  s_waitcnt lgkmcnt(8)
  v_mfma_f32_32x32x16_bf16 v[48:63], v[216:219], v[120:123], v[48:63]
  ds_read_b64_tr_b16 v[208:209], v5 offset:32768
  ds_read_b64_tr_b16 v[210:211], v5 offset:33792
  v_cvt_pk_bf16_f32 v25, v26, v27
  v_mfma_f32_32x32x16_bf16 v[48:63], v[220:223], v[124:127], v[48:63]
  ds_read_b64_tr_b16 v[212:213], v5 offset:34816
  ds_read_b64_tr_b16 v[214:215], v5 offset:35840
  v_cvt_pk_bf16_f32 v26, v28, v29
  s_waitcnt lgkmcnt(8)
  v_mfma_f32_32x32x16_bf16 v[48:63], v[224:227], v[128:131], v[48:63]
  ds_read_b64_tr_b16 v[216:217], v5 offset:36864
  ds_read_b64_tr_b16 v[218:219], v5 offset:37888
  v_mfma_f32_32x32x16_bf16 v[48:63], v[228:231], v[132:135], v[48:63]
  ds_read_b64_tr_b16 v[220:221], v5 offset:38912
  ds_read_b64_tr_b16 v[222:223], v5 offset:39936
  v_cvt_pk_bf16_f32 v27, v30, v31
  s_waitcnt lgkmcnt(8)
  v_mfma_f32_32x32x16_bf16 v[48:63], v[232:235], v[136:139], v[48:63]
  ds_read_b64_tr_b16 v[224:225], v5 offset:40960
  ds_read_b64_tr_b16 v[226:227], v5 offset:41984
  buffer_store_dwordx4 v[24:27], v1, s[24:27], s51 offen offset:1024 sc1
  v_mfma_f32_32x32x16_bf16 v[48:63], v[236:239], v[140:143], v[48:63]
  ds_read_b64_tr_b16 v[228:229], v5 offset:43008
  ds_read_b64_tr_b16 v[230:231], v5 offset:44032
  s_waitcnt lgkmcnt(8)
  v_mfma_f32_32x32x16_bf16 v[48:63], v[208:211], v[144:147], v[48:63]
  ds_read_b64_tr_b16 v[232:233], v5 offset:45056
  ds_read_b64_tr_b16 v[234:235], v5 offset:46080
  v_mfma_f32_32x32x16_bf16 v[48:63], v[212:215], v[148:151], v[48:63]
  ds_read_b64_tr_b16 v[236:237], v5 offset:47104
  ds_read_b64_tr_b16 v[238:239], v5 offset:48128
  v_cvt_pk_bf16_f32 v32, v32, v33
  s_waitcnt lgkmcnt(8)
  v_mfma_f32_32x32x16_bf16 v[48:63], v[216:219], v[152:155], v[48:63]
  ds_read_b64_tr_b16 v[208:209], v5 offset:49152
  ds_read_b64_tr_b16 v[210:211], v5 offset:50176
  v_cvt_pk_bf16_f32 v33, v34, v35
  v_mfma_f32_32x32x16_bf16 v[48:63], v[220:223], v[156:159], v[48:63]
  ds_read_b64_tr_b16 v[212:213], v5 offset:51200
  ds_read_b64_tr_b16 v[214:215], v5 offset:52224
  v_cvt_pk_bf16_f32 v34, v36, v37
  s_waitcnt lgkmcnt(8)
  v_mfma_f32_32x32x16_bf16 v[48:63], v[224:227], v[160:163], v[48:63]
  ds_read_b64_tr_b16 v[216:217], v5 offset:53248
  ds_read_b64_tr_b16 v[218:219], v5 offset:54272
  v_mfma_f32_32x32x16_bf16 v[48:63], v[228:231], v[164:167], v[48:63]
  ds_read_b64_tr_b16 v[220:221], v5 offset:55296
  ds_read_b64_tr_b16 v[222:223], v5 offset:56320
  v_cvt_pk_bf16_f32 v35, v38, v39
  s_waitcnt lgkmcnt(8)
  v_mfma_f32_32x32x16_bf16 v[48:63], v[232:235], v[168:171], v[48:63]
  ds_read_b64_tr_b16 v[224:225], v5 offset:57344
  ds_read_b64_tr_b16 v[226:227], v5 offset:58368
  buffer_store_dwordx4 v[32:35], v1, s[24:27], s51 offen offset:2048 sc1
  v_mfma_f32_32x32x16_bf16 v[48:63], v[236:239], v[172:175], v[48:63]
  ds_read_b64_tr_b16 v[228:229], v5 offset:59392
  ds_read_b64_tr_b16 v[230:231], v5 offset:60416
  s_waitcnt lgkmcnt(8)
  v_mfma_f32_32x32x16_bf16 v[48:63], v[208:211], v[80:83], v[48:63]
  ds_read_b64_tr_b16 v[232:233], v5 offset:61440
  ds_read_b64_tr_b16 v[234:235], v5 offset:62464
  v_cvt_pk_bf16_f32 v40, v40, v41
  v_mfma_f32_32x32x16_bf16 v[48:63], v[212:215], v[84:87], v[48:63]
  ds_read_b64_tr_b16 v[236:237], v5 offset:63488
  ds_read_b64_tr_b16 v[238:239], v5 offset:64512
  v_cvt_pk_bf16_f32 v41, v42, v43
  s_waitcnt lgkmcnt(8)
  v_mfma_f32_32x32x16_bf16 v[48:63], v[216:219], v[88:91], v[48:63]
  ds_read_b64_tr_b16 v[208:209], v6 offset:0
  ds_read_b64_tr_b16 v[210:211], v6 offset:1024
  v_cvt_pk_bf16_f32 v42, v44, v45
  v_mfma_f32_32x32x16_bf16 v[48:63], v[220:223], v[92:95], v[48:63]
  ds_read_b64_tr_b16 v[212:213], v6 offset:2048
  ds_read_b64_tr_b16 v[214:215], v6 offset:3072
  s_waitcnt lgkmcnt(8)
  v_mfma_f32_32x32x16_bf16 v[48:63], v[224:227], v[96:99], v[48:63]
  ds_read_b64_tr_b16 v[216:217], v6 offset:4096
  ds_read_b64_tr_b16 v[218:219], v6 offset:5120
  v_cvt_pk_bf16_f32 v43, v46, v47
  v_mfma_f32_32x32x16_bf16 v[48:63], v[228:231], v[100:103], v[48:63]
  ds_read_b64_tr_b16 v[220:221], v6 offset:6144
  ds_read_b64_tr_b16 v[222:223], v6 offset:7168
  buffer_store_dwordx4 v[40:43], v1, s[24:27], s51 offen offset:3072 sc1
  s_waitcnt lgkmcnt(8)
  v_mfma_f32_32x32x16_bf16 v[48:63], v[232:235], v[104:107], v[48:63]
  ds_read_b64_tr_b16 v[224:225], v6 offset:8192
  ds_read_b64_tr_b16 v[226:227], v6 offset:9216
  v_mfma_f32_32x32x16_bf16 v[48:63], v[236:239], v[108:111], v[48:63]
  ds_read_b64_tr_b16 v[228:229], v6 offset:10240
  ds_read_b64_tr_b16 v[230:231], v6 offset:11264
  s_waitcnt lgkmcnt(8)
  v_mfma_f32_32x32x16_bf16 v[64:79], v[208:211], v[176:179], 0
  ds_read_b64_tr_b16 v[232:233], v6 offset:12288
  ds_read_b64_tr_b16 v[234:235], v6 offset:13312
  v_mfma_f32_32x32x16_bf16 v[64:79], v[212:215], v[180:183], v[64:79]
  ds_read_b64_tr_b16 v[236:237], v6 offset:14336
  ds_read_b64_tr_b16 v[238:239], v6 offset:15360
  s_waitcnt lgkmcnt(8)
  v_mfma_f32_32x32x16_bf16 v[64:79], v[216:219], v[184:187], v[64:79]
  ds_read_b64_tr_b16 v[208:209], v6 offset:16384
  ds_read_b64_tr_b16 v[210:211], v6 offset:17408
  v_mfma_f32_32x32x16_bf16 v[64:79], v[220:223], v[188:191], v[64:79]
  ds_read_b64_tr_b16 v[212:213], v6 offset:18432
  ds_read_b64_tr_b16 v[214:215], v6 offset:19456
  v_cvt_pk_bf16_f32 v48, v48, v49
  s_waitcnt lgkmcnt(8)
  v_mfma_f32_32x32x16_bf16 v[64:79], v[224:227], v[192:195], v[64:79]
  ds_read_b64_tr_b16 v[216:217], v6 offset:20480
  ds_read_b64_tr_b16 v[218:219], v6 offset:21504
  v_cvt_pk_bf16_f32 v49, v50, v51
  v_mfma_f32_32x32x16_bf16 v[64:79], v[228:231], v[196:199], v[64:79]
  ds_read_b64_tr_b16 v[220:221], v6 offset:22528
  ds_read_b64_tr_b16 v[222:223], v6 offset:23552
  v_cvt_pk_bf16_f32 v50, v52, v53
  s_waitcnt lgkmcnt(8)
  v_mfma_f32_32x32x16_bf16 v[64:79], v[232:235], v[200:203], v[64:79]
  ds_read_b64_tr_b16 v[224:225], v6 offset:24576
  ds_read_b64_tr_b16 v[226:227], v6 offset:25600
  v_mfma_f32_32x32x16_bf16 v[64:79], v[236:239], v[204:207], v[64:79]
  ds_read_b64_tr_b16 v[228:229], v6 offset:26624
  ds_read_b64_tr_b16 v[230:231], v6 offset:27648
  v_cvt_pk_bf16_f32 v51, v54, v55
  s_waitcnt lgkmcnt(8)
  v_mfma_f32_32x32x16_bf16 v[64:79], v[208:211], v[112:115], v[64:79]
  ds_read_b64_tr_b16 v[232:233], v6 offset:28672
  ds_read_b64_tr_b16 v[234:235], v6 offset:29696
  s_add_u32 s51, s51, 4096
  buffer_store_dwordx4 v[48:51], v1, s[24:27], s51 offen offset:0 sc1
  v_mfma_f32_32x32x16_bf16 v[64:79], v[212:215], v[116:119], v[64:79]
  ds_read_b64_tr_b16 v[236:237], v6 offset:30720
  ds_read_b64_tr_b16 v[238:239], v6 offset:31744
  s_waitcnt lgkmcnt(8)
  v_mfma_f32_32x32x16_bf16 v[64:79], v[216:219], v[120:123], v[64:79]
  ds_read_b64_tr_b16 v[208:209], v6 offset:32768
  ds_read_b64_tr_b16 v[210:211], v6 offset:33792
  v_cvt_pk_bf16_f32 v56, v56, v57
  v_mfma_f32_32x32x16_bf16 v[64:79], v[220:223], v[124:127], v[64:79]
  ds_read_b64_tr_b16 v[212:213], v6 offset:34816
  ds_read_b64_tr_b16 v[214:215], v6 offset:35840
  v_cvt_pk_bf16_f32 v57, v58, v59
  s_waitcnt lgkmcnt(8)
  v_mfma_f32_32x32x16_bf16 v[64:79], v[224:227], v[128:131], v[64:79]
  ds_read_b64_tr_b16 v[216:217], v6 offset:36864
  ds_read_b64_tr_b16 v[218:219], v6 offset:37888
  v_cvt_pk_bf16_f32 v58, v60, v61
  v_mfma_f32_32x32x16_bf16 v[64:79], v[228:231], v[132:135], v[64:79]
  ds_read_b64_tr_b16 v[220:221], v6 offset:38912
  ds_read_b64_tr_b16 v[222:223], v6 offset:39936
  s_waitcnt lgkmcnt(8)
  v_mfma_f32_32x32x16_bf16 v[64:79], v[232:235], v[136:139], v[64:79]
  ds_read_b64_tr_b16 v[224:225], v6 offset:40960
  ds_read_b64_tr_b16 v[226:227], v6 offset:41984
  v_cvt_pk_bf16_f32 v59, v62, v63
  v_mfma_f32_32x32x16_bf16 v[64:79], v[236:239], v[140:143], v[64:79]
  ds_read_b64_tr_b16 v[228:229], v6 offset:43008
  ds_read_b64_tr_b16 v[230:231], v6 offset:44032
  buffer_store_dwordx4 v[56:59], v1, s[24:27], s51 offen offset:1024 sc1
  s_waitcnt lgkmcnt(8)
  v_mfma_f32_32x32x16_bf16 v[64:79], v[208:211], v[144:147], v[64:79]
  ds_read_b64_tr_b16 v[232:233], v6 offset:45056
  ds_read_b64_tr_b16 v[234:235], v6 offset:46080
  v_mfma_f32_32x32x16_bf16 v[64:79], v[212:215], v[148:151], v[64:79]
  ds_read_b64_tr_b16 v[236:237], v6 offset:47104
  ds_read_b64_tr_b16 v[238:239], v6 offset:48128
  s_waitcnt lgkmcnt(8)
  v_mfma_f32_32x32x16_bf16 v[64:79], v[216:219], v[152:155], v[64:79]
  ds_read_b64_tr_b16 v[208:209], v6 offset:49152
  ds_read_b64_tr_b16 v[210:211], v6 offset:50176
  v_mfma_f32_32x32x16_bf16 v[64:79], v[220:223], v[156:159], v[64:79]
  ds_read_b64_tr_b16 v[212:213], v6 offset:51200
  ds_read_b64_tr_b16 v[214:215], v6 offset:52224
  s_waitcnt lgkmcnt(8)
  v_mfma_f32_32x32x16_bf16 v[64:79], v[224:227], v[160:163], v[64:79]
  ds_read_b64_tr_b16 v[216:217], v6 offset:53248
  ds_read_b64_tr_b16 v[218:219], v6 offset:54272
  v_mfma_f32_32x32x16_bf16 v[64:79], v[228:231], v[164:167], v[64:79]
  ds_read_b64_tr_b16 v[220:221], v6 offset:55296
  ds_read_b64_tr_b16 v[222:223], v6 offset:56320
  s_waitcnt lgkmcnt(8)
  v_mfma_f32_32x32x16_bf16 v[64:79], v[232:235], v[168:171], v[64:79]
  ds_read_b64_tr_b16 v[224:225], v6 offset:57344
  ds_read_b64_tr_b16 v[226:227], v6 offset:58368
  v_mfma_f32_32x32x16_bf16 v[64:79], v[236:239], v[172:175], v[64:79]
  ds_read_b64_tr_b16 v[228:229], v6 offset:59392
  ds_read_b64_tr_b16 v[230:231], v6 offset:60416
  s_waitcnt lgkmcnt(8)
  v_mfma_f32_32x32x16_bf16 v[64:79], v[208:211], v[80:83], v[64:79]
  ds_read_b64_tr_b16 v[232:233], v6 offset:61440
  ds_read_b64_tr_b16 v[234:235], v6 offset:62464
  v_mfma_f32_32x32x16_bf16 v[64:79], v[212:215], v[84:87], v[64:79]
  ds_read_b64_tr_b16 v[236:237], v6 offset:63488
  ds_read_b64_tr_b16 v[238:239], v6 offset:64512
  s_waitcnt lgkmcnt(8)
  v_mfma_f32_32x32x16_bf16 v[64:79], v[216:219], v[88:91], v[64:79]
  v_mfma_f32_32x32x16_bf16 v[64:79], v[220:223], v[92:95], v[64:79]
  s_waitcnt lgkmcnt(4)
  v_mfma_f32_32x32x16_bf16 v[64:79], v[224:227], v[96:99], v[64:79]
  v_mfma_f32_32x32x16_bf16 v[64:79], v[228:231], v[100:103], v[64:79]
  s_waitcnt lgkmcnt(0)
  v_mfma_f32_32x32x16_bf16 v[64:79], v[232:235], v[104:107], v[64:79]
  v_mfma_f32_32x32x16_bf16 v[64:79], v[236:239], v[108:111], v[64:79]
  s_barrier
  s_nop 7
  s_nop 3
  v_cvt_pk_bf16_f32 v64, v64, v65
  v_cvt_pk_bf16_f32 v65, v66, v67
  v_cvt_pk_bf16_f32 v66, v68, v69
  v_cvt_pk_bf16_f32 v67, v70, v71
  buffer_store_dwordx4 v[64:67], v1, s[24:27], s51 offen offset:2048 sc1
  v_cvt_pk_bf16_f32 v72, v72, v73
  v_cvt_pk_bf16_f32 v73, v74, v75
  v_cvt_pk_bf16_f32 v74, v76, v77
  v_cvt_pk_bf16_f32 v75, v78, v79
  buffer_store_dwordx4 v[72:75], v1, s[24:27], s51 offen offset:3072 sc1
  s_load_dwordx2 s[70:71], s[0:1], 96
  s_sub_u32 s35, 15, s31
  s_cmp_lt_u32 s30, 16
  s_cselect_b32 s32, s31, s35
  s_cselect_b32 s37, 4, 0
  s_and_b32 s40, s30, 15
  s_mul_i32 s41, s45, 44032
  s_mul_i32 s35, s40, 192
  s_add_u32 s41, s41, s35
  s_mul_i32 s48, s45, 3072
  v_add_u32 v208, 0, v0
  v_mul_u32_u24 v209, 43691, v208
  v_lshrrev_b32 v209, 19, v209
  v_mul_u32_u24 v210, 12, v209
  v_sub_u32 v210, v208, v210
  v_mul_u32_u24 v216, 2752, v209
  v_lshl_add_u32 v216, v210, 4, v216
  v_add_u32 v208, 64, v0
  v_mul_u32_u24 v209, 43691, v208
  v_lshrrev_b32 v209, 19, v209
  v_mul_u32_u24 v210, 12, v209
  v_sub_u32 v210, v208, v210
  v_mul_u32_u24 v217, 2752, v209
  v_lshl_add_u32 v217, v210, 4, v217
  v_add_u32 v208, 128, v0
  v_mul_u32_u24 v209, 43691, v208
  v_lshrrev_b32 v209, 19, v209
  v_mul_u32_u24 v210, 12, v209
  v_sub_u32 v210, v208, v210
  v_mul_u32_u24 v218, 2752, v209
  v_lshl_add_u32 v218, v210, 4, v218
  s_mov_b32 s8, s80
  s_mov_b32 s9, s81
  s_mov_b32 s10, 1409024
  s_mov_b32 s11, 0x20000
  s_mov_b32 s16, s82
  s_mov_b32 s17, s83
  s_mov_b32 s18, 1409024
  s_mov_b32 s19, 0x20000
  s_add_u32 m0, s48, 0
  s_add_u32 s35, s41, 0
  buffer_load_dwordx4 v216, s[8:11], s35 offen lds
  s_add_u32 m0, s48, 1024
  s_add_u32 s35, s41, 0
  buffer_load_dwordx4 v217, s[8:11], s35 offen lds
  s_add_u32 m0, s48, 2048
  s_add_u32 s35, s41, 0
  buffer_load_dwordx4 v218, s[8:11], s35 offen lds
  s_add_u32 m0, s48, 12288
  s_add_u32 s35, s41, 0
  buffer_load_dwordx4 v216, s[16:19], s35 offen lds
  s_add_u32 m0, s48, 13312
  s_add_u32 s35, s41, 0
  buffer_load_dwordx4 v217, s[16:19], s35 offen lds
  s_add_u32 m0, s48, 14336
  s_add_u32 s35, s41, 0
  buffer_load_dwordx4 v218, s[16:19], s35 offen lds
  v_lshrrev_b32 v232, 5, v0
  v_and_b32 v233, 15, v0
  v_lshrrev_b32 v234, 2, v233
  v_lshl_add_u32 v234, v232, 2, v234
  v_mul_u32_u24 v228, 192, v234
  v_and_b32 v234, 16, v0
  v_lshl_add_u32 v228, v234, 1, v228
  v_lshlrev_b32 v231, 6, v234
  v_lshl_add_u32 v231, v232, 8, v231
  v_lshl_add_u32 v231, v233, 4, v231
  v_and_b32 v234, 3, v0
  v_lshl_add_u32 v228, v234, 3, v228
  v_add_u32 v229, 49152, v228
  v_add_u32 v230, 98304, v228
  s_add_u32 s42, s37, s45
  s_lshl_b32 s50, s42, 11
  s_lshl_b32 s42, s42, 15
  s_add_u32 s42, s42, 2097152
  s_mul_i32 s35, s40, 49152
  s_add_u32 s50, s50, s35
  s_add_u32 s50, s50, 2621440
  s_mov_b32 s56, 0xc0135761
  s_mov_b32 s57, 0xbdd2d3e8
  s_and_b32 s35, s30, 7
  s_lshl_b32 s35, s35, 8
  s_add_u32 s35, s35, 161792
  v_and_b32 v209, 7, v0
  v_lshlrev_b32 v209, 5, v209
  v_add_u32 v209, s35, v209
  ds_read_b128 v[244:247], v209
  ds_read_b128 v[248:251], v209 offset:16
  s_waitcnt vmcnt(3)
  s_add_u32 m0, s48, 24576
  s_add_u32 s35, s41, 176128
  buffer_load_dwordx4 v216, s[8:11], s35 offen lds
  s_add_u32 m0, s48, 25600
  s_add_u32 s35, s41, 176128
  buffer_load_dwordx4 v217, s[8:11], s35 offen lds
  s_add_u32 m0, s48, 26624
  s_add_u32 s35, s41, 176128
  buffer_load_dwordx4 v218, s[8:11], s35 offen lds
  s_add_u32 m0, s48, 36864
  s_add_u32 s35, s41, 176128
  buffer_load_dwordx4 v216, s[16:19], s35 offen lds
  s_add_u32 m0, s48, 37888
  s_add_u32 s35, s41, 176128
  buffer_load_dwordx4 v217, s[16:19], s35 offen lds
  s_add_u32 m0, s48, 38912
  s_add_u32 s35, s41, 176128
  buffer_load_dwordx4 v218, s[16:19], s35 offen lds
  s_waitcnt vmcnt(3)
  s_add_u32 m0, s48, 49152
  s_add_u32 s35, s41, 352256
  buffer_load_dwordx4 v216, s[8:11], s35 offen lds
  s_add_u32 m0, s48, 50176
  s_add_u32 s35, s41, 352256
  buffer_load_dwordx4 v217, s[8:11], s35 offen lds
  s_add_u32 m0, s48, 51200
  s_add_u32 s35, s41, 352256
  buffer_load_dwordx4 v218, s[8:11], s35 offen lds
  s_add_u32 m0, s48, 61440
  s_add_u32 s35, s41, 352256
  buffer_load_dwordx4 v216, s[16:19], s35 offen lds
  s_add_u32 m0, s48, 62464
  s_add_u32 s35, s41, 352256
  buffer_load_dwordx4 v217, s[16:19], s35 offen lds
  s_add_u32 m0, s48, 63488
  s_add_u32 s35, s41, 352256
  buffer_load_dwordx4 v218, s[16:19], s35 offen lds
  s_waitcnt vmcnt(3)
  s_add_u32 m0, s48, 73728
  s_add_u32 s35, s41, 528384
  buffer_load_dwordx4 v216, s[8:11], s35 offen lds
  s_add_u32 m0, s48, 74752
  s_add_u32 s35, s41, 528384
  buffer_load_dwordx4 v217, s[8:11], s35 offen lds
  s_add_u32 m0, s48, 75776
  s_add_u32 s35, s41, 528384
  buffer_load_dwordx4 v218, s[8:11], s35 offen lds
  s_add_u32 m0, s48, 86016
  s_add_u32 s35, s41, 528384
  buffer_load_dwordx4 v216, s[16:19], s35 offen lds
  s_add_u32 m0, s48, 87040
  s_add_u32 s35, s41, 528384
  buffer_load_dwordx4 v217, s[16:19], s35 offen lds
  s_add_u32 m0, s48, 88064
  s_add_u32 s35, s41, 528384
  buffer_load_dwordx4 v218, s[16:19], s35 offen lds
  s_waitcnt vmcnt(3)
  s_add_u32 m0, s48, 98304
  s_add_u32 s35, s41, 704512
  buffer_load_dwordx4 v216, s[8:11], s35 offen lds
  s_add_u32 m0, s48, 99328
  s_add_u32 s35, s41, 704512
  buffer_load_dwordx4 v217, s[8:11], s35 offen lds
  s_add_u32 m0, s48, 100352
  s_add_u32 s35, s41, 704512
  buffer_load_dwordx4 v218, s[8:11], s35 offen lds
  s_add_u32 m0, s48, 110592
  s_add_u32 s35, s41, 704512
  buffer_load_dwordx4 v216, s[16:19], s35 offen lds
  s_add_u32 m0, s48, 111616
  s_add_u32 s35, s41, 704512
  buffer_load_dwordx4 v217, s[16:19], s35 offen lds
  s_add_u32 m0, s48, 112640
  s_add_u32 s35, s41, 704512
  buffer_load_dwordx4 v218, s[16:19], s35 offen lds
  s_waitcnt vmcnt(3)
  s_add_u32 m0, s48, 122880
  s_add_u32 s35, s41, 880640
  buffer_load_dwordx4 v216, s[8:11], s35 offen lds
  s_add_u32 m0, s48, 123904
  s_add_u32 s35, s41, 880640
  buffer_load_dwordx4 v217, s[8:11], s35 offen lds
  s_add_u32 m0, s48, 124928
  s_add_u32 s35, s41, 880640
  buffer_load_dwordx4 v218, s[8:11], s35 offen lds
  s_add_u32 m0, s48, 135168
  s_add_u32 s35, s41, 880640
  buffer_load_dwordx4 v216, s[16:19], s35 offen lds
  s_add_u32 m0, s48, 136192
  s_add_u32 s35, s41, 880640
  buffer_load_dwordx4 v217, s[16:19], s35 offen lds
  s_add_u32 m0, s48, 137216
  s_add_u32 s35, s41, 880640
  buffer_load_dwordx4 v218, s[16:19], s35 offen lds
  s_waitcnt vmcnt(0) lgkmcnt(0)
  s_barrier
  ds_read_b64_tr_b16 v[176:177], v228 offset:0
  ds_read_b64_tr_b16 v[178:179], v228 offset:1536
  ds_read_b64_tr_b16 v[180:181], v228 offset:64
  ds_read_b64_tr_b16 v[182:183], v228 offset:1600
  ds_read_b64_tr_b16 v[184:185], v228 offset:128
  ds_read_b64_tr_b16 v[186:187], v228 offset:1664
  ds_read_b64_tr_b16 v[188:189], v228 offset:12288
  ds_read_b64_tr_b16 v[190:191], v228 offset:13824
  ds_read_b64_tr_b16 v[192:193], v228 offset:12352
  ds_read_b64_tr_b16 v[194:195], v228 offset:13888
  ds_read_b64_tr_b16 v[196:197], v228 offset:12416
  ds_read_b64_tr_b16 v[198:199], v228 offset:13952
  s_add_u32 s36, s42, 0
  buffer_load_dwordx4 v[112:115], v1, s[24:27], s36 offen offset:0 sc1
  s_add_u32 s36, s42, 0
  buffer_load_dwordx4 v[116:119], v1, s[24:27], s36 offen offset:1024 sc1
  s_add_u32 s36, s42, 0
  buffer_load_dwordx4 v[120:123], v1, s[24:27], s36 offen offset:2048 sc1
  s_add_u32 s36, s42, 0
  buffer_load_dwordx4 v[124:127], v1, s[24:27], s36 offen offset:3072 sc1
  s_waitcnt vmcnt(0)
  v_max3_u32 v12, v112, v116, v120
  v_max_u32 v12, v12, v124
  v_cmp_eq_u32 vcc, -1, v12
  s_cbranch_vccnz k2_ry
k2_ryr:
  s_add_u32 s36, s42, 4096
  buffer_load_dwordx4 v[128:131], v1, s[24:27], s36 offen offset:0 sc1
  s_add_u32 s36, s42, 4096
  buffer_load_dwordx4 v[132:135], v1, s[24:27], s36 offen offset:1024 sc1
  s_add_u32 s36, s42, 4096
  buffer_load_dwordx4 v[136:139], v1, s[24:27], s36 offen offset:2048 sc1
  s_add_u32 s36, s42, 4096
  buffer_load_dwordx4 v[140:143], v1, s[24:27], s36 offen offset:3072 sc1
  s_add_u32 s36, s42, 8192
  buffer_load_dwordx4 v[144:147], v1, s[24:27], s36 offen offset:0 sc1
  s_add_u32 s36, s42, 8192
  buffer_load_dwordx4 v[148:151], v1, s[24:27], s36 offen offset:1024 sc1
  s_add_u32 s36, s42, 8192
  buffer_load_dwordx4 v[152:155], v1, s[24:27], s36 offen offset:2048 sc1
  s_add_u32 s36, s42, 8192
  buffer_load_dwordx4 v[156:159], v1, s[24:27], s36 offen offset:3072 sc1
  s_add_u32 s36, s42, 12288
  buffer_load_dwordx4 v[160:163], v1, s[24:27], s36 offen offset:0 sc1
  s_add_u32 s36, s42, 12288
  buffer_load_dwordx4 v[164:167], v1, s[24:27], s36 offen offset:1024 sc1
  s_add_u32 s36, s42, 12288
  buffer_load_dwordx4 v[168:171], v1, s[24:27], s36 offen offset:2048 sc1
  s_add_u32 s36, s42, 12288
  buffer_load_dwordx4 v[172:175], v1, s[24:27], s36 offen offset:3072 sc1
  v_mov_b32 v232, s56
  s_waitcnt lgkmcnt(8)
  v_mfma_f32_32x32x16_bf16 v[16:31], v[176:179], v[112:115], 0
  ds_read_b64_tr_b16 v[200:201], v228 offset:3072
  ds_read_b64_tr_b16 v[202:203], v228 offset:4608
  v_mfma_f32_32x32x16_bf16 v[32:47], v[180:183], v[112:115], 0
  ds_read_b64_tr_b16 v[204:205], v228 offset:3136
  ds_read_b64_tr_b16 v[206:207], v228 offset:4672
  s_waitcnt lgkmcnt(8)
  v_mfma_f32_32x32x16_bf16 v[48:63], v[184:187], v[112:115], 0
  ds_read_b64_tr_b16 v[176:177], v228 offset:3200
  ds_read_b64_tr_b16 v[178:179], v228 offset:4736
  v_mfma_f32_32x32x16_bf16 v[64:79], v[188:191], v[112:115], 0
  ds_read_b64_tr_b16 v[180:181], v228 offset:15360
  ds_read_b64_tr_b16 v[182:183], v228 offset:16896
  s_waitcnt lgkmcnt(8)
  v_mfma_f32_32x32x16_bf16 v[80:95], v[192:195], v[112:115], 0
  ds_read_b64_tr_b16 v[184:185], v228 offset:15424
  ds_read_b64_tr_b16 v[186:187], v228 offset:16960
  v_mfma_f32_32x32x16_bf16 v[96:111], v[196:199], v[112:115], 0
  ds_read_b64_tr_b16 v[188:189], v228 offset:15488
  ds_read_b64_tr_b16 v[190:191], v228 offset:17024
  s_waitcnt lgkmcnt(8)
  v_mfma_f32_32x32x16_bf16 v[16:31], v[200:203], v[116:119], v[16:31]
  ds_read_b64_tr_b16 v[192:193], v228 offset:6144
  ds_read_b64_tr_b16 v[194:195], v228 offset:7680
  v_mfma_f32_32x32x16_bf16 v[32:47], v[204:207], v[116:119], v[32:47]
  ds_read_b64_tr_b16 v[196:197], v228 offset:6208
  ds_read_b64_tr_b16 v[198:199], v228 offset:7744
  s_waitcnt lgkmcnt(8)
  v_mfma_f32_32x32x16_bf16 v[48:63], v[176:179], v[116:119], v[48:63]
  ds_read_b64_tr_b16 v[200:201], v228 offset:6272
  ds_read_b64_tr_b16 v[202:203], v228 offset:7808
  s_add_u32 s36, s42, 16384
  buffer_load_dwordx4 v[112:115], v1, s[24:27], s36 offen offset:0 sc1
  v_mfma_f32_32x32x16_bf16 v[64:79], v[180:183], v[116:119], v[64:79]
  ds_read_b64_tr_b16 v[204:205], v228 offset:18432
  ds_read_b64_tr_b16 v[206:207], v228 offset:19968
  s_waitcnt lgkmcnt(8)
  v_mfma_f32_32x32x16_bf16 v[80:95], v[184:187], v[116:119], v[80:95]
  ds_read_b64_tr_b16 v[176:177], v228 offset:18496
  ds_read_b64_tr_b16 v[178:179], v228 offset:20032
  v_mfma_f32_32x32x16_bf16 v[96:111], v[188:191], v[116:119], v[96:111]
  ds_read_b64_tr_b16 v[180:181], v228 offset:18560
  ds_read_b64_tr_b16 v[182:183], v228 offset:20096
  s_waitcnt lgkmcnt(8)
  v_mfma_f32_32x32x16_bf16 v[16:31], v[192:195], v[120:123], v[16:31]
  ds_read_b64_tr_b16 v[184:185], v228 offset:9216
  ds_read_b64_tr_b16 v[186:187], v228 offset:10752
  v_mfma_f32_32x32x16_bf16 v[32:47], v[196:199], v[120:123], v[32:47]
  ds_read_b64_tr_b16 v[188:189], v228 offset:9280
  ds_read_b64_tr_b16 v[190:191], v228 offset:10816
  s_waitcnt lgkmcnt(8)
  v_mfma_f32_32x32x16_bf16 v[48:63], v[200:203], v[120:123], v[48:63]
  ds_read_b64_tr_b16 v[192:193], v228 offset:9344
  ds_read_b64_tr_b16 v[194:195], v228 offset:10880
  s_add_u32 s36, s42, 16384
  buffer_load_dwordx4 v[116:119], v1, s[24:27], s36 offen offset:1024 sc1
  v_mfma_f32_32x32x16_bf16 v[64:79], v[204:207], v[120:123], v[64:79]
  ds_read_b64_tr_b16 v[196:197], v228 offset:21504
  ds_read_b64_tr_b16 v[198:199], v228 offset:23040
  s_waitcnt lgkmcnt(8)
  v_mfma_f32_32x32x16_bf16 v[80:95], v[176:179], v[120:123], v[80:95]
  ds_read_b64_tr_b16 v[200:201], v228 offset:21568
  ds_read_b64_tr_b16 v[202:203], v228 offset:23104
  v_mfma_f32_32x32x16_bf16 v[96:111], v[180:183], v[120:123], v[96:111]
  ds_read_b64_tr_b16 v[204:205], v228 offset:21632
  ds_read_b64_tr_b16 v[206:207], v228 offset:23168
  s_waitcnt lgkmcnt(8)
  v_mfma_f32_32x32x16_bf16 v[16:31], v[184:187], v[124:127], v[16:31]
  ds_read_b64_tr_b16 v[176:177], v228 offset:24576
  ds_read_b64_tr_b16 v[178:179], v228 offset:26112
  v_mfma_f32_32x32x16_bf16 v[32:47], v[188:191], v[124:127], v[32:47]
  ds_read_b64_tr_b16 v[180:181], v228 offset:24640
  ds_read_b64_tr_b16 v[182:183], v228 offset:26176
  s_waitcnt lgkmcnt(8)
  v_mfma_f32_32x32x16_bf16 v[48:63], v[192:195], v[124:127], v[48:63]
  ds_read_b64_tr_b16 v[184:185], v228 offset:24704
  ds_read_b64_tr_b16 v[186:187], v228 offset:26240
  s_add_u32 s36, s42, 16384
  buffer_load_dwordx4 v[120:123], v1, s[24:27], s36 offen offset:2048 sc1
  v_mfma_f32_32x32x16_bf16 v[64:79], v[196:199], v[124:127], v[64:79]
  ds_read_b64_tr_b16 v[188:189], v228 offset:36864
  ds_read_b64_tr_b16 v[190:191], v228 offset:38400
  s_waitcnt lgkmcnt(8)
  v_mfma_f32_32x32x16_bf16 v[80:95], v[200:203], v[124:127], v[80:95]
  ds_read_b64_tr_b16 v[192:193], v228 offset:36928
  ds_read_b64_tr_b16 v[194:195], v228 offset:38464
  s_waitcnt vmcnt(14)
  v_cmp_eq_u32 vcc, -1, v128
  s_cbranch_vccnz k2_ry4
k2_ry4r:
  v_mfma_f32_32x32x16_bf16 v[96:111], v[204:207], v[124:127], v[96:111]
  s_barrier
  ds_read_b64_tr_b16 v[196:197], v228 offset:36992
  ds_read_b64_tr_b16 v[198:199], v228 offset:38528
  s_waitcnt lgkmcnt(8)
  v_mfma_f32_32x32x16_bf16 v[16:31], v[176:179], v[128:131], v[16:31]
  ds_read_b64_tr_b16 v[200:201], v228 offset:27648
  ds_read_b64_tr_b16 v[202:203], v228 offset:29184
  v_mfma_f32_32x32x16_bf16 v[32:47], v[180:183], v[128:131], v[32:47]
  ds_read_b64_tr_b16 v[204:205], v228 offset:27712
  ds_read_b64_tr_b16 v[206:207], v228 offset:29248
  s_waitcnt lgkmcnt(8)
  v_mfma_f32_32x32x16_bf16 v[48:63], v[184:187], v[128:131], v[48:63]
  ds_read_b64_tr_b16 v[176:177], v228 offset:27776
  ds_read_b64_tr_b16 v[178:179], v228 offset:29312
  s_add_u32 s36, s42, 16384
  buffer_load_dwordx4 v[124:127], v1, s[24:27], s36 offen offset:3072 sc1
  v_mfma_f32_32x32x16_bf16 v[64:79], v[188:191], v[128:131], v[64:79]
  ds_read_b64_tr_b16 v[180:181], v228 offset:39936
  ds_read_b64_tr_b16 v[182:183], v228 offset:41472
  s_waitcnt lgkmcnt(8)
  v_mfma_f32_32x32x16_bf16 v[80:95], v[192:195], v[128:131], v[80:95]
  ds_read_b64_tr_b16 v[184:185], v228 offset:40000
  ds_read_b64_tr_b16 v[186:187], v228 offset:41536
  s_waitcnt vmcnt(14)
  v_cmp_eq_u32 vcc, -1, v132
  s_cbranch_vccnz k2_ry5
k2_ry5r:
  v_mfma_f32_32x32x16_bf16 v[96:111], v[196:199], v[128:131], v[96:111]
  ds_read_b64_tr_b16 v[188:189], v228 offset:40064
  ds_read_b64_tr_b16 v[190:191], v228 offset:41600
  s_waitcnt lgkmcnt(8)
  v_mfma_f32_32x32x16_bf16 v[16:31], v[200:203], v[132:135], v[16:31]
  ds_read_b64_tr_b16 v[192:193], v228 offset:30720
  ds_read_b64_tr_b16 v[194:195], v228 offset:32256
  v_mfma_f32_32x32x16_bf16 v[32:47], v[204:207], v[132:135], v[32:47]
  ds_read_b64_tr_b16 v[196:197], v228 offset:30784
  ds_read_b64_tr_b16 v[198:199], v228 offset:32320
  s_waitcnt lgkmcnt(8)
  v_mfma_f32_32x32x16_bf16 v[48:63], v[176:179], v[132:135], v[48:63]
  ds_read_b64_tr_b16 v[200:201], v228 offset:30848
  ds_read_b64_tr_b16 v[202:203], v228 offset:32384
  s_add_u32 s36, s42, 20480
  buffer_load_dwordx4 v[128:131], v1, s[24:27], s36 offen offset:0 sc1
  v_mfma_f32_32x32x16_bf16 v[64:79], v[180:183], v[132:135], v[64:79]
  ds_read_b64_tr_b16 v[204:205], v228 offset:43008
  ds_read_b64_tr_b16 v[206:207], v228 offset:44544
  s_waitcnt lgkmcnt(8)
  v_mfma_f32_32x32x16_bf16 v[80:95], v[184:187], v[132:135], v[80:95]
  ds_read_b64_tr_b16 v[176:177], v228 offset:43072
  ds_read_b64_tr_b16 v[178:179], v228 offset:44608
  s_waitcnt vmcnt(14)
  v_cmp_eq_u32 vcc, -1, v136
  s_cbranch_vccnz k2_ry6
k2_ry6r:
  v_mfma_f32_32x32x16_bf16 v[96:111], v[188:191], v[132:135], v[96:111]
  ds_read_b64_tr_b16 v[180:181], v228 offset:43136
  ds_read_b64_tr_b16 v[182:183], v228 offset:44672
  s_waitcnt lgkmcnt(8)
  v_mfma_f32_32x32x16_bf16 v[16:31], v[192:195], v[136:139], v[16:31]
  ds_read_b64_tr_b16 v[184:185], v228 offset:33792
  ds_read_b64_tr_b16 v[186:187], v228 offset:35328
  v_mfma_f32_32x32x16_bf16 v[32:47], v[196:199], v[136:139], v[32:47]
  ds_read_b64_tr_b16 v[188:189], v228 offset:33856
  ds_read_b64_tr_b16 v[190:191], v228 offset:35392
  s_waitcnt lgkmcnt(8)
  v_mfma_f32_32x32x16_bf16 v[48:63], v[200:203], v[136:139], v[48:63]
  ds_read_b64_tr_b16 v[192:193], v228 offset:33920
  ds_read_b64_tr_b16 v[194:195], v228 offset:35456
  s_add_u32 s36, s42, 20480
  buffer_load_dwordx4 v[132:135], v1, s[24:27], s36 offen offset:1024 sc1
  v_mfma_f32_32x32x16_bf16 v[64:79], v[204:207], v[136:139], v[64:79]
  ds_read_b64_tr_b16 v[196:197], v228 offset:46080
  ds_read_b64_tr_b16 v[198:199], v228 offset:47616
  s_waitcnt lgkmcnt(8)
  v_mfma_f32_32x32x16_bf16 v[80:95], v[176:179], v[136:139], v[80:95]
  ds_read_b64_tr_b16 v[200:201], v228 offset:46144
  ds_read_b64_tr_b16 v[202:203], v228 offset:47680
  s_waitcnt vmcnt(14)
  v_cmp_eq_u32 vcc, -1, v140
  s_cbranch_vccnz k2_ry7
k2_ry7r:
  v_mfma_f32_32x32x16_bf16 v[96:111], v[180:183], v[136:139], v[96:111]
  ds_read_b64_tr_b16 v[204:205], v228 offset:46208
  ds_read_b64_tr_b16 v[206:207], v228 offset:47744
  s_waitcnt lgkmcnt(8)
  v_mfma_f32_32x32x16_bf16 v[16:31], v[184:187], v[140:143], v[16:31]
  ds_read_b64_tr_b16 v[176:177], v229 offset:0
  ds_read_b64_tr_b16 v[178:179], v229 offset:1536
  v_mfma_f32_32x32x16_bf16 v[32:47], v[188:191], v[140:143], v[32:47]
  ds_read_b64_tr_b16 v[180:181], v229 offset:64
  ds_read_b64_tr_b16 v[182:183], v229 offset:1600
  s_waitcnt lgkmcnt(8)
  v_mfma_f32_32x32x16_bf16 v[48:63], v[192:195], v[140:143], v[48:63]
  ds_read_b64_tr_b16 v[184:185], v229 offset:128
  ds_read_b64_tr_b16 v[186:187], v229 offset:1664
  s_add_u32 s36, s42, 20480
  buffer_load_dwordx4 v[136:139], v1, s[24:27], s36 offen offset:2048 sc1
  v_mfma_f32_32x32x16_bf16 v[64:79], v[196:199], v[140:143], v[64:79]
  ds_read_b64_tr_b16 v[188:189], v229 offset:12288
  ds_read_b64_tr_b16 v[190:191], v229 offset:13824
  s_waitcnt lgkmcnt(8)
  v_mfma_f32_32x32x16_bf16 v[80:95], v[200:203], v[140:143], v[80:95]
  ds_read_b64_tr_b16 v[192:193], v229 offset:12352
  ds_read_b64_tr_b16 v[194:195], v229 offset:13888
  s_waitcnt vmcnt(14)
  v_cmp_eq_u32 vcc, -1, v144
  s_cbranch_vccnz k2_ry8
k2_ry8r:
  v_mfma_f32_32x32x16_bf16 v[96:111], v[204:207], v[140:143], v[96:111]
  s_barrier
  ds_read_b64_tr_b16 v[196:197], v229 offset:12416
  ds_read_b64_tr_b16 v[198:199], v229 offset:13952
  s_waitcnt lgkmcnt(8)
  v_mfma_f32_32x32x16_bf16 v[16:31], v[176:179], v[144:147], v[16:31]
  ds_read_b64_tr_b16 v[200:201], v229 offset:3072
  ds_read_b64_tr_b16 v[202:203], v229 offset:4608
  v_mfma_f32_32x32x16_bf16 v[32:47], v[180:183], v[144:147], v[32:47]
  ds_read_b64_tr_b16 v[204:205], v229 offset:3136
  ds_read_b64_tr_b16 v[206:207], v229 offset:4672
  s_waitcnt lgkmcnt(8)
  v_mfma_f32_32x32x16_bf16 v[48:63], v[184:187], v[144:147], v[48:63]
  ds_read_b64_tr_b16 v[176:177], v229 offset:3200
  ds_read_b64_tr_b16 v[178:179], v229 offset:4736
  s_add_u32 s36, s42, 20480
  buffer_load_dwordx4 v[140:143], v1, s[24:27], s36 offen offset:3072 sc1
  v_mfma_f32_32x32x16_bf16 v[64:79], v[188:191], v[144:147], v[64:79]
  ds_read_b64_tr_b16 v[180:181], v229 offset:15360
  ds_read_b64_tr_b16 v[182:183], v229 offset:16896
  s_waitcnt lgkmcnt(8)
  v_mfma_f32_32x32x16_bf16 v[80:95], v[192:195], v[144:147], v[80:95]
  ds_read_b64_tr_b16 v[184:185], v229 offset:15424
  ds_read_b64_tr_b16 v[186:187], v229 offset:16960
  s_waitcnt vmcnt(14)
  v_cmp_eq_u32 vcc, -1, v148
  s_cbranch_vccnz k2_ry9
k2_ry9r:
  v_mfma_f32_32x32x16_bf16 v[96:111], v[196:199], v[144:147], v[96:111]
  ds_read_b64_tr_b16 v[188:189], v229 offset:15488
  ds_read_b64_tr_b16 v[190:191], v229 offset:17024
  s_waitcnt lgkmcnt(8)
  v_mfma_f32_32x32x16_bf16 v[16:31], v[200:203], v[148:151], v[16:31]
  ds_read_b64_tr_b16 v[192:193], v229 offset:6144
  ds_read_b64_tr_b16 v[194:195], v229 offset:7680
  v_mfma_f32_32x32x16_bf16 v[32:47], v[204:207], v[148:151], v[32:47]
  ds_read_b64_tr_b16 v[196:197], v229 offset:6208
  ds_read_b64_tr_b16 v[198:199], v229 offset:7744
  s_waitcnt lgkmcnt(8)
  v_mfma_f32_32x32x16_bf16 v[48:63], v[176:179], v[148:151], v[48:63]
  ds_read_b64_tr_b16 v[200:201], v229 offset:6272
  ds_read_b64_tr_b16 v[202:203], v229 offset:7808
  s_add_u32 s36, s42, 24576
  buffer_load_dwordx4 v[144:147], v1, s[24:27], s36 offen offset:0 sc1
  v_mfma_f32_32x32x16_bf16 v[64:79], v[180:183], v[148:151], v[64:79]
  ds_read_b64_tr_b16 v[204:205], v229 offset:18432
  ds_read_b64_tr_b16 v[206:207], v229 offset:19968
  s_waitcnt lgkmcnt(8)
  v_mfma_f32_32x32x16_bf16 v[80:95], v[184:187], v[148:151], v[80:95]
  ds_read_b64_tr_b16 v[176:177], v229 offset:18496
  ds_read_b64_tr_b16 v[178:179], v229 offset:20032
  s_waitcnt vmcnt(14)
  v_cmp_eq_u32 vcc, -1, v152
  s_cbranch_vccnz k2_ry10
k2_ry10r:
  v_mfma_f32_32x32x16_bf16 v[96:111], v[188:191], v[148:151], v[96:111]
  ds_read_b64_tr_b16 v[180:181], v229 offset:18560
  ds_read_b64_tr_b16 v[182:183], v229 offset:20096
  s_waitcnt lgkmcnt(8)
  v_mfma_f32_32x32x16_bf16 v[16:31], v[192:195], v[152:155], v[16:31]
  ds_read_b64_tr_b16 v[184:185], v229 offset:9216
  ds_read_b64_tr_b16 v[186:187], v229 offset:10752
  v_mfma_f32_32x32x16_bf16 v[32:47], v[196:199], v[152:155], v[32:47]
  ds_read_b64_tr_b16 v[188:189], v229 offset:9280
  ds_read_b64_tr_b16 v[190:191], v229 offset:10816
  s_waitcnt lgkmcnt(8)
  v_mfma_f32_32x32x16_bf16 v[48:63], v[200:203], v[152:155], v[48:63]
  ds_read_b64_tr_b16 v[192:193], v229 offset:9344
  ds_read_b64_tr_b16 v[194:195], v229 offset:10880
  s_add_u32 s36, s42, 24576
  buffer_load_dwordx4 v[148:151], v1, s[24:27], s36 offen offset:1024 sc1
  v_mfma_f32_32x32x16_bf16 v[64:79], v[204:207], v[152:155], v[64:79]
  ds_read_b64_tr_b16 v[196:197], v229 offset:21504
  ds_read_b64_tr_b16 v[198:199], v229 offset:23040
  s_waitcnt lgkmcnt(8)
  v_mfma_f32_32x32x16_bf16 v[80:95], v[176:179], v[152:155], v[80:95]
  ds_read_b64_tr_b16 v[200:201], v229 offset:21568
  ds_read_b64_tr_b16 v[202:203], v229 offset:23104
  s_waitcnt vmcnt(14)
  v_cmp_eq_u32 vcc, -1, v156
  s_cbranch_vccnz k2_ry11
k2_ry11r:
  v_mfma_f32_32x32x16_bf16 v[96:111], v[180:183], v[152:155], v[96:111]
  ds_read_b64_tr_b16 v[204:205], v229 offset:21632
  ds_read_b64_tr_b16 v[206:207], v229 offset:23168
  s_waitcnt lgkmcnt(8)
  v_mfma_f32_32x32x16_bf16 v[16:31], v[184:187], v[156:159], v[16:31]
  ds_read_b64_tr_b16 v[176:177], v229 offset:24576
  ds_read_b64_tr_b16 v[178:179], v229 offset:26112
  v_mfma_f32_32x32x16_bf16 v[32:47], v[188:191], v[156:159], v[32:47]
  ds_read_b64_tr_b16 v[180:181], v229 offset:24640
  ds_read_b64_tr_b16 v[182:183], v229 offset:26176
  s_waitcnt lgkmcnt(8)
  v_mfma_f32_32x32x16_bf16 v[48:63], v[192:195], v[156:159], v[48:63]
  ds_read_b64_tr_b16 v[184:185], v229 offset:24704
  ds_read_b64_tr_b16 v[186:187], v229 offset:26240
  s_add_u32 s36, s42, 24576
  buffer_load_dwordx4 v[152:155], v1, s[24:27], s36 offen offset:2048 sc1
  v_mfma_f32_32x32x16_bf16 v[64:79], v[196:199], v[156:159], v[64:79]
  ds_read_b64_tr_b16 v[188:189], v229 offset:36864
  ds_read_b64_tr_b16 v[190:191], v229 offset:38400
  s_waitcnt lgkmcnt(8)
  v_mfma_f32_32x32x16_bf16 v[80:95], v[200:203], v[156:159], v[80:95]
  ds_read_b64_tr_b16 v[192:193], v229 offset:36928
  ds_read_b64_tr_b16 v[194:195], v229 offset:38464
  s_waitcnt vmcnt(14)
  v_cmp_eq_u32 vcc, -1, v160
  s_cbranch_vccnz k2_ry12
k2_ry12r:
  v_mfma_f32_32x32x16_bf16 v[96:111], v[204:207], v[156:159], v[96:111]
  ds_read_b64_tr_b16 v[196:197], v229 offset:36992
  ds_read_b64_tr_b16 v[198:199], v229 offset:38528
  s_waitcnt lgkmcnt(8)
  v_mfma_f32_32x32x16_bf16 v[16:31], v[176:179], v[160:163], v[16:31]
  ds_read_b64_tr_b16 v[200:201], v229 offset:27648
  ds_read_b64_tr_b16 v[202:203], v229 offset:29184
  v_mfma_f32_32x32x16_bf16 v[32:47], v[180:183], v[160:163], v[32:47]
  ds_read_b64_tr_b16 v[204:205], v229 offset:27712
  ds_read_b64_tr_b16 v[206:207], v229 offset:29248
  s_waitcnt lgkmcnt(8)
  v_mfma_f32_32x32x16_bf16 v[48:63], v[184:187], v[160:163], v[48:63]
  ds_read_b64_tr_b16 v[176:177], v229 offset:27776
  ds_read_b64_tr_b16 v[178:179], v229 offset:29312
  s_add_u32 s36, s42, 24576
  buffer_load_dwordx4 v[156:159], v1, s[24:27], s36 offen offset:3072 sc1
  v_mfma_f32_32x32x16_bf16 v[64:79], v[188:191], v[160:163], v[64:79]
  ds_read_b64_tr_b16 v[180:181], v229 offset:39936
  ds_read_b64_tr_b16 v[182:183], v229 offset:41472
  s_waitcnt lgkmcnt(8)
  v_mfma_f32_32x32x16_bf16 v[80:95], v[192:195], v[160:163], v[80:95]
  ds_read_b64_tr_b16 v[184:185], v229 offset:40000
  ds_read_b64_tr_b16 v[186:187], v229 offset:41536
  s_waitcnt vmcnt(14)
  v_cmp_eq_u32 vcc, -1, v164
  s_cbranch_vccnz k2_ry13
k2_ry13r:
  v_mfma_f32_32x32x16_bf16 v[96:111], v[196:199], v[160:163], v[96:111]
  ds_read_b64_tr_b16 v[188:189], v229 offset:40064
  ds_read_b64_tr_b16 v[190:191], v229 offset:41600
  s_waitcnt lgkmcnt(8)
  v_mfma_f32_32x32x16_bf16 v[16:31], v[200:203], v[164:167], v[16:31]
  ds_read_b64_tr_b16 v[192:193], v229 offset:30720
  ds_read_b64_tr_b16 v[194:195], v229 offset:32256
  v_mfma_f32_32x32x16_bf16 v[32:47], v[204:207], v[164:167], v[32:47]
  ds_read_b64_tr_b16 v[196:197], v229 offset:30784
  ds_read_b64_tr_b16 v[198:199], v229 offset:32320
  s_waitcnt lgkmcnt(8)
  v_mfma_f32_32x32x16_bf16 v[48:63], v[176:179], v[164:167], v[48:63]
  ds_read_b64_tr_b16 v[200:201], v229 offset:30848
  ds_read_b64_tr_b16 v[202:203], v229 offset:32384
  s_add_u32 s36, s42, 28672
  buffer_load_dwordx4 v[160:163], v1, s[24:27], s36 offen offset:0 sc1
  v_mfma_f32_32x32x16_bf16 v[64:79], v[180:183], v[164:167], v[64:79]
  ds_read_b64_tr_b16 v[204:205], v229 offset:43008
  ds_read_b64_tr_b16 v[206:207], v229 offset:44544
  s_waitcnt lgkmcnt(8)
  v_mfma_f32_32x32x16_bf16 v[80:95], v[184:187], v[164:167], v[80:95]
  ds_read_b64_tr_b16 v[176:177], v229 offset:43072
  ds_read_b64_tr_b16 v[178:179], v229 offset:44608
  s_waitcnt vmcnt(14)
  v_cmp_eq_u32 vcc, -1, v168
  s_cbranch_vccnz k2_ry14
k2_ry14r:
  v_mfma_f32_32x32x16_bf16 v[96:111], v[188:191], v[164:167], v[96:111]
  ds_read_b64_tr_b16 v[180:181], v229 offset:43136
  ds_read_b64_tr_b16 v[182:183], v229 offset:44672
  s_waitcnt lgkmcnt(8)
  v_mfma_f32_32x32x16_bf16 v[16:31], v[192:195], v[168:171], v[16:31]
  ds_read_b64_tr_b16 v[184:185], v229 offset:33792
  ds_read_b64_tr_b16 v[186:187], v229 offset:35328
  v_mfma_f32_32x32x16_bf16 v[32:47], v[196:199], v[168:171], v[32:47]
  ds_read_b64_tr_b16 v[188:189], v229 offset:33856
  ds_read_b64_tr_b16 v[190:191], v229 offset:35392
  s_waitcnt lgkmcnt(8)
  v_mfma_f32_32x32x16_bf16 v[48:63], v[200:203], v[168:171], v[48:63]
  ds_read_b64_tr_b16 v[192:193], v229 offset:33920
  ds_read_b64_tr_b16 v[194:195], v229 offset:35456
  s_add_u32 s36, s42, 28672
  buffer_load_dwordx4 v[164:167], v1, s[24:27], s36 offen offset:1024 sc1
  v_mfma_f32_32x32x16_bf16 v[64:79], v[204:207], v[168:171], v[64:79]
  ds_read_b64_tr_b16 v[196:197], v229 offset:46080
  ds_read_b64_tr_b16 v[198:199], v229 offset:47616
  s_waitcnt lgkmcnt(8)
  v_mfma_f32_32x32x16_bf16 v[80:95], v[176:179], v[168:171], v[80:95]
  ds_read_b64_tr_b16 v[200:201], v229 offset:46144
  ds_read_b64_tr_b16 v[202:203], v229 offset:47680
  s_waitcnt vmcnt(14)
  v_cmp_eq_u32 vcc, -1, v172
  s_cbranch_vccnz k2_ry15
k2_ry15r:
  v_mfma_f32_32x32x16_bf16 v[96:111], v[180:183], v[168:171], v[96:111]
  ds_read_b64_tr_b16 v[204:205], v229 offset:46208
  ds_read_b64_tr_b16 v[206:207], v229 offset:47744
  s_waitcnt lgkmcnt(8)
  v_mfma_f32_32x32x16_bf16 v[16:31], v[184:187], v[172:175], v[16:31]
  ds_read_b64_tr_b16 v[176:177], v230 offset:0
  ds_read_b64_tr_b16 v[178:179], v230 offset:1536
  v_mfma_f32_32x32x16_bf16 v[32:47], v[188:191], v[172:175], v[32:47]
  ds_read_b64_tr_b16 v[180:181], v230 offset:64
  ds_read_b64_tr_b16 v[182:183], v230 offset:1600
  s_waitcnt lgkmcnt(8)
  v_mfma_f32_32x32x16_bf16 v[48:63], v[192:195], v[172:175], v[48:63]
  ds_read_b64_tr_b16 v[184:185], v230 offset:128
  ds_read_b64_tr_b16 v[186:187], v230 offset:1664
  s_add_u32 s36, s42, 28672
  buffer_load_dwordx4 v[168:171], v1, s[24:27], s36 offen offset:2048 sc1
  v_mfma_f32_32x32x16_bf16 v[64:79], v[196:199], v[172:175], v[64:79]
  ds_read_b64_tr_b16 v[188:189], v230 offset:12288
  ds_read_b64_tr_b16 v[190:191], v230 offset:13824
  s_waitcnt lgkmcnt(8)
  v_mfma_f32_32x32x16_bf16 v[80:95], v[200:203], v[172:175], v[80:95]
  ds_read_b64_tr_b16 v[192:193], v230 offset:12352
  ds_read_b64_tr_b16 v[194:195], v230 offset:13888
  s_waitcnt vmcnt(14)
  v_cmp_eq_u32 vcc, -1, v112
  s_cbranch_vccnz k2_ry16
k2_ry16r:
  v_mfma_f32_32x32x16_bf16 v[96:111], v[204:207], v[172:175], v[96:111]
  s_barrier
  ds_read_b64_tr_b16 v[196:197], v230 offset:12416
  ds_read_b64_tr_b16 v[198:199], v230 offset:13952
  s_waitcnt lgkmcnt(8)
  v_mfma_f32_32x32x16_bf16 v[16:31], v[176:179], v[112:115], v[16:31]
  ds_read_b64_tr_b16 v[200:201], v230 offset:3072
  ds_read_b64_tr_b16 v[202:203], v230 offset:4608
  v_mfma_f32_32x32x16_bf16 v[32:47], v[180:183], v[112:115], v[32:47]
  ds_read_b64_tr_b16 v[204:205], v230 offset:3136
  ds_read_b64_tr_b16 v[206:207], v230 offset:4672
  s_waitcnt lgkmcnt(8)
  v_mfma_f32_32x32x16_bf16 v[48:63], v[184:187], v[112:115], v[48:63]
  ds_read_b64_tr_b16 v[176:177], v230 offset:3200
  ds_read_b64_tr_b16 v[178:179], v230 offset:4736
  s_add_u32 s36, s42, 28672
  buffer_load_dwordx4 v[172:175], v1, s[24:27], s36 offen offset:3072 sc1
  v_mfma_f32_32x32x16_bf16 v[64:79], v[188:191], v[112:115], v[64:79]
  ds_read_b64_tr_b16 v[180:181], v230 offset:15360
  ds_read_b64_tr_b16 v[182:183], v230 offset:16896
  s_waitcnt lgkmcnt(8)
  v_mfma_f32_32x32x16_bf16 v[80:95], v[192:195], v[112:115], v[80:95]
  ds_read_b64_tr_b16 v[184:185], v230 offset:15424
  ds_read_b64_tr_b16 v[186:187], v230 offset:16960
  s_waitcnt vmcnt(14)
  v_cmp_eq_u32 vcc, -1, v116
  s_cbranch_vccnz k2_ry17
k2_ry17r:
  v_mfma_f32_32x32x16_bf16 v[96:111], v[196:199], v[112:115], v[96:111]
  ds_read_b64_tr_b16 v[188:189], v230 offset:15488
  ds_read_b64_tr_b16 v[190:191], v230 offset:17024
  s_waitcnt lgkmcnt(8)
  v_mfma_f32_32x32x16_bf16 v[16:31], v[200:203], v[116:119], v[16:31]
  ds_read_b64_tr_b16 v[192:193], v230 offset:6144
  ds_read_b64_tr_b16 v[194:195], v230 offset:7680
  v_mfma_f32_32x32x16_bf16 v[32:47], v[204:207], v[116:119], v[32:47]
  ds_read_b64_tr_b16 v[196:197], v230 offset:18432
  ds_read_b64_tr_b16 v[198:199], v230 offset:19968
  s_waitcnt lgkmcnt(8)
  v_mfma_f32_32x32x16_bf16 v[48:63], v[176:179], v[116:119], v[48:63]
  ds_read_b64_tr_b16 v[200:201], v230 offset:9216
  ds_read_b64_tr_b16 v[202:203], v230 offset:10752
  v_mfma_f32_32x32x16_bf16 v[64:79], v[180:183], v[116:119], v[64:79]
  ds_read_b64_tr_b16 v[204:205], v230 offset:21504
  ds_read_b64_tr_b16 v[206:207], v230 offset:23040
  s_waitcnt lgkmcnt(8)
  v_mfma_f32_32x32x16_bf16 v[80:95], v[184:187], v[116:119], v[80:95]
  ds_read_b64_tr_b16 v[176:177], v230 offset:24576
  ds_read_b64_tr_b16 v[178:179], v230 offset:26112
  s_waitcnt vmcnt(13)
  v_cmp_eq_u32 vcc, -1, v120
  s_cbranch_vccnz k2_ry18
k2_ry18r:
  v_mfma_f32_32x32x16_bf16 v[96:111], v[188:191], v[116:119], v[96:111]
  ds_read_b64_tr_b16 v[180:181], v230 offset:36864
  ds_read_b64_tr_b16 v[182:183], v230 offset:38400
  s_waitcnt lgkmcnt(8)
  v_mfma_f32_32x32x16_bf16 v[16:31], v[192:195], v[120:123], v[16:31]
  ds_read_b64_tr_b16 v[184:185], v230 offset:27648
  ds_read_b64_tr_b16 v[186:187], v230 offset:29184
  s_waitcnt vmcnt(12)
  v_cmp_eq_u32 vcc, -1, v124
  s_cbranch_vccnz k2_ry19
k2_ry19r:
  v_mfma_f32_32x32x16_bf16 v[64:79], v[196:199], v[120:123], v[64:79]
  ds_read_b64_tr_b16 v[188:189], v230 offset:39936
  ds_read_b64_tr_b16 v[190:191], v230 offset:41472
  s_waitcnt lgkmcnt(8)
  v_mfma_f32_32x32x16_bf16 v[16:31], v[200:203], v[124:127], v[16:31]
  ds_read_b64_tr_b16 v[192:193], v230 offset:30720
  ds_read_b64_tr_b16 v[194:195], v230 offset:32256
  s_waitcnt vmcnt(11)
  v_cmp_eq_u32 vcc, -1, v128
  s_cbranch_vccnz k2_ry20
k2_ry20r:
  v_mfma_f32_32x32x16_bf16 v[64:79], v[204:207], v[124:127], v[64:79]
  ds_read_b64_tr_b16 v[196:197], v230 offset:43008
  ds_read_b64_tr_b16 v[198:199], v230 offset:44544
  s_waitcnt lgkmcnt(8)
  v_mfma_f32_32x32x16_bf16 v[16:31], v[176:179], v[128:131], v[16:31]
  ds_read_b64_tr_b16 v[200:201], v230 offset:33792
  ds_read_b64_tr_b16 v[202:203], v230 offset:35328
  s_waitcnt vmcnt(10)
  v_cmp_eq_u32 vcc, -1, v132
  s_cbranch_vccnz k2_ry21
k2_ry21r:
  v_mfma_f32_32x32x16_bf16 v[64:79], v[180:183], v[128:131], v[64:79]
  ds_read_b64_tr_b16 v[204:205], v230 offset:46080
  ds_read_b64_tr_b16 v[206:207], v230 offset:47616
  s_waitcnt lgkmcnt(8)
  v_mfma_f32_32x32x16_bf16 v[16:31], v[184:187], v[132:135], v[16:31]
  ds_read_b64_tr_b16 v[176:177], v228 offset:0
  ds_read_b64_tr_b16 v[178:179], v228 offset:1536
  s_waitcnt vmcnt(9)
  v_cmp_eq_u32 vcc, -1, v136
  s_cbranch_vccnz k2_ry22
k2_ry22r:
  v_mfma_f32_32x32x16_bf16 v[64:79], v[188:191], v[132:135], v[64:79]
  ds_read_b64_tr_b16 v[180:181], v228 offset:12288
  ds_read_b64_tr_b16 v[182:183], v228 offset:13824
  s_waitcnt lgkmcnt(8)
  v_mfma_f32_32x32x16_bf16 v[16:31], v[192:195], v[136:139], v[16:31]
  ds_read_b64_tr_b16 v[184:185], v228 offset:3072
  ds_read_b64_tr_b16 v[186:187], v228 offset:4608
  s_waitcnt vmcnt(8)
  v_cmp_eq_u32 vcc, -1, v140
  s_cbranch_vccnz k2_ry23
k2_ry23r:
  v_mfma_f32_32x32x16_bf16 v[64:79], v[196:199], v[136:139], v[64:79]
  ds_read_b64_tr_b16 v[188:189], v228 offset:15360
  ds_read_b64_tr_b16 v[190:191], v228 offset:16896
  s_waitcnt lgkmcnt(8)
  v_mfma_f32_32x32x16_bf16 v[16:31], v[200:203], v[140:143], v[16:31]
  ds_read_b64_tr_b16 v[192:193], v228 offset:6144
  ds_read_b64_tr_b16 v[194:195], v228 offset:7680
  s_waitcnt vmcnt(7)
  v_cmp_eq_u32 vcc, -1, v144
  s_cbranch_vccnz k2_ry24
k2_ry24r:
  v_mfma_f32_32x32x16_bf16 v[64:79], v[204:207], v[140:143], v[64:79]
  ds_read_b64_tr_b16 v[196:197], v228 offset:18432
  ds_read_b64_tr_b16 v[198:199], v228 offset:19968
  s_waitcnt lgkmcnt(8)
  v_mfma_f32_32x32x16_bf16 v[16:31], v[176:179], v[144:147], v[16:31]
  ds_read_b64_tr_b16 v[200:201], v228 offset:9216
  ds_read_b64_tr_b16 v[202:203], v228 offset:10752
  s_waitcnt vmcnt(6)
  v_cmp_eq_u32 vcc, -1, v148
  s_cbranch_vccnz k2_ry25
k2_ry25r:
  v_mfma_f32_32x32x16_bf16 v[64:79], v[180:183], v[144:147], v[64:79]
  ds_read_b64_tr_b16 v[204:205], v228 offset:21504
  ds_read_b64_tr_b16 v[206:207], v228 offset:23040
  s_waitcnt lgkmcnt(8)
  v_mfma_f32_32x32x16_bf16 v[16:31], v[184:187], v[148:151], v[16:31]
  ds_read_b64_tr_b16 v[176:177], v228 offset:24576
  ds_read_b64_tr_b16 v[178:179], v228 offset:26112
  s_waitcnt vmcnt(5)
  v_cmp_eq_u32 vcc, -1, v152
  s_cbranch_vccnz k2_ry26
k2_ry26r:
  v_mfma_f32_32x32x16_bf16 v[64:79], v[188:191], v[148:151], v[64:79]
  ds_read_b64_tr_b16 v[180:181], v228 offset:36864
  ds_read_b64_tr_b16 v[182:183], v228 offset:38400
  s_waitcnt lgkmcnt(8)
  v_mfma_f32_32x32x16_bf16 v[16:31], v[192:195], v[152:155], v[16:31]
  ds_read_b64_tr_b16 v[184:185], v228 offset:27648
  ds_read_b64_tr_b16 v[186:187], v228 offset:29184
  s_waitcnt vmcnt(4)
  v_cmp_eq_u32 vcc, -1, v156
  s_cbranch_vccnz k2_ry27
k2_ry27r:
  v_mfma_f32_32x32x16_bf16 v[64:79], v[196:199], v[152:155], v[64:79]
  ds_read_b64_tr_b16 v[188:189], v228 offset:39936
  ds_read_b64_tr_b16 v[190:191], v228 offset:41472
  s_waitcnt lgkmcnt(8)
  v_mfma_f32_32x32x16_bf16 v[16:31], v[200:203], v[156:159], v[16:31]
  ds_read_b64_tr_b16 v[192:193], v228 offset:30720
  ds_read_b64_tr_b16 v[194:195], v228 offset:32256
  s_waitcnt vmcnt(3)
  v_cmp_eq_u32 vcc, -1, v160
  s_cbranch_vccnz k2_ry28
k2_ry28r:
  v_mfma_f32_32x32x16_bf16 v[64:79], v[204:207], v[156:159], v[64:79]
  ds_read_b64_tr_b16 v[196:197], v228 offset:43008
  ds_read_b64_tr_b16 v[198:199], v228 offset:44544
  s_waitcnt lgkmcnt(8)
  v_mfma_f32_32x32x16_bf16 v[16:31], v[176:179], v[160:163], v[16:31]
  ds_read_b64_tr_b16 v[200:201], v228 offset:33792
  ds_read_b64_tr_b16 v[202:203], v228 offset:35328
  s_waitcnt vmcnt(2)
  v_cmp_eq_u32 vcc, -1, v164
  s_cbranch_vccnz k2_ry29
k2_ry29r:
  v_mfma_f32_32x32x16_bf16 v[64:79], v[180:183], v[160:163], v[64:79]
  ds_read_b64_tr_b16 v[204:205], v228 offset:46080
  ds_read_b64_tr_b16 v[206:207], v228 offset:47616
  s_waitcnt lgkmcnt(8)
  v_mfma_f32_32x32x16_bf16 v[16:31], v[184:187], v[164:167], v[16:31]
  ds_read_b64_tr_b16 v[176:177], v230 offset:6208
  ds_read_b64_tr_b16 v[178:179], v230 offset:7744
  s_waitcnt vmcnt(1)
  v_cmp_eq_u32 vcc, -1, v168
  s_cbranch_vccnz k2_ry30
k2_ry30r:
  v_mfma_f32_32x32x16_bf16 v[64:79], v[188:191], v[164:167], v[64:79]
  ds_read_b64_tr_b16 v[180:181], v230 offset:18496
  ds_read_b64_tr_b16 v[182:183], v230 offset:20032
  s_waitcnt lgkmcnt(8)
  v_mfma_f32_32x32x16_bf16 v[16:31], v[192:195], v[168:171], v[16:31]
  ds_read_b64_tr_b16 v[184:185], v230 offset:9280
  ds_read_b64_tr_b16 v[186:187], v230 offset:10816
  s_waitcnt vmcnt(0)
  v_cmp_eq_u32 vcc, -1, v172
  s_cbranch_vccnz k2_ry31
k2_ry31r:
  v_mfma_f32_32x32x16_bf16 v[64:79], v[196:199], v[168:171], v[64:79]
  ds_read_b64_tr_b16 v[188:189], v230 offset:21568
  ds_read_b64_tr_b16 v[190:191], v230 offset:23104
  s_waitcnt lgkmcnt(8)
  v_mfma_f32_32x32x16_bf16 v[16:31], v[200:203], v[172:175], v[16:31]
  ds_read_b64_tr_b16 v[192:193], v230 offset:24640
  ds_read_b64_tr_b16 v[194:195], v230 offset:26176
  v_mfma_f32_32x32x16_bf16 v[64:79], v[204:207], v[172:175], v[64:79]
  ds_read_b64_tr_b16 v[196:197], v230 offset:36928
  ds_read_b64_tr_b16 v[198:199], v230 offset:38464
  s_waitcnt lgkmcnt(8)
  v_mfma_f32_32x32x16_bf16 v[32:47], v[176:179], v[120:123], v[32:47]
  ds_read_b64_tr_b16 v[200:201], v230 offset:27712
  ds_read_b64_tr_b16 v[202:203], v230 offset:29248
  v_mfma_f32_32x32x16_bf16 v[80:95], v[180:183], v[120:123], v[80:95]
  ds_read_b64_tr_b16 v[204:205], v230 offset:40000
  ds_read_b64_tr_b16 v[206:207], v230 offset:41536
  s_waitcnt lgkmcnt(8)
  v_mfma_f32_32x32x16_bf16 v[32:47], v[184:187], v[124:127], v[32:47]
  ds_read_b64_tr_b16 v[176:177], v230 offset:30784
  ds_read_b64_tr_b16 v[178:179], v230 offset:32320
  v_mul_f32 v208, v16, v16
  v_mul_f32 v209, v17, v17
  v_mul_f32 v210, v18, v18
  v_mul_f32 v211, v19, v19
  v_mul_f32 v212, v20, v20
  v_mul_f32 v213, v21, v21
  v_mul_f32 v214, v22, v22
  v_mfma_f32_32x32x16_bf16 v[80:95], v[188:191], v[124:127], v[80:95]
  ds_read_b64_tr_b16 v[180:181], v230 offset:43072
  ds_read_b64_tr_b16 v[182:183], v230 offset:44608
  v_mul_f32 v215, v23, v23
  v_fma_f32 v208, v208, s57, v232
  v_fma_f32 v209, v209, s57, v232
  v_fma_f32 v210, v210, s57, v232
  v_fma_f32 v211, v211, s57, v232
  v_fma_f32 v212, v212, s57, v232
  v_fma_f32 v213, v213, s57, v232
  s_waitcnt lgkmcnt(8)
  v_mfma_f32_32x32x16_bf16 v[32:47], v[192:195], v[128:131], v[32:47]
  ds_read_b64_tr_b16 v[184:185], v230 offset:33856
  ds_read_b64_tr_b16 v[186:187], v230 offset:35392
  v_fma_f32 v214, v214, s57, v232
  v_fma_f32 v215, v215, s57, v232
  v_mul_f32 v208, v208, v16
  v_mul_f32 v209, v209, v17
  v_mul_f32 v210, v210, v18
  v_mul_f32 v211, v211, v19
  v_mfma_f32_32x32x16_bf16 v[80:95], v[196:199], v[128:131], v[80:95]
  ds_read_b64_tr_b16 v[188:189], v230 offset:46144
  ds_read_b64_tr_b16 v[190:191], v230 offset:47680
  v_mul_f32 v212, v212, v20
  v_mul_f32 v213, v213, v21
  v_mul_f32 v214, v214, v22
  v_mul_f32 v215, v215, v23
  v_exp_f32 v208, v208
  v_exp_f32 v209, v209
  s_waitcnt lgkmcnt(8)
  v_mfma_f32_32x32x16_bf16 v[32:47], v[200:203], v[132:135], v[32:47]
  ds_read_b64_tr_b16 v[192:193], v228 offset:64
  ds_read_b64_tr_b16 v[194:195], v228 offset:1600
  v_exp_f32 v210, v210
  v_exp_f32 v211, v211
  v_exp_f32 v212, v212
  v_mfma_f32_32x32x16_bf16 v[80:95], v[204:207], v[132:135], v[80:95]
  ds_read_b64_tr_b16 v[196:197], v228 offset:12352
  ds_read_b64_tr_b16 v[198:199], v228 offset:13888
  v_exp_f32 v213, v213
  v_exp_f32 v214, v214
  v_exp_f32 v215, v215
  s_waitcnt lgkmcnt(8)
  v_mfma_f32_32x32x16_bf16 v[32:47], v[176:179], v[136:139], v[32:47]
  ds_read_b64_tr_b16 v[200:201], v228 offset:3136
  ds_read_b64_tr_b16 v[202:203], v228 offset:4672
  v_mul_f32 v16, v16, v64
  v_mul_f32 v17, v17, v65
  v_mul_f32 v18, v18, v66
  v_mul_f32 v19, v19, v67
  v_mul_f32 v20, v20, v68
  v_mul_f32 v21, v21, v69
  v_mfma_f32_32x32x16_bf16 v[80:95], v[180:183], v[136:139], v[80:95]
  ds_read_b64_tr_b16 v[204:205], v228 offset:15424
  ds_read_b64_tr_b16 v[206:207], v228 offset:16960
  v_mul_f32 v22, v22, v70
  v_mul_f32 v23, v23, v71
  v_add_f32 v208, 1.0, v208
  v_add_f32 v209, 1.0, v209
  v_add_f32 v210, 1.0, v210
  v_add_f32 v211, 1.0, v211
  v_add_f32 v212, 1.0, v212
  s_waitcnt lgkmcnt(8)
  v_mfma_f32_32x32x16_bf16 v[32:47], v[184:187], v[140:143], v[32:47]
  ds_read_b64_tr_b16 v[176:177], v228 offset:6208
  ds_read_b64_tr_b16 v[178:179], v228 offset:7744
  v_add_f32 v213, 1.0, v213
  v_add_f32 v214, 1.0, v214
  v_add_f32 v215, 1.0, v215
  v_rcp_f32 v208, v208
  v_rcp_f32 v209, v209
  v_mfma_f32_32x32x16_bf16 v[80:95], v[188:191], v[140:143], v[80:95]
  ds_read_b64_tr_b16 v[180:181], v228 offset:18496
  ds_read_b64_tr_b16 v[182:183], v228 offset:20032
  v_rcp_f32 v210, v210
  v_rcp_f32 v211, v211
  v_rcp_f32 v212, v212
  s_waitcnt lgkmcnt(8)
  v_mfma_f32_32x32x16_bf16 v[32:47], v[192:195], v[144:147], v[32:47]
  ds_read_b64_tr_b16 v[184:185], v228 offset:9280
  ds_read_b64_tr_b16 v[186:187], v228 offset:10816
  v_rcp_f32 v213, v213
  v_rcp_f32 v214, v214
  v_rcp_f32 v215, v215
  v_mfma_f32_32x32x16_bf16 v[80:95], v[196:199], v[144:147], v[80:95]
  ds_read_b64_tr_b16 v[188:189], v228 offset:21568
  ds_read_b64_tr_b16 v[190:191], v228 offset:23104
  v_mul_f32 v16, v16, v208
  v_mul_f32 v17, v17, v209
  v_mul_f32 v18, v18, v210
  v_mul_f32 v19, v19, v211
  v_mul_f32 v20, v20, v212
  v_mul_f32 v21, v21, v213
  v_mul_f32 v22, v22, v214
  s_waitcnt lgkmcnt(8)
  v_mfma_f32_32x32x16_bf16 v[32:47], v[200:203], v[148:151], v[32:47]
  ds_read_b64_tr_b16 v[192:193], v228 offset:24640
  ds_read_b64_tr_b16 v[194:195], v228 offset:26176
  v_mul_f32 v23, v23, v215
  v_cvt_pk_bf16_f32 v64, v16, v17
  v_cvt_pk_bf16_f32 v65, v18, v19
  v_cvt_pk_bf16_f32 v66, v20, v21
  v_cvt_pk_bf16_f32 v67, v22, v23
  s_add_u32 s35, s50, 0
  buffer_store_dwordx4 v[64:67], v231, s[24:27], s35 offen offset:0 sc1
  v_mfma_f32_32x32x16_bf16 v[80:95], v[204:207], v[148:151], v[80:95]
  ds_read_b64_tr_b16 v[196:197], v228 offset:36928
  ds_read_b64_tr_b16 v[198:199], v228 offset:38464
  v_mul_f32 v216, v24, v24
  v_mul_f32 v217, v25, v25
  v_mul_f32 v218, v26, v26
  v_mul_f32 v219, v27, v27
  v_mul_f32 v220, v28, v28
  v_mul_f32 v221, v29, v29
  v_mul_f32 v222, v30, v30
  s_waitcnt lgkmcnt(8)
  v_mfma_f32_32x32x16_bf16 v[32:47], v[176:179], v[152:155], v[32:47]
  ds_read_b64_tr_b16 v[200:201], v228 offset:27712
  ds_read_b64_tr_b16 v[202:203], v228 offset:29248
  v_mul_f32 v223, v31, v31
  v_fma_f32 v216, v216, s57, v232
  v_fma_f32 v217, v217, s57, v232
  v_fma_f32 v218, v218, s57, v232
  v_fma_f32 v219, v219, s57, v232
  v_fma_f32 v220, v220, s57, v232
  v_fma_f32 v221, v221, s57, v232
  v_mfma_f32_32x32x16_bf16 v[80:95], v[180:183], v[152:155], v[80:95]
  ds_read_b64_tr_b16 v[204:205], v228 offset:40000
  ds_read_b64_tr_b16 v[206:207], v228 offset:41536
  v_fma_f32 v222, v222, s57, v232
  v_fma_f32 v223, v223, s57, v232
  v_mul_f32 v216, v216, v24
  v_mul_f32 v217, v217, v25
  v_mul_f32 v218, v218, v26
  v_mul_f32 v219, v219, v27
  s_waitcnt lgkmcnt(8)
  v_mfma_f32_32x32x16_bf16 v[32:47], v[184:187], v[156:159], v[32:47]
  ds_read_b64_tr_b16 v[176:177], v228 offset:30784
  ds_read_b64_tr_b16 v[178:179], v228 offset:32320
  v_mul_f32 v220, v220, v28
  v_mul_f32 v221, v221, v29
  v_mul_f32 v222, v222, v30
  v_mul_f32 v223, v223, v31
  v_exp_f32 v216, v216
  v_exp_f32 v217, v217
  v_mfma_f32_32x32x16_bf16 v[80:95], v[188:191], v[156:159], v[80:95]
  ds_read_b64_tr_b16 v[180:181], v228 offset:43072
  ds_read_b64_tr_b16 v[182:183], v228 offset:44608
  v_exp_f32 v218, v218
  v_exp_f32 v219, v219
  v_exp_f32 v220, v220
  s_waitcnt lgkmcnt(8)
  v_mfma_f32_32x32x16_bf16 v[32:47], v[192:195], v[160:163], v[32:47]
  ds_read_b64_tr_b16 v[184:185], v228 offset:33856
  ds_read_b64_tr_b16 v[186:187], v228 offset:35392
  v_exp_f32 v221, v221
  v_exp_f32 v222, v222
  v_exp_f32 v223, v223
  v_mfma_f32_32x32x16_bf16 v[80:95], v[196:199], v[160:163], v[80:95]
  ds_read_b64_tr_b16 v[188:189], v228 offset:46144
  ds_read_b64_tr_b16 v[190:191], v228 offset:47680
  v_mul_f32 v24, v24, v72
  v_mul_f32 v25, v25, v73
  v_mul_f32 v26, v26, v74
  v_mul_f32 v27, v27, v75
  v_mul_f32 v28, v28, v76
  v_mul_f32 v29, v29, v77
  s_waitcnt lgkmcnt(8)
  v_mfma_f32_32x32x16_bf16 v[32:47], v[200:203], v[164:167], v[32:47]
  ds_read_b64_tr_b16 v[192:193], v230 offset:6272
  ds_read_b64_tr_b16 v[194:195], v230 offset:7808
  v_mul_f32 v30, v30, v78
  v_mul_f32 v31, v31, v79
  v_add_f32 v216, 1.0, v216
  v_add_f32 v217, 1.0, v217
  v_add_f32 v218, 1.0, v218
  v_add_f32 v219, 1.0, v219
  v_add_f32 v220, 1.0, v220
  v_mfma_f32_32x32x16_bf16 v[80:95], v[204:207], v[164:167], v[80:95]
  ds_read_b64_tr_b16 v[196:197], v230 offset:18560
  ds_read_b64_tr_b16 v[198:199], v230 offset:20096
  v_add_f32 v221, 1.0, v221
  v_add_f32 v222, 1.0, v222
  v_add_f32 v223, 1.0, v223
  v_rcp_f32 v216, v216
  v_rcp_f32 v217, v217
  s_waitcnt lgkmcnt(8)
  v_mfma_f32_32x32x16_bf16 v[32:47], v[176:179], v[168:171], v[32:47]
  ds_read_b64_tr_b16 v[200:201], v230 offset:9344
  ds_read_b64_tr_b16 v[202:203], v230 offset:10880
  v_rcp_f32 v218, v218
  v_rcp_f32 v219, v219
  v_rcp_f32 v220, v220
  v_mfma_f32_32x32x16_bf16 v[80:95], v[180:183], v[168:171], v[80:95]
  ds_read_b64_tr_b16 v[204:205], v230 offset:21632
  ds_read_b64_tr_b16 v[206:207], v230 offset:23168
  v_rcp_f32 v221, v221
  v_rcp_f32 v222, v222
  v_rcp_f32 v223, v223
  s_waitcnt lgkmcnt(8)
  v_mfma_f32_32x32x16_bf16 v[32:47], v[184:187], v[172:175], v[32:47]
  ds_read_b64_tr_b16 v[176:177], v230 offset:24704
  ds_read_b64_tr_b16 v[178:179], v230 offset:26240
  v_mul_f32 v24, v24, v216
  v_mul_f32 v25, v25, v217
  v_mul_f32 v26, v26, v218
  v_mul_f32 v27, v27, v219
  v_mul_f32 v28, v28, v220
  v_mul_f32 v29, v29, v221
  v_mul_f32 v30, v30, v222
  v_mfma_f32_32x32x16_bf16 v[80:95], v[188:191], v[172:175], v[80:95]
  ds_read_b64_tr_b16 v[180:181], v230 offset:36992
  ds_read_b64_tr_b16 v[182:183], v230 offset:38528
  v_mul_f32 v31, v31, v223
  v_cvt_pk_bf16_f32 v72, v24, v25
  v_cvt_pk_bf16_f32 v73, v26, v27
  v_cvt_pk_bf16_f32 v74, v28, v29
  v_cvt_pk_bf16_f32 v75, v30, v31
  s_add_u32 s35, s50, 0
  buffer_store_dwordx4 v[72:75], v231, s[24:27], s35 offen offset:512 sc1
  s_waitcnt lgkmcnt(8)
  v_mfma_f32_32x32x16_bf16 v[48:63], v[192:195], v[120:123], v[48:63]
  ds_read_b64_tr_b16 v[184:185], v230 offset:27776
  ds_read_b64_tr_b16 v[186:187], v230 offset:29312
  v_mfma_f32_32x32x16_bf16 v[96:111], v[196:199], v[120:123], v[96:111]
  ds_read_b64_tr_b16 v[188:189], v230 offset:40064
  ds_read_b64_tr_b16 v[190:191], v230 offset:41600
  s_waitcnt lgkmcnt(8)
  v_mfma_f32_32x32x16_bf16 v[48:63], v[200:203], v[124:127], v[48:63]
  ds_read_b64_tr_b16 v[192:193], v230 offset:30848
  ds_read_b64_tr_b16 v[194:195], v230 offset:32384
  v_mul_f32 v208, v32, v32
  v_mul_f32 v209, v33, v33
  v_mul_f32 v210, v34, v34
  v_mul_f32 v211, v35, v35
  v_mul_f32 v212, v36, v36
  v_mul_f32 v213, v37, v37
  v_mul_f32 v214, v38, v38
  v_mfma_f32_32x32x16_bf16 v[96:111], v[204:207], v[124:127], v[96:111]
  ds_read_b64_tr_b16 v[196:197], v230 offset:43136
  ds_read_b64_tr_b16 v[198:199], v230 offset:44672
  v_mul_f32 v215, v39, v39
  v_fma_f32 v208, v208, s57, v232
  v_fma_f32 v209, v209, s57, v232
  v_fma_f32 v210, v210, s57, v232
  v_fma_f32 v211, v211, s57, v232
  v_fma_f32 v212, v212, s57, v232
  v_fma_f32 v213, v213, s57, v232
  s_waitcnt lgkmcnt(8)
  v_mfma_f32_32x32x16_bf16 v[48:63], v[176:179], v[128:131], v[48:63]
  ds_read_b64_tr_b16 v[200:201], v230 offset:33920
  ds_read_b64_tr_b16 v[202:203], v230 offset:35456
  v_fma_f32 v214, v214, s57, v232
  v_fma_f32 v215, v215, s57, v232
  v_mul_f32 v208, v208, v32
  v_mul_f32 v209, v209, v33
  v_mul_f32 v210, v210, v34
  v_mul_f32 v211, v211, v35
  v_mfma_f32_32x32x16_bf16 v[96:111], v[180:183], v[128:131], v[96:111]
  ds_read_b64_tr_b16 v[204:205], v230 offset:46208
  ds_read_b64_tr_b16 v[206:207], v230 offset:47744
  v_mul_f32 v212, v212, v36
  v_mul_f32 v213, v213, v37
  v_mul_f32 v214, v214, v38
  v_mul_f32 v215, v215, v39
  v_exp_f32 v208, v208
  v_exp_f32 v209, v209
  s_waitcnt lgkmcnt(8)
  v_mfma_f32_32x32x16_bf16 v[48:63], v[184:187], v[132:135], v[48:63]
  ds_read_b64_tr_b16 v[176:177], v228 offset:128
  ds_read_b64_tr_b16 v[178:179], v228 offset:1664
  v_exp_f32 v210, v210
  v_exp_f32 v211, v211
  v_exp_f32 v212, v212
  v_mfma_f32_32x32x16_bf16 v[96:111], v[188:191], v[132:135], v[96:111]
  ds_read_b64_tr_b16 v[180:181], v228 offset:12416
  ds_read_b64_tr_b16 v[182:183], v228 offset:13952
  v_exp_f32 v213, v213
  v_exp_f32 v214, v214
  v_exp_f32 v215, v215
  s_waitcnt lgkmcnt(8)
  v_mfma_f32_32x32x16_bf16 v[48:63], v[192:195], v[136:139], v[48:63]
  ds_read_b64_tr_b16 v[184:185], v228 offset:3200
  ds_read_b64_tr_b16 v[186:187], v228 offset:4736
  v_mul_f32 v32, v32, v80
  v_mul_f32 v33, v33, v81
  v_mul_f32 v34, v34, v82
  v_mul_f32 v35, v35, v83
  v_mul_f32 v36, v36, v84
  v_mul_f32 v37, v37, v85
  v_mfma_f32_32x32x16_bf16 v[96:111], v[196:199], v[136:139], v[96:111]
  ds_read_b64_tr_b16 v[188:189], v228 offset:15488
  ds_read_b64_tr_b16 v[190:191], v228 offset:17024
  v_mul_f32 v38, v38, v86
  v_mul_f32 v39, v39, v87
  v_add_f32 v208, 1.0, v208
  v_add_f32 v209, 1.0, v209
  v_add_f32 v210, 1.0, v210
  v_add_f32 v211, 1.0, v211
  v_add_f32 v212, 1.0, v212
  s_waitcnt lgkmcnt(8)
  v_mfma_f32_32x32x16_bf16 v[48:63], v[200:203], v[140:143], v[48:63]
  ds_read_b64_tr_b16 v[192:193], v228 offset:6272
  ds_read_b64_tr_b16 v[194:195], v228 offset:7808
  v_add_f32 v213, 1.0, v213
  v_add_f32 v214, 1.0, v214
  v_add_f32 v215, 1.0, v215
  v_rcp_f32 v208, v208
  v_rcp_f32 v209, v209
  v_mfma_f32_32x32x16_bf16 v[96:111], v[204:207], v[140:143], v[96:111]
  ds_read_b64_tr_b16 v[196:197], v228 offset:18560
  ds_read_b64_tr_b16 v[198:199], v228 offset:20096
  v_rcp_f32 v210, v210
  v_rcp_f32 v211, v211
  v_rcp_f32 v212, v212
  s_waitcnt lgkmcnt(8)
  v_mfma_f32_32x32x16_bf16 v[48:63], v[176:179], v[144:147], v[48:63]
  ds_read_b64_tr_b16 v[200:201], v228 offset:9344
  ds_read_b64_tr_b16 v[202:203], v228 offset:10880
  v_rcp_f32 v213, v213
  v_rcp_f32 v214, v214
  v_rcp_f32 v215, v215
  v_mfma_f32_32x32x16_bf16 v[96:111], v[180:183], v[144:147], v[96:111]
  ds_read_b64_tr_b16 v[204:205], v228 offset:21632
  ds_read_b64_tr_b16 v[206:207], v228 offset:23168
  v_mul_f32 v32, v32, v208
  v_mul_f32 v33, v33, v209
  v_mul_f32 v34, v34, v210
  v_mul_f32 v35, v35, v211
  v_mul_f32 v36, v36, v212
  v_mul_f32 v37, v37, v213
  v_mul_f32 v38, v38, v214
  s_waitcnt lgkmcnt(8)
  v_mfma_f32_32x32x16_bf16 v[48:63], v[184:187], v[148:151], v[48:63]
  ds_read_b64_tr_b16 v[176:177], v228 offset:24704
  ds_read_b64_tr_b16 v[178:179], v228 offset:26240
  v_mul_f32 v39, v39, v215
  v_cvt_pk_bf16_f32 v80, v32, v33
  v_cvt_pk_bf16_f32 v81, v34, v35
  v_cvt_pk_bf16_f32 v82, v36, v37
  v_cvt_pk_bf16_f32 v83, v38, v39
  s_add_u32 s35, s50, 16384
  buffer_store_dwordx4 v[80:83], v231, s[24:27], s35 offen offset:0 sc1
  v_mfma_f32_32x32x16_bf16 v[96:111], v[188:191], v[148:151], v[96:111]
  ds_read_b64_tr_b16 v[180:181], v228 offset:36992
  ds_read_b64_tr_b16 v[182:183], v228 offset:38528
  v_mul_f32 v216, v40, v40
  v_mul_f32 v217, v41, v41
  v_mul_f32 v218, v42, v42
  v_mul_f32 v219, v43, v43
  v_mul_f32 v220, v44, v44
  v_mul_f32 v221, v45, v45
  v_mul_f32 v222, v46, v46
  s_waitcnt lgkmcnt(8)
  v_mfma_f32_32x32x16_bf16 v[48:63], v[192:195], v[152:155], v[48:63]
  ds_read_b64_tr_b16 v[184:185], v228 offset:27776
  ds_read_b64_tr_b16 v[186:187], v228 offset:29312
  v_mul_f32 v223, v47, v47
  v_fma_f32 v216, v216, s57, v232
  v_fma_f32 v217, v217, s57, v232
  v_fma_f32 v218, v218, s57, v232
  v_fma_f32 v219, v219, s57, v232
  v_fma_f32 v220, v220, s57, v232
  v_fma_f32 v221, v221, s57, v232
  v_mfma_f32_32x32x16_bf16 v[96:111], v[196:199], v[152:155], v[96:111]
  ds_read_b64_tr_b16 v[188:189], v228 offset:40064
  ds_read_b64_tr_b16 v[190:191], v228 offset:41600
  v_fma_f32 v222, v222, s57, v232
  v_fma_f32 v223, v223, s57, v232
  v_mul_f32 v216, v216, v40
  v_mul_f32 v217, v217, v41
  v_mul_f32 v218, v218, v42
  v_mul_f32 v219, v219, v43
  s_waitcnt lgkmcnt(8)
  v_mfma_f32_32x32x16_bf16 v[48:63], v[200:203], v[156:159], v[48:63]
  ds_read_b64_tr_b16 v[192:193], v228 offset:30848
  ds_read_b64_tr_b16 v[194:195], v228 offset:32384
  v_mul_f32 v220, v220, v44
  v_mul_f32 v221, v221, v45
  v_mul_f32 v222, v222, v46
  v_mul_f32 v223, v223, v47
  v_exp_f32 v216, v216
  v_exp_f32 v217, v217
  v_mfma_f32_32x32x16_bf16 v[96:111], v[204:207], v[156:159], v[96:111]
  ds_read_b64_tr_b16 v[196:197], v228 offset:43136
  ds_read_b64_tr_b16 v[198:199], v228 offset:44672
  v_exp_f32 v218, v218
  v_exp_f32 v219, v219
  v_exp_f32 v220, v220
  s_waitcnt lgkmcnt(8)
  v_mfma_f32_32x32x16_bf16 v[48:63], v[176:179], v[160:163], v[48:63]
  ds_read_b64_tr_b16 v[200:201], v228 offset:33920
  ds_read_b64_tr_b16 v[202:203], v228 offset:35456
  v_exp_f32 v221, v221
  v_exp_f32 v222, v222
  v_exp_f32 v223, v223
  v_mfma_f32_32x32x16_bf16 v[96:111], v[180:183], v[160:163], v[96:111]
  ds_read_b64_tr_b16 v[204:205], v228 offset:46208
  ds_read_b64_tr_b16 v[206:207], v228 offset:47744
  v_mul_f32 v40, v40, v88
  v_mul_f32 v41, v41, v89
  v_mul_f32 v42, v42, v90
  v_mul_f32 v43, v43, v91
  v_mul_f32 v44, v44, v92
  v_mul_f32 v45, v45, v93
  s_waitcnt lgkmcnt(8)
  v_mfma_f32_32x32x16_bf16 v[48:63], v[184:187], v[164:167], v[48:63]
  v_mul_f32 v46, v46, v94
  v_mul_f32 v47, v47, v95
  v_add_f32 v216, 1.0, v216
  v_add_f32 v217, 1.0, v217
  v_add_f32 v218, 1.0, v218
  v_add_f32 v219, 1.0, v219
  v_add_f32 v220, 1.0, v220
  v_mfma_f32_32x32x16_bf16 v[96:111], v[188:191], v[164:167], v[96:111]
  v_add_f32 v221, 1.0, v221
  v_add_f32 v222, 1.0, v222
  v_add_f32 v223, 1.0, v223
  v_rcp_f32 v216, v216
  v_rcp_f32 v217, v217
  s_waitcnt lgkmcnt(4)
  v_mfma_f32_32x32x16_bf16 v[48:63], v[192:195], v[168:171], v[48:63]
  v_rcp_f32 v218, v218
  v_rcp_f32 v219, v219
  v_rcp_f32 v220, v220
  v_mfma_f32_32x32x16_bf16 v[96:111], v[196:199], v[168:171], v[96:111]
  v_rcp_f32 v221, v221
  v_rcp_f32 v222, v222
  v_rcp_f32 v223, v223
  s_waitcnt lgkmcnt(0)
  v_mfma_f32_32x32x16_bf16 v[48:63], v[200:203], v[172:175], v[48:63]
  v_mul_f32 v40, v40, v216
  v_mul_f32 v41, v41, v217
  v_mul_f32 v42, v42, v218
  v_mul_f32 v43, v43, v219
  v_mul_f32 v44, v44, v220
  v_mul_f32 v45, v45, v221
  v_mul_f32 v46, v46, v222
  v_mfma_f32_32x32x16_bf16 v[96:111], v[204:207], v[172:175], v[96:111]
  v_mul_f32 v47, v47, v223
  v_cvt_pk_bf16_f32 v88, v40, v41
  v_cvt_pk_bf16_f32 v89, v42, v43
  v_cvt_pk_bf16_f32 v90, v44, v45
  v_cvt_pk_bf16_f32 v91, v46, v47
  s_add_u32 s35, s50, 16384
  buffer_store_dwordx4 v[88:91], v231, s[24:27], s35 offen offset:512 sc1
  s_barrier
  s_bfe_u32 s36, s30, 0x10003
  s_lshr_b32 s43, s37, 1
  s_add_u32 s43, s43, s36
  s_lshl_b32 s41, s43, 12
  s_mul_i32 s35, s45, 49152
  s_add_u32 s41, s41, s35
  s_add_u32 s41, s41, 2621440
  s_cmp_ge_u32 s45, 3
  s_cselect_b32 s74, 720896, 0
  s_sub_u32 s74, s41, s74
  s_cmp_ge_u32 s45, 2
  s_cselect_b32 s75, 720896, 0
  s_sub_u32 s75, s41, s75
  s_add_u32 s36, s41, 0
  buffer_load_dwordx4 v[112:115], v1, s[24:27], s36 offen offset:0 sc1
  buffer_load_dwordx4 v[116:119], v1, s[24:27], s36 offen offset:1024 sc1
  buffer_load_dwordx4 v[120:123], v1, s[24:27], s36 offen offset:2048 sc1
  buffer_load_dwordx4 v[124:127], v1, s[24:27], s36 offen offset:3072 sc1
  s_add_u32 s36, s41, 196608
  buffer_load_dwordx4 v[128:131], v1, s[24:27], s36 offen offset:0 sc1
  buffer_load_dwordx4 v[132:135], v1, s[24:27], s36 offen offset:1024 sc1
  buffer_load_dwordx4 v[136:139], v1, s[24:27], s36 offen offset:2048 sc1
  buffer_load_dwordx4 v[140:143], v1, s[24:27], s36 offen offset:3072 sc1
  v_pk_mul_f32 v[208:209], v[48:49], v[48:49]
  v_pk_mul_f32 v[210:211], v[50:51], v[50:51]
  v_pk_mul_f32 v[212:213], v[52:53], v[52:53]
  v_pk_mul_f32 v[214:215], v[54:55], v[54:55]
  v_pk_fma_f32 v[208:209], v[208:209], s[56:57], s[56:57] op_sel:[0,1,0] op_sel_hi:[1,1,0]
  v_pk_fma_f32 v[210:211], v[210:211], s[56:57], s[56:57] op_sel:[0,1,0] op_sel_hi:[1,1,0]
  v_pk_fma_f32 v[212:213], v[212:213], s[56:57], s[56:57] op_sel:[0,1,0] op_sel_hi:[1,1,0]
  v_pk_fma_f32 v[214:215], v[214:215], s[56:57], s[56:57] op_sel:[0,1,0] op_sel_hi:[1,1,0]
  v_pk_mul_f32 v[208:209], v[208:209], v[48:49]
  v_pk_mul_f32 v[210:211], v[210:211], v[50:51]
  v_pk_mul_f32 v[212:213], v[212:213], v[52:53]
  v_pk_mul_f32 v[214:215], v[214:215], v[54:55]
  v_exp_f32 v208, v208
  v_exp_f32 v209, v209
  v_exp_f32 v210, v210
  v_exp_f32 v211, v211
  v_exp_f32 v212, v212
  v_exp_f32 v213, v213
  v_exp_f32 v214, v214
  v_exp_f32 v215, v215
  v_pk_mul_f32 v[48:49], v[48:49], v[96:97]
  v_pk_mul_f32 v[50:51], v[50:51], v[98:99]
  v_pk_mul_f32 v[52:53], v[52:53], v[100:101]
  v_pk_mul_f32 v[54:55], v[54:55], v[102:103]
  v_pk_add_f32 v[208:209], v[208:209], 1.0 op_sel_hi:[1,0]
  v_pk_add_f32 v[210:211], v[210:211], 1.0 op_sel_hi:[1,0]
  v_pk_add_f32 v[212:213], v[212:213], 1.0 op_sel_hi:[1,0]
  v_pk_add_f32 v[214:215], v[214:215], 1.0 op_sel_hi:[1,0]
  v_rcp_f32 v208, v208
  v_rcp_f32 v209, v209
  v_rcp_f32 v210, v210
  v_rcp_f32 v211, v211
  v_rcp_f32 v212, v212
  v_rcp_f32 v213, v213
  v_rcp_f32 v214, v214
  v_rcp_f32 v215, v215
  v_pk_mul_f32 v[48:49], v[48:49], v[208:209]
  v_pk_mul_f32 v[50:51], v[50:51], v[210:211]
  v_pk_mul_f32 v[52:53], v[52:53], v[212:213]
  v_pk_mul_f32 v[54:55], v[54:55], v[214:215]
  v_cvt_pk_bf16_f32 v96, v48, v49
  v_cvt_pk_bf16_f32 v97, v50, v51
  v_cvt_pk_bf16_f32 v98, v52, v53
  v_cvt_pk_bf16_f32 v99, v54, v55
  s_add_u32 s35, s50, 32768
  buffer_store_dwordx4 v[96:99], v231, s[24:27], s35 offen offset:0 sc1
  v_pk_mul_f32 v[216:217], v[56:57], v[56:57]
  v_pk_mul_f32 v[218:219], v[58:59], v[58:59]
  v_pk_mul_f32 v[220:221], v[60:61], v[60:61]
  v_pk_mul_f32 v[222:223], v[62:63], v[62:63]
  v_pk_fma_f32 v[216:217], v[216:217], s[56:57], s[56:57] op_sel:[0,1,0] op_sel_hi:[1,1,0]
  v_pk_fma_f32 v[218:219], v[218:219], s[56:57], s[56:57] op_sel:[0,1,0] op_sel_hi:[1,1,0]
  v_pk_fma_f32 v[220:221], v[220:221], s[56:57], s[56:57] op_sel:[0,1,0] op_sel_hi:[1,1,0]
  v_pk_fma_f32 v[222:223], v[222:223], s[56:57], s[56:57] op_sel:[0,1,0] op_sel_hi:[1,1,0]
  v_pk_mul_f32 v[216:217], v[216:217], v[56:57]
  v_pk_mul_f32 v[218:219], v[218:219], v[58:59]
  v_pk_mul_f32 v[220:221], v[220:221], v[60:61]
  v_pk_mul_f32 v[222:223], v[222:223], v[62:63]
  v_exp_f32 v216, v216
  v_exp_f32 v217, v217
  v_exp_f32 v218, v218
  v_exp_f32 v219, v219
  v_exp_f32 v220, v220
  v_exp_f32 v221, v221
  v_exp_f32 v222, v222
  v_exp_f32 v223, v223
  v_pk_mul_f32 v[56:57], v[56:57], v[104:105]
  v_pk_mul_f32 v[58:59], v[58:59], v[106:107]
  v_pk_mul_f32 v[60:61], v[60:61], v[108:109]
  v_pk_mul_f32 v[62:63], v[62:63], v[110:111]
  v_pk_add_f32 v[216:217], v[216:217], 1.0 op_sel_hi:[1,0]
  v_pk_add_f32 v[218:219], v[218:219], 1.0 op_sel_hi:[1,0]
  v_pk_add_f32 v[220:221], v[220:221], 1.0 op_sel_hi:[1,0]
  v_pk_add_f32 v[222:223], v[222:223], 1.0 op_sel_hi:[1,0]
  v_rcp_f32 v216, v216
  v_rcp_f32 v217, v217
  v_rcp_f32 v218, v218
  v_rcp_f32 v219, v219
  v_rcp_f32 v220, v220
  v_rcp_f32 v221, v221
  v_rcp_f32 v222, v222
  v_rcp_f32 v223, v223
  v_pk_mul_f32 v[56:57], v[56:57], v[216:217]
  v_pk_mul_f32 v[58:59], v[58:59], v[218:219]
  v_pk_mul_f32 v[60:61], v[60:61], v[220:221]
  v_pk_mul_f32 v[62:63], v[62:63], v[222:223]
  v_cvt_pk_bf16_f32 v104, v56, v57
  v_cvt_pk_bf16_f32 v105, v58, v59
  v_cvt_pk_bf16_f32 v106, v60, v61
  v_cvt_pk_bf16_f32 v107, v62, v63
  s_add_u32 s35, s50, 32768
  buffer_store_dwordx4 v[104:107], v231, s[24:27], s35 offen offset:512 sc1
  s_add_u32 s36, s41, 393216
  buffer_load_dwordx4 v[144:147], v1, s[24:27], s36 offen offset:0 sc1
  buffer_load_dwordx4 v[148:151], v1, s[24:27], s36 offen offset:1024 sc1
  buffer_load_dwordx4 v[152:155], v1, s[24:27], s36 offen offset:2048 sc1
  buffer_load_dwordx4 v[156:159], v1, s[24:27], s36 offen offset:3072 sc1
  s_bfe_u32 s36, s30, 0x10003
  s_lshl_b32 s49, s45, 12
  s_and_b32 s40, s30, 7
  s_lshl_b32 s43, s43, 16
  s_lshl_b32 s35, s40, 12
  s_add_u32 s43, s43, s35
  s_add_u32 s43, s43, 2359296
  s_lshl_b32 s42, s32, 1
  s_add_u32 s42, s42, s36
  s_lshl_b32 s42, s42, 16
  s_lshl_b32 s35, s40, 7
  s_add_u32 s42, s42, s35
  s_add_u32 s50, s42, 32768
  s_lshl_b32 s35, s45, 3
  v_lshrrev_b32 v216, 3, v0
  v_add_u32 v216, s35, v216
  v_and_b32 v217, 7, v0
  v_lshlrev_b32 v228, 10, v216
  v_lshl_add_u32 v228, v217, 4, v228
  v_lshrrev_b32 v218, 1, v217
  v_lshlrev_b32 v231, 10, v218
  v_lshl_add_u32 v231, v216, 4, v231
  v_and_b32 v218, 1, v217
  v_lshl_add_u32 v231, v218, 3, v231
  s_mov_b32 s64, s70
  s_mov_b32 s65, s71
  s_mov_b32 s66, 2097152
  s_mov_b32 s67, 0x20000
  v_and_b32 v218, 15, v216
  v_lshlrev_b32 v229, 1, v217
  v_xor_b32 v229, v229, v218
  v_lshlrev_b32 v229, 4, v229
  v_lshl_add_u32 v229, v218, 8, v229
  v_lshrrev_b32 v218, 4, v216
  v_lshl_add_u32 v229, v218, 14, v229
  v_add_u32 v229, 49152, v229
  v_xor_b32 v230, 16, v229
  v_and_b32 v216, 15, v0
  v_lshrrev_b32 v217, 4, v0
  v_xor_b32 v220, v216, v217
  v_lshlrev_b32 v220, 4, v220
  v_lshl_add_u32 v220, v216, 8, v220
  s_add_u32 s35, s49, 49152
  v_add_u32 v220, s35, v220
  v_xor_b32 v221, 64, v220
  v_xor_b32 v222, 128, v220
  v_xor_b32 v223, 192, v220
  v_lshrrev_b32 v216, 3, v0
  v_and_b32 v217, 7, v0
  v_lshrrev_b32 v218, 4, v0
  v_lshlrev_b32 v219, 1, v218
  v_xor_b32 v219, v219, v217
  v_lshlrev_b32 v219, 4, v219
  v_lshl_add_u32 v219, v216, 10, v219
  s_mov_b32 s20, s84
  s_mov_b32 s21, s85
  s_mov_b32 s22, 1409024
  s_mov_b32 s23, 0x20000
  s_lshl_b32 s49, s45, 12
  s_mul_i32 s39, s45, 98304
  s_and_b32 s35, s30, 7
  s_lshl_b32 s35, s35, 7
  s_add_u32 s39, s39, s35
  v_and_b32 v216, 15, v0
  v_lshrrev_b32 v216, 2, v216
  v_and_b32 v217, 1, v218
  v_lshl_add_u32 v216, v217, 2, v216
  v_lshrrev_b32 v217, 1, v216
  v_lshrrev_b32 v218, 1, v218
  v_lshl_add_u32 v216, v218, 4, v216
  v_lshlrev_b32 v232, 7, v216
  v_lshl_add_u32 v232, v217, 5, v232
  v_and_b32 v216, 3, v0
  v_lshl_add_u32 v232, v216, 3, v232
  v_add_u32 v232, s49, v232
  v_xor_b32 v233, 32, v232
  v_xor_b32 v234, 64, v232
  v_xor_b32 v235, 96, v232
  v_add_u32 v236, 65536, v232
  v_add_u32 v237, 65536, v233
  v_add_u32 v238, 65536, v234
  v_add_u32 v239, 65536, v235
  v_add_u32 v240, 131072, v232
  v_add_u32 v241, 131072, v233
  v_add_u32 v242, 131072, v234
  v_add_u32 v243, 131072, v235
  s_barrier
  ds_read_b64_tr_b16 v[176:177], v240 offset:16384
  ds_read_b64_tr_b16 v[178:179], v240 offset:17408
  ds_read_b64_tr_b16 v[180:181], v241 offset:16384
  ds_read_b64_tr_b16 v[182:183], v241 offset:17408
  ds_read_b64_tr_b16 v[184:185], v242 offset:16384
  ds_read_b64_tr_b16 v[186:187], v242 offset:17408
  ds_read_b64_tr_b16 v[188:189], v243 offset:16384
  ds_read_b64_tr_b16 v[190:191], v243 offset:17408
  s_add_u32 s36, s74, 589824
  buffer_load_dwordx4 v[160:163], v1, s[24:27], s36 offen offset:0 sc1
  buffer_load_dwordx4 v[164:167], v1, s[24:27], s36 offen offset:1024 sc1
  buffer_load_dwordx4 v[168:171], v1, s[24:27], s36 offen offset:2048 sc1
  buffer_load_dwordx4 v[172:175], v1, s[24:27], s36 offen offset:3072 sc1
  s_waitcnt vmcnt(12) lgkmcnt(0)
  v_max3_u32 v12, v112, v116, v120
  v_max_u32 v12, v12, v124
  v_cmp_eq_u32 vcc, -1, v12
  s_cbranch_vccnz k2_rg0
k2_rg0r:
  v_mfma_f32_16x16x32_bf16 v[16:19], v[176:179], v[112:115], 0
  ds_read_b64_tr_b16 v[192:193], v232 offset:49152
  v_mfma_f32_16x16x32_bf16 v[20:23], v[176:179], v[116:119], 0
  ds_read_b64_tr_b16 v[194:195], v232 offset:50176
  v_mfma_f32_16x16x32_bf16 v[24:27], v[176:179], v[120:123], 0
  ds_read_b64_tr_b16 v[196:197], v233 offset:49152
  v_mfma_f32_16x16x32_bf16 v[28:31], v[176:179], v[124:127], 0
  v_mfma_f32_16x16x32_bf16 v[32:35], v[180:183], v[112:115], 0
  ds_read_b64_tr_b16 v[198:199], v233 offset:50176
  v_mfma_f32_16x16x32_bf16 v[36:39], v[180:183], v[116:119], 0
  ds_read_b64_tr_b16 v[200:201], v234 offset:49152
  v_mfma_f32_16x16x32_bf16 v[40:43], v[180:183], v[120:123], 0
  ds_read_b64_tr_b16 v[202:203], v234 offset:50176
  v_mfma_f32_16x16x32_bf16 v[44:47], v[180:183], v[124:127], 0
  v_mfma_f32_16x16x32_bf16 v[48:51], v[184:187], v[112:115], 0
  ds_read_b64_tr_b16 v[204:205], v235 offset:49152
  v_mfma_f32_16x16x32_bf16 v[52:55], v[184:187], v[116:119], 0
  ds_read_b64_tr_b16 v[206:207], v235 offset:50176
  v_mfma_f32_16x16x32_bf16 v[56:59], v[184:187], v[120:123], 0
  s_add_u32 s36, s41, 65536
  buffer_load_dwordx4 v[80:83], v1, s[24:27], s36 offen offset:0 sc1
  v_mfma_f32_16x16x32_bf16 v[60:63], v[184:187], v[124:127], 0
  v_mfma_f32_16x16x32_bf16 v[64:67], v[188:191], v[112:115], 0
  buffer_load_dwordx4 v[84:87], v1, s[24:27], s36 offen offset:1024 sc1
  v_mfma_f32_16x16x32_bf16 v[68:71], v[188:191], v[116:119], 0
  buffer_load_dwordx4 v[88:91], v1, s[24:27], s36 offen offset:2048 sc1
  v_mfma_f32_16x16x32_bf16 v[72:75], v[188:191], v[120:123], 0
  buffer_load_dwordx4 v[92:95], v1, s[24:27], s36 offen offset:3072 sc1
  v_mfma_f32_16x16x32_bf16 v[76:79], v[188:191], v[124:127], 0
  s_waitcnt vmcnt(12) lgkmcnt(0)
  v_max3_u32 v12, v128, v132, v136
  v_max_u32 v12, v12, v140
  v_cmp_eq_u32 vcc, -1, v12
  s_cbranch_vccnz k2_rg1
k2_rg1r:
  v_mfma_f32_16x16x32_bf16 v[16:19], v[192:195], v[128:131], v[16:19]
  ds_read_b64_tr_b16 v[176:177], v236 offset:0
  v_mfma_f32_16x16x32_bf16 v[20:23], v[192:195], v[132:135], v[20:23]
  ds_read_b64_tr_b16 v[178:179], v236 offset:1024
  v_mfma_f32_16x16x32_bf16 v[24:27], v[192:195], v[136:139], v[24:27]
  ds_read_b64_tr_b16 v[180:181], v237 offset:0
  v_mfma_f32_16x16x32_bf16 v[28:31], v[192:195], v[140:143], v[28:31]
  v_mfma_f32_16x16x32_bf16 v[32:35], v[196:199], v[128:131], v[32:35]
  ds_read_b64_tr_b16 v[182:183], v237 offset:1024
  v_mfma_f32_16x16x32_bf16 v[36:39], v[196:199], v[132:135], v[36:39]
  ds_read_b64_tr_b16 v[184:185], v238 offset:0
  v_mfma_f32_16x16x32_bf16 v[40:43], v[196:199], v[136:139], v[40:43]
  ds_read_b64_tr_b16 v[186:187], v238 offset:1024
  v_mfma_f32_16x16x32_bf16 v[44:47], v[196:199], v[140:143], v[44:47]
  v_mfma_f32_16x16x32_bf16 v[48:51], v[200:203], v[128:131], v[48:51]
  ds_read_b64_tr_b16 v[188:189], v239 offset:0
  v_mfma_f32_16x16x32_bf16 v[52:55], v[200:203], v[132:135], v[52:55]
  ds_read_b64_tr_b16 v[190:191], v239 offset:1024
  v_mfma_f32_16x16x32_bf16 v[56:59], v[200:203], v[136:139], v[56:59]
  s_add_u32 s36, s41, 262144
  buffer_load_dwordx4 v[96:99], v1, s[24:27], s36 offen offset:0 sc1
  v_mfma_f32_16x16x32_bf16 v[60:63], v[200:203], v[140:143], v[60:63]
  v_mfma_f32_16x16x32_bf16 v[64:67], v[204:207], v[128:131], v[64:67]
  buffer_load_dwordx4 v[100:103], v1, s[24:27], s36 offen offset:1024 sc1
  v_mfma_f32_16x16x32_bf16 v[68:71], v[204:207], v[132:135], v[68:71]
  buffer_load_dwordx4 v[104:107], v1, s[24:27], s36 offen offset:2048 sc1
  v_mfma_f32_16x16x32_bf16 v[72:75], v[204:207], v[136:139], v[72:75]
  buffer_load_dwordx4 v[108:111], v1, s[24:27], s36 offen offset:3072 sc1
  v_mfma_f32_16x16x32_bf16 v[76:79], v[204:207], v[140:143], v[76:79]
  s_waitcnt vmcnt(12) lgkmcnt(0)
  v_max3_u32 v12, v144, v148, v152
  v_max_u32 v12, v12, v156
  v_cmp_eq_u32 vcc, -1, v12
  s_cbranch_vccnz k2_rg2
k2_rg2r:
  v_mfma_f32_16x16x32_bf16 v[16:19], v[176:179], v[144:147], v[16:19]
  ds_read_b64_tr_b16 v[192:193], v236 offset:16384
  v_mfma_f32_16x16x32_bf16 v[20:23], v[176:179], v[148:151], v[20:23]
  ds_read_b64_tr_b16 v[194:195], v236 offset:17408
  v_mfma_f32_16x16x32_bf16 v[24:27], v[176:179], v[152:155], v[24:27]
  ds_read_b64_tr_b16 v[196:197], v237 offset:16384
  v_mfma_f32_16x16x32_bf16 v[28:31], v[176:179], v[156:159], v[28:31]
  v_mfma_f32_16x16x32_bf16 v[32:35], v[180:183], v[144:147], v[32:35]
  ds_read_b64_tr_b16 v[198:199], v237 offset:17408
  v_mfma_f32_16x16x32_bf16 v[36:39], v[180:183], v[148:151], v[36:39]
  ds_read_b64_tr_b16 v[200:201], v238 offset:16384
  v_mfma_f32_16x16x32_bf16 v[40:43], v[180:183], v[152:155], v[40:43]
  ds_read_b64_tr_b16 v[202:203], v238 offset:17408
  v_mfma_f32_16x16x32_bf16 v[44:47], v[180:183], v[156:159], v[44:47]
  v_mfma_f32_16x16x32_bf16 v[48:51], v[184:187], v[144:147], v[48:51]
  ds_read_b64_tr_b16 v[204:205], v239 offset:16384
  v_mfma_f32_16x16x32_bf16 v[52:55], v[184:187], v[148:151], v[52:55]
  ds_read_b64_tr_b16 v[206:207], v239 offset:17408
  v_mfma_f32_16x16x32_bf16 v[56:59], v[184:187], v[152:155], v[56:59]
  s_add_u32 s36, s41, 458752
  buffer_load_dwordx4 v[112:115], v1, s[24:27], s36 offen offset:0 sc1
  v_mfma_f32_16x16x32_bf16 v[60:63], v[184:187], v[156:159], v[60:63]
  v_mfma_f32_16x16x32_bf16 v[64:67], v[188:191], v[144:147], v[64:67]
  buffer_load_dwordx4 v[116:119], v1, s[24:27], s36 offen offset:1024 sc1
  v_mfma_f32_16x16x32_bf16 v[68:71], v[188:191], v[148:151], v[68:71]
  buffer_load_dwordx4 v[120:123], v1, s[24:27], s36 offen offset:2048 sc1
  v_mfma_f32_16x16x32_bf16 v[72:75], v[188:191], v[152:155], v[72:75]
  buffer_load_dwordx4 v[124:127], v1, s[24:27], s36 offen offset:3072 sc1
  v_mfma_f32_16x16x32_bf16 v[76:79], v[188:191], v[156:159], v[76:79]
  s_waitcnt vmcnt(12) lgkmcnt(0)
  v_max3_u32 v12, v160, v164, v168
  v_max_u32 v12, v12, v172
  v_cmp_eq_u32 vcc, -1, v12
  s_cbranch_vccnz k2_rg3
k2_rg3r:
  v_mfma_f32_16x16x32_bf16 v[16:19], v[192:195], v[160:163], v[16:19]
  ds_read_b64_tr_b16 v[176:177], v236 offset:32768
  ds_read_b64_tr_b16 v[178:179], v236 offset:33792
  v_mfma_f32_16x16x32_bf16 v[20:23], v[192:195], v[164:167], v[20:23]
  ds_read_b64_tr_b16 v[180:181], v237 offset:32768
  v_mfma_f32_16x16x32_bf16 v[24:27], v[192:195], v[168:171], v[24:27]
  ds_read_b64_tr_b16 v[182:183], v237 offset:33792
  v_mfma_f32_16x16x32_bf16 v[28:31], v[192:195], v[172:175], v[28:31]
  ds_read_b64_tr_b16 v[184:185], v238 offset:32768
  v_mfma_f32_16x16x32_bf16 v[32:35], v[196:199], v[160:163], v[32:35]
  ds_read_b64_tr_b16 v[186:187], v238 offset:33792
  v_mfma_f32_16x16x32_bf16 v[36:39], v[196:199], v[164:167], v[36:39]
  ds_read_b64_tr_b16 v[188:189], v239 offset:32768
  v_mfma_f32_16x16x32_bf16 v[40:43], v[196:199], v[168:171], v[40:43]
  ds_read_b64_tr_b16 v[190:191], v239 offset:33792
  v_mfma_f32_16x16x32_bf16 v[44:47], v[196:199], v[172:175], v[44:47]
  s_add_u32 m0, s49, 147456
  s_add_u32 s35, s39, 1048576
  buffer_load_dwordx4 v219, s[20:23], s35 offen lds
  v_mfma_f32_16x16x32_bf16 v[48:51], v[200:203], v[160:163], v[48:51]
  s_add_u32 m0, s49, 148480
  s_add_u32 s35, s39, 1056768
  buffer_load_dwordx4 v219, s[20:23], s35 offen lds
  v_mfma_f32_16x16x32_bf16 v[52:55], v[200:203], v[164:167], v[52:55]
  s_add_u32 m0, s49, 149504
  s_add_u32 s35, s39, 1064960
  buffer_load_dwordx4 v219, s[20:23], s35 offen lds
  v_mfma_f32_16x16x32_bf16 v[56:59], v[200:203], v[168:171], v[56:59]
  s_add_u32 m0, s49, 150528
  s_add_u32 s35, s39, 1073152
  buffer_load_dwordx4 v219, s[20:23], s35 offen lds
  v_mfma_f32_16x16x32_bf16 v[60:63], v[200:203], v[172:175], v[60:63]
  buffer_load_dwordx2 v[208:209], v231, s[24:27], s43 offen sc1
  buffer_load_dwordx2 v[210:211], v231, s[24:27], s43 offen offset:512 sc1
  v_mfma_f32_16x16x32_bf16 v[64:67], v[204:207], v[160:163], v[64:67]
  s_add_u32 s36, s75, 655360
  buffer_load_dwordx4 v[128:131], v1, s[24:27], s36 offen offset:0 sc1
  v_mfma_f32_16x16x32_bf16 v[68:71], v[204:207], v[164:167], v[68:71]
  buffer_load_dwordx4 v[132:135], v1, s[24:27], s36 offen offset:1024 sc1
  v_mfma_f32_16x16x32_bf16 v[72:75], v[204:207], v[168:171], v[72:75]
  buffer_load_dwordx4 v[136:139], v1, s[24:27], s36 offen offset:2048 sc1
  v_mfma_f32_16x16x32_bf16 v[76:79], v[204:207], v[172:175], v[76:79]
  buffer_load_dwordx4 v[140:143], v1, s[24:27], s36 offen offset:3072 sc1
  s_waitcnt vmcnt(18) lgkmcnt(0)
  v_max3_u32 v12, v80, v84, v88
  v_max_u32 v12, v12, v92
  v_cmp_eq_u32 vcc, -1, v12
  s_cbranch_vccnz k2_rg4
k2_rg4r:
  v_mfma_f32_16x16x32_bf16 v[16:19], v[176:179], v[80:83], v[16:19]
  ds_read_b64_tr_b16 v[192:193], v236 offset:49152
  v_mfma_f32_16x16x32_bf16 v[20:23], v[176:179], v[84:87], v[20:23]
  ds_read_b64_tr_b16 v[194:195], v236 offset:50176
  v_mfma_f32_16x16x32_bf16 v[24:27], v[176:179], v[88:91], v[24:27]
  ds_read_b64_tr_b16 v[196:197], v237 offset:49152
  v_mfma_f32_16x16x32_bf16 v[28:31], v[176:179], v[92:95], v[28:31]
  v_mfma_f32_16x16x32_bf16 v[32:35], v[180:183], v[80:83], v[32:35]
  ds_read_b64_tr_b16 v[198:199], v237 offset:50176
  v_mfma_f32_16x16x32_bf16 v[36:39], v[180:183], v[84:87], v[36:39]
  ds_read_b64_tr_b16 v[200:201], v238 offset:49152
  v_mfma_f32_16x16x32_bf16 v[40:43], v[180:183], v[88:91], v[40:43]
  ds_read_b64_tr_b16 v[202:203], v238 offset:50176
  v_mfma_f32_16x16x32_bf16 v[44:47], v[180:183], v[92:95], v[44:47]
  v_mfma_f32_16x16x32_bf16 v[48:51], v[184:187], v[80:83], v[48:51]
  ds_read_b64_tr_b16 v[204:205], v239 offset:49152
  v_mfma_f32_16x16x32_bf16 v[52:55], v[184:187], v[84:87], v[52:55]
  ds_read_b64_tr_b16 v[206:207], v239 offset:50176
  v_mfma_f32_16x16x32_bf16 v[56:59], v[184:187], v[88:91], v[56:59]
  s_add_u32 s36, s41, 131072
  buffer_load_dwordx4 v[144:147], v1, s[24:27], s36 offen offset:0 sc1
  v_mfma_f32_16x16x32_bf16 v[60:63], v[184:187], v[92:95], v[60:63]
  v_mfma_f32_16x16x32_bf16 v[64:67], v[188:191], v[80:83], v[64:67]
  buffer_load_dwordx4 v[148:151], v1, s[24:27], s36 offen offset:1024 sc1
  v_mfma_f32_16x16x32_bf16 v[68:71], v[188:191], v[84:87], v[68:71]
  buffer_load_dwordx4 v[152:155], v1, s[24:27], s36 offen offset:2048 sc1
  v_mfma_f32_16x16x32_bf16 v[72:75], v[188:191], v[88:91], v[72:75]
  buffer_load_dwordx4 v[156:159], v1, s[24:27], s36 offen offset:3072 sc1
  v_mfma_f32_16x16x32_bf16 v[76:79], v[188:191], v[92:95], v[76:79]
  s_waitcnt vmcnt(18) lgkmcnt(0)
  v_max3_u32 v12, v96, v100, v104
  v_max_u32 v12, v12, v108
  v_cmp_eq_u32 vcc, -1, v12
  s_cbranch_vccnz k2_rg5
k2_rg5r:
  v_mfma_f32_16x16x32_bf16 v[16:19], v[192:195], v[96:99], v[16:19]
  ds_read_b64_tr_b16 v[176:177], v240 offset:0
  v_mfma_f32_16x16x32_bf16 v[20:23], v[192:195], v[100:103], v[20:23]
  ds_read_b64_tr_b16 v[178:179], v240 offset:1024
  v_mfma_f32_16x16x32_bf16 v[24:27], v[192:195], v[104:107], v[24:27]
  ds_read_b64_tr_b16 v[180:181], v241 offset:0
  v_mfma_f32_16x16x32_bf16 v[28:31], v[192:195], v[108:111], v[28:31]
  v_mfma_f32_16x16x32_bf16 v[32:35], v[196:199], v[96:99], v[32:35]
  ds_read_b64_tr_b16 v[182:183], v241 offset:1024
  v_mfma_f32_16x16x32_bf16 v[36:39], v[196:199], v[100:103], v[36:39]
  ds_read_b64_tr_b16 v[184:185], v242 offset:0
  v_mfma_f32_16x16x32_bf16 v[40:43], v[196:199], v[104:107], v[40:43]
  ds_read_b64_tr_b16 v[186:187], v242 offset:1024
  v_mfma_f32_16x16x32_bf16 v[44:47], v[196:199], v[108:111], v[44:47]
  v_mfma_f32_16x16x32_bf16 v[48:51], v[200:203], v[96:99], v[48:51]
  ds_read_b64_tr_b16 v[188:189], v243 offset:0
  v_mfma_f32_16x16x32_bf16 v[52:55], v[200:203], v[100:103], v[52:55]
  ds_read_b64_tr_b16 v[190:191], v243 offset:1024
  v_mfma_f32_16x16x32_bf16 v[56:59], v[200:203], v[104:107], v[56:59]
  s_add_u32 s36, s41, 327680
  buffer_load_dwordx4 v[160:163], v1, s[24:27], s36 offen offset:0 sc1
  v_mfma_f32_16x16x32_bf16 v[60:63], v[200:203], v[108:111], v[60:63]
  v_mfma_f32_16x16x32_bf16 v[64:67], v[204:207], v[96:99], v[64:67]
  buffer_load_dwordx4 v[164:167], v1, s[24:27], s36 offen offset:1024 sc1
  v_mfma_f32_16x16x32_bf16 v[68:71], v[204:207], v[100:103], v[68:71]
  buffer_load_dwordx4 v[168:171], v1, s[24:27], s36 offen offset:2048 sc1
  v_mfma_f32_16x16x32_bf16 v[72:75], v[204:207], v[104:107], v[72:75]
  buffer_load_dwordx4 v[172:175], v1, s[24:27], s36 offen offset:3072 sc1
  v_mfma_f32_16x16x32_bf16 v[76:79], v[204:207], v[108:111], v[76:79]
  s_waitcnt vmcnt(18) lgkmcnt(0)
  v_max3_u32 v12, v112, v116, v120
  v_max_u32 v12, v12, v124
  v_cmp_eq_u32 vcc, -1, v12
  s_cbranch_vccnz k2_rg6
k2_rg6r:
  v_mfma_f32_16x16x32_bf16 v[16:19], v[176:179], v[112:115], v[16:19]
  ds_read_b64_tr_b16 v[192:193], v232 offset:0
  v_mfma_f32_16x16x32_bf16 v[20:23], v[176:179], v[116:119], v[20:23]
  ds_read_b64_tr_b16 v[194:195], v232 offset:1024
  v_mfma_f32_16x16x32_bf16 v[24:27], v[176:179], v[120:123], v[24:27]
  ds_read_b64_tr_b16 v[196:197], v233 offset:0
  v_mfma_f32_16x16x32_bf16 v[28:31], v[176:179], v[124:127], v[28:31]
  v_mfma_f32_16x16x32_bf16 v[32:35], v[180:183], v[112:115], v[32:35]
  ds_read_b64_tr_b16 v[198:199], v233 offset:1024
  v_mfma_f32_16x16x32_bf16 v[36:39], v[180:183], v[116:119], v[36:39]
  ds_read_b64_tr_b16 v[200:201], v234 offset:0
  v_mfma_f32_16x16x32_bf16 v[40:43], v[180:183], v[120:123], v[40:43]
  ds_read_b64_tr_b16 v[202:203], v234 offset:1024
  v_mfma_f32_16x16x32_bf16 v[44:47], v[180:183], v[124:127], v[44:47]
  v_mfma_f32_16x16x32_bf16 v[48:51], v[184:187], v[112:115], v[48:51]
  ds_read_b64_tr_b16 v[204:205], v235 offset:0
  v_mfma_f32_16x16x32_bf16 v[52:55], v[184:187], v[116:119], v[52:55]
  ds_read_b64_tr_b16 v[206:207], v235 offset:1024
  v_mfma_f32_16x16x32_bf16 v[56:59], v[184:187], v[120:123], v[56:59]
  s_add_u32 s36, s41, 524288
  buffer_load_dwordx4 v[80:83], v1, s[24:27], s36 offen offset:0 sc1
  v_mfma_f32_16x16x32_bf16 v[60:63], v[184:187], v[124:127], v[60:63]
  v_mfma_f32_16x16x32_bf16 v[64:67], v[188:191], v[112:115], v[64:67]
  buffer_load_dwordx4 v[84:87], v1, s[24:27], s36 offen offset:1024 sc1
  v_mfma_f32_16x16x32_bf16 v[68:71], v[188:191], v[116:119], v[68:71]
  buffer_load_dwordx4 v[88:91], v1, s[24:27], s36 offen offset:2048 sc1
  v_mfma_f32_16x16x32_bf16 v[72:75], v[188:191], v[120:123], v[72:75]
  buffer_load_dwordx4 v[92:95], v1, s[24:27], s36 offen offset:3072 sc1
  v_mfma_f32_16x16x32_bf16 v[76:79], v[188:191], v[124:127], v[76:79]
  s_waitcnt vmcnt(12) lgkmcnt(0)
  v_max3_u32 v12, v128, v132, v136
  v_max_u32 v12, v12, v140
  v_cmp_eq_u32 vcc, -1, v12
  s_cbranch_vccnz k2_rg7
k2_rg7r:
  v_mfma_f32_16x16x32_bf16 v[16:19], v[192:195], v[128:131], v[16:19]
  ds_read_b64_tr_b16 v[176:177], v232 offset:16384
  v_mfma_f32_16x16x32_bf16 v[20:23], v[192:195], v[132:135], v[20:23]
  v_mfma_f32_16x16x32_bf16 v[24:27], v[192:195], v[136:139], v[24:27]
  ds_read_b64_tr_b16 v[178:179], v232 offset:17408
  v_mfma_f32_16x16x32_bf16 v[28:31], v[192:195], v[140:143], v[28:31]
  v_mfma_f32_16x16x32_bf16 v[32:35], v[196:199], v[128:131], v[32:35]
  ds_read_b64_tr_b16 v[180:181], v233 offset:16384
  v_mfma_f32_16x16x32_bf16 v[36:39], v[196:199], v[132:135], v[36:39]
  v_mfma_f32_16x16x32_bf16 v[40:43], v[196:199], v[136:139], v[40:43]
  ds_read_b64_tr_b16 v[182:183], v233 offset:17408
  v_mfma_f32_16x16x32_bf16 v[44:47], v[196:199], v[140:143], v[44:47]
  v_mfma_f32_16x16x32_bf16 v[48:51], v[200:203], v[128:131], v[48:51]
  ds_read_b64_tr_b16 v[184:185], v234 offset:16384
  v_mfma_f32_16x16x32_bf16 v[52:55], v[200:203], v[132:135], v[52:55]
  v_mfma_f32_16x16x32_bf16 v[56:59], v[200:203], v[136:139], v[56:59]
  ds_read_b64_tr_b16 v[186:187], v234 offset:17408
  v_mfma_f32_16x16x32_bf16 v[60:63], v[200:203], v[140:143], v[60:63]
  v_mfma_f32_16x16x32_bf16 v[64:67], v[204:207], v[128:131], v[64:67]
  ds_read_b64_tr_b16 v[188:189], v235 offset:16384
  v_mfma_f32_16x16x32_bf16 v[68:71], v[204:207], v[132:135], v[68:71]
  v_mfma_f32_16x16x32_bf16 v[72:75], v[204:207], v[136:139], v[72:75]
  ds_read_b64_tr_b16 v[190:191], v235 offset:17408
  v_mfma_f32_16x16x32_bf16 v[76:79], v[204:207], v[140:143], v[76:79]
  s_waitcnt vmcnt(8) lgkmcnt(0)
  v_max3_u32 v12, v144, v148, v152
  v_max_u32 v12, v12, v156
  v_cmp_eq_u32 vcc, -1, v12
  s_cbranch_vccnz k2_rg8
k2_rg8r:
  v_mfma_f32_16x16x32_bf16 v[16:19], v[176:179], v[144:147], v[16:19]
  ds_read_b64_tr_b16 v[192:193], v232 offset:32768
  v_mfma_f32_16x16x32_bf16 v[20:23], v[176:179], v[148:151], v[20:23]
  v_mfma_f32_16x16x32_bf16 v[24:27], v[176:179], v[152:155], v[24:27]
  ds_read_b64_tr_b16 v[194:195], v232 offset:33792
  v_mfma_f32_16x16x32_bf16 v[28:31], v[176:179], v[156:159], v[28:31]
  v_mfma_f32_16x16x32_bf16 v[32:35], v[180:183], v[144:147], v[32:35]
  ds_read_b64_tr_b16 v[196:197], v233 offset:32768
  v_mfma_f32_16x16x32_bf16 v[36:39], v[180:183], v[148:151], v[36:39]
  v_mfma_f32_16x16x32_bf16 v[40:43], v[180:183], v[152:155], v[40:43]
  ds_read_b64_tr_b16 v[198:199], v233 offset:33792
  v_mfma_f32_16x16x32_bf16 v[44:47], v[180:183], v[156:159], v[44:47]
  v_mfma_f32_16x16x32_bf16 v[48:51], v[184:187], v[144:147], v[48:51]
  ds_read_b64_tr_b16 v[200:201], v234 offset:32768
  v_mfma_f32_16x16x32_bf16 v[52:55], v[184:187], v[148:151], v[52:55]
  v_mfma_f32_16x16x32_bf16 v[56:59], v[184:187], v[152:155], v[56:59]
  ds_read_b64_tr_b16 v[202:203], v234 offset:33792
  v_mfma_f32_16x16x32_bf16 v[60:63], v[184:187], v[156:159], v[60:63]
  v_mfma_f32_16x16x32_bf16 v[64:67], v[188:191], v[144:147], v[64:67]
  ds_read_b64_tr_b16 v[204:205], v235 offset:32768
  v_mfma_f32_16x16x32_bf16 v[68:71], v[188:191], v[148:151], v[68:71]
  v_mfma_f32_16x16x32_bf16 v[72:75], v[188:191], v[152:155], v[72:75]
  ds_read_b64_tr_b16 v[206:207], v235 offset:33792
  v_mfma_f32_16x16x32_bf16 v[76:79], v[188:191], v[156:159], v[76:79]
  s_waitcnt vmcnt(4) lgkmcnt(0)
  v_max3_u32 v12, v160, v164, v168
  v_max_u32 v12, v12, v172
  v_cmp_eq_u32 vcc, -1, v12
  s_cbranch_vccnz k2_rg9
k2_rg9r:
  v_mfma_f32_16x16x32_bf16 v[16:19], v[192:195], v[160:163], v[16:19]
  ds_read_b64_tr_b16 v[176:177], v240 offset:16384
  v_mfma_f32_16x16x32_bf16 v[20:23], v[192:195], v[164:167], v[20:23]
  v_mfma_f32_16x16x32_bf16 v[24:27], v[192:195], v[168:171], v[24:27]
  ds_read_b64_tr_b16 v[178:179], v240 offset:17408
  v_mfma_f32_16x16x32_bf16 v[28:31], v[192:195], v[172:175], v[28:31]
  v_mfma_f32_16x16x32_bf16 v[32:35], v[196:199], v[160:163], v[32:35]
  ds_read_b64_tr_b16 v[180:181], v241 offset:16384
  v_mfma_f32_16x16x32_bf16 v[36:39], v[196:199], v[164:167], v[36:39]
  v_mfma_f32_16x16x32_bf16 v[40:43], v[196:199], v[168:171], v[40:43]
  ds_read_b64_tr_b16 v[182:183], v241 offset:17408
  v_mfma_f32_16x16x32_bf16 v[44:47], v[196:199], v[172:175], v[44:47]
  v_mfma_f32_16x16x32_bf16 v[48:51], v[200:203], v[160:163], v[48:51]
  ds_read_b64_tr_b16 v[184:185], v242 offset:16384
  v_mfma_f32_16x16x32_bf16 v[52:55], v[200:203], v[164:167], v[52:55]
  v_mfma_f32_16x16x32_bf16 v[56:59], v[200:203], v[168:171], v[56:59]
  ds_read_b64_tr_b16 v[186:187], v242 offset:17408
  v_mfma_f32_16x16x32_bf16 v[60:63], v[200:203], v[172:175], v[60:63]
  v_mfma_f32_16x16x32_bf16 v[64:67], v[204:207], v[160:163], v[64:67]
  ds_read_b64_tr_b16 v[188:189], v243 offset:16384
  v_mfma_f32_16x16x32_bf16 v[68:71], v[204:207], v[164:167], v[68:71]
  v_mfma_f32_16x16x32_bf16 v[72:75], v[204:207], v[168:171], v[72:75]
  ds_read_b64_tr_b16 v[190:191], v243 offset:17408
  v_mfma_f32_16x16x32_bf16 v[76:79], v[204:207], v[172:175], v[76:79]
  s_waitcnt vmcnt(0) lgkmcnt(0)
  v_max3_u32 v12, v80, v84, v88
  v_max_u32 v12, v12, v92
  v_cmp_eq_u32 vcc, -1, v12
  s_cbranch_vccnz k2_rg10
k2_rg10r:
  v_max_u32 v12, v208, v210
  v_cmp_eq_u32 vcc, -1, v12
  s_cbranch_vccnz k2_rx
k2_rxr:
  v_mfma_f32_16x16x32_bf16 v[16:19], v[176:179], v[80:83], v[16:19]
  v_mfma_f32_16x16x32_bf16 v[20:23], v[176:179], v[84:87], v[20:23]
  v_mfma_f32_16x16x32_bf16 v[24:27], v[176:179], v[88:91], v[24:27]
  v_mfma_f32_16x16x32_bf16 v[28:31], v[176:179], v[92:95], v[28:31]
  v_mfma_f32_16x16x32_bf16 v[32:35], v[180:183], v[80:83], v[32:35]
  v_mfma_f32_16x16x32_bf16 v[36:39], v[180:183], v[84:87], v[36:39]
  v_mfma_f32_16x16x32_bf16 v[40:43], v[180:183], v[88:91], v[40:43]
  v_mfma_f32_16x16x32_bf16 v[44:47], v[180:183], v[92:95], v[44:47]
  v_mfma_f32_16x16x32_bf16 v[48:51], v[184:187], v[80:83], v[48:51]
  ds_write_b128 v220, v[16:19] offset:0
  v_mfma_f32_16x16x32_bf16 v[52:55], v[184:187], v[84:87], v[52:55]
  ds_write_b128 v220, v[20:23] offset:16384
  v_mfma_f32_16x16x32_bf16 v[56:59], v[184:187], v[88:91], v[56:59]
  ds_write_b128 v220, v[24:27] offset:32768
  v_mfma_f32_16x16x32_bf16 v[60:63], v[184:187], v[92:95], v[60:63]
  ds_write_b128 v220, v[28:31] offset:49152
  v_mfma_f32_16x16x32_bf16 v[64:67], v[188:191], v[80:83], v[64:67]
  ds_write_b128 v221, v[32:35] offset:0
  v_mfma_f32_16x16x32_bf16 v[68:71], v[188:191], v[84:87], v[68:71]
  ds_write_b128 v221, v[36:39] offset:16384
  v_mfma_f32_16x16x32_bf16 v[72:75], v[188:191], v[88:91], v[72:75]
  ds_write_b128 v221, v[40:43] offset:32768
  v_mfma_f32_16x16x32_bf16 v[76:79], v[188:191], v[92:95], v[76:79]
  ds_write_b128 v221, v[44:47] offset:49152
  ds_write_b128 v222, v[48:51] offset:0
  ds_write_b128 v222, v[52:55] offset:16384
  ds_write_b128 v222, v[56:59] offset:32768
  ds_write_b128 v222, v[60:63] offset:49152
  s_nop 1
  ds_write_b128 v223, v[64:67] offset:0
  ds_write_b128 v223, v[68:71] offset:16384
  ds_write_b128 v223, v[72:75] offset:32768
  ds_write_b128 v223, v[76:79] offset:49152
  s_waitcnt lgkmcnt(0)
  s_barrier
  ds_read_b128 v[16:19], v229 offset:0
  ds_read_b128 v[20:23], v230 offset:0
  ds_read_b128 v[24:27], v229 offset:4096
  ds_read_b128 v[28:31], v230 offset:4096
  ds_read_b128 v[32:35], v229 offset:8192
  ds_read_b128 v[36:39], v230 offset:8192
  ds_read_b128 v[40:43], v229 offset:12288
  ds_read_b128 v[44:47], v230 offset:12288
  v_lshlrev_b32 v96, 16, v208
  v_and_b32 v97, 0xffff0000, v208
  v_lshlrev_b32 v98, 16, v209
  v_and_b32 v99, 0xffff0000, v209
  v_lshlrev_b32 v100, 16, v210
  v_and_b32 v101, 0xffff0000, v210
  v_lshlrev_b32 v102, 16, v211
  v_and_b32 v103, 0xffff0000, v211
  s_waitcnt lgkmcnt(4)
  v_pk_add_f32 v[16:17], v[16:17], v[24:25]
  v_pk_add_f32 v[18:19], v[18:19], v[26:27]
  v_pk_add_f32 v[20:21], v[20:21], v[28:29]
  v_pk_add_f32 v[22:23], v[22:23], v[30:31]
  s_waitcnt lgkmcnt(0)
  v_pk_add_f32 v[32:33], v[32:33], v[40:41]
  v_pk_add_f32 v[34:35], v[34:35], v[42:43]
  v_pk_add_f32 v[36:37], v[36:37], v[44:45]
  v_pk_add_f32 v[38:39], v[38:39], v[46:47]
  v_pk_add_f32 v[16:17], v[16:17], v[32:33]
  v_pk_add_f32 v[18:19], v[18:19], v[34:35]
  v_pk_add_f32 v[20:21], v[20:21], v[36:37]
  v_pk_add_f32 v[22:23], v[22:23], v[38:39]
  v_pk_fma_f32 v[96:97], v[16:17], v[244:245], v[96:97]
  v_pk_fma_f32 v[98:99], v[18:19], v[246:247], v[98:99]
  v_pk_fma_f32 v[100:101], v[20:21], v[248:249], v[100:101]
  v_pk_fma_f32 v[102:103], v[22:23], v[250:251], v[102:103]
  v_cvt_pk_bf16_f32 v208, v96, v97
  v_cvt_pk_bf16_f32 v209, v98, v99
  v_cvt_pk_bf16_f32 v210, v100, v101
  v_cvt_pk_bf16_f32 v211, v102, v103
  buffer_store_dwordx4 v[208:211], v228, s[64:67], s42 offen
  s_branch k2_fin
k2_t1:
  s_load_dwordx2 s[68:69], s[0:1], 0
  s_load_dwordx2 s[70:71], s[0:1], 96
  s_sub_u32 s35, 15, s31
  s_cmp_lt_u32 s30, 16
  s_cselect_b32 s32, s31, s35
  s_cselect_b32 s37, 4, 0
  s_and_b32 s40, s30, 15
  s_mul_i32 s41, s45, 44032
  s_mul_i32 s35, s40, 192
  s_add_u32 s41, s41, s35
  s_mul_i32 s48, s45, 3072
  v_add_u32 v208, 0, v0
  v_mul_u32_u24 v209, 43691, v208
  v_lshrrev_b32 v209, 19, v209
  v_mul_u32_u24 v210, 12, v209
  v_sub_u32 v210, v208, v210
  v_mul_u32_u24 v216, 2752, v209
  v_lshl_add_u32 v216, v210, 4, v216
  v_add_u32 v208, 64, v0
  v_mul_u32_u24 v209, 43691, v208
  v_lshrrev_b32 v209, 19, v209
  v_mul_u32_u24 v210, 12, v209
  v_sub_u32 v210, v208, v210
  v_mul_u32_u24 v217, 2752, v209
  v_lshl_add_u32 v217, v210, 4, v217
  v_add_u32 v208, 128, v0
  v_mul_u32_u24 v209, 43691, v208
  v_lshrrev_b32 v209, 19, v209
  v_mul_u32_u24 v210, 12, v209
  v_sub_u32 v210, v208, v210
  v_mul_u32_u24 v218, 2752, v209
  v_lshl_add_u32 v218, v210, 4, v218
  s_mov_b32 s8, s80
  s_mov_b32 s9, s81
  s_mov_b32 s10, 1409024
  s_mov_b32 s11, 0x20000
  s_mov_b32 s16, s82
  s_mov_b32 s17, s83
  s_mov_b32 s18, 1409024
  s_mov_b32 s19, 0x20000
  s_lshl_b32 s35, s45, 1
  v_bfe_u32 v208, v0, 3, 1
  v_lshrrev_b32 v209, 4, v0
  v_lshl_add_u32 v208, v209, 3, v208
  v_add_u32 v208, s35, v208
  v_and_b32 v209, 7, v0
  v_lshlrev_b32 v220, 9, v208
  v_lshl_add_u32 v220, v209, 4, v220
  v_lshrrev_b32 v210, 1, v208
  v_lshlrev_b32 v210, 4, v210
  v_and_b32 v211, 1, v208
  v_lshl_add_u32 v210, v211, 2, v210
  v_lshlrev_b32 v222, 2, v210
  v_lshlrev_b32 v221, 10, v209
  v_lshl_add_u32 v221, v210, 1, v221
  s_lshl_b32 s35, s45, 3
  v_lshlrev_b32 v227, 5, v209
  v_add_u32 v227, 147456, v227
  v_add_u32 v226, s35, v227
  s_lshl_b32 s42, s32, 7
  s_lshl_b32 s35, s40, 3
  s_add_u32 s42, s42, s35
  s_lshr_b32 s50, s40, 2
  s_add_u32 s50, s50, s37
  s_lshl_b32 s50, s50, 15
  s_and_b32 s35, s40, 3
  s_lshl_b32 s35, s35, 7
  s_add_u32 s50, s50, s35
  s_lshl_b32 s42, s42, 10
  v_add_u32 v222, 155648, v222
  s_waitcnt lgkmcnt(0)
  s_mov_b32 s64, s68
  s_mov_b32 s65, s69
  s_mov_b32 s66, 2097152
  s_mov_b32 s67, 0x20000
  buffer_load_dwordx2 v[80:81], v221, s[64:67], s42 offen offset:0
  buffer_load_dwordx2 v[82:83], v221, s[64:67], s42 offen offset:16
  ds_read_b128 v[88:91], v222 offset:0
  ds_read_b128 v[120:123], v222 offset:2048
  ds_read_b128 v[104:107], v222 offset:4096
  ds_read_b128 v[92:95], v222 offset:32
  ds_read_b128 v[124:127], v222 offset:2080
  ds_read_b128 v[108:111], v222 offset:4128
  buffer_load_dwordx2 v[84:85], v221, s[64:67], s42 offen offset:512
  buffer_load_dwordx2 v[86:87], v221, s[64:67], s42 offen offset:528
  ds_read_b128 v[96:99], v222 offset:1024
  ds_read_b128 v[128:131], v222 offset:3072
  ds_read_b128 v[112:115], v222 offset:5120
  ds_read_b128 v[100:103], v222 offset:1056
  ds_read_b128 v[132:135], v222 offset:3104
  ds_read_b128 v[116:119], v222 offset:5152
  s_and_b32 s35, s30, 7
  s_lshl_b32 s35, s35, 8
  s_add_u32 s35, s35, 161792
  v_and_b32 v209, 7, v0
  v_lshlrev_b32 v209, 5, v209
  v_add_u32 v209, s35, v209
  ds_read_b128 v[244:247], v209
  ds_read_b128 v[248:251], v209 offset:16
  v_lshrrev_b32 v232, 3, v0
  v_and_b32 v233, 7, v0
  v_lshrrev_b32 v234, 4, v0
  v_lshlrev_b32 v219, 1, v234
  v_xor_b32 v219, v219, v233
  v_lshlrev_b32 v219, 4, v219
  v_lshl_add_u32 v219, v232, 10, v219
  s_mov_b32 s20, s84
  s_mov_b32 s21, s85
  s_mov_b32 s22, 1409024
  s_mov_b32 s23, 0x20000
  s_lshl_b32 s49, s45, 12
  s_mul_i32 s39, s45, 98304
  s_and_b32 s35, s30, 7
  s_lshl_b32 s35, s35, 7
  s_add_u32 s39, s39, s35
  v_mov_b32 v228, 147968
  v_mov_b32 v229, 0
  ds_write_b32 v228, v229
  v_mov_b32 v229, 1
  s_waitcnt lgkmcnt(0)
  s_barrier
  s_add_u32 s35, s50, 0
  buffer_load_dwordx4 v[16:19], v220, s[24:27], s35 offen sc1
  s_add_u32 s35, s50, 16384
  buffer_load_dwordx4 v[20:23], v220, s[24:27], s35 offen sc1
  s_add_u32 s35, s50, 262144
  buffer_load_dwordx4 v[24:27], v220, s[24:27], s35 offen sc1
  s_add_u32 s35, s50, 278528
  buffer_load_dwordx4 v[28:31], v220, s[24:27], s35 offen sc1
  s_add_u32 s35, s50, 524288
  buffer_load_dwordx4 v[32:35], v220, s[24:27], s35 offen sc1
  s_add_u32 s35, s50, 540672
  buffer_load_dwordx4 v[36:39], v220, s[24:27], s35 offen sc1
  s_add_u32 s35, s50, 786432
  buffer_load_dwordx4 v[40:43], v220, s[24:27], s35 offen sc1
  s_add_u32 s35, s50, 802816
  buffer_load_dwordx4 v[44:47], v220, s[24:27], s35 offen sc1
  s_add_u32 s35, s50, 1048576
  buffer_load_dwordx4 v[48:51], v220, s[24:27], s35 offen sc1
  s_add_u32 s35, s50, 1064960
  buffer_load_dwordx4 v[52:55], v220, s[24:27], s35 offen sc1
  s_add_u32 s35, s50, 1310720
  buffer_load_dwordx4 v[56:59], v220, s[24:27], s35 offen sc1
  s_add_u32 s35, s50, 1327104
  buffer_load_dwordx4 v[60:63], v220, s[24:27], s35 offen sc1
  s_add_u32 s35, s50, 1572864
  buffer_load_dwordx4 v[64:67], v220, s[24:27], s35 offen sc1
  s_add_u32 s35, s50, 1589248
  buffer_load_dwordx4 v[68:71], v220, s[24:27], s35 offen sc1
  s_add_u32 s35, s50, 1835008
  buffer_load_dwordx4 v[72:75], v220, s[24:27], s35 offen sc1
  s_add_u32 s35, s50, 1851392
  buffer_load_dwordx4 v[76:79], v220, s[24:27], s35 offen sc1
  s_waitcnt vmcnt(14)
  v_lshlrev_b32 v160, 16, v80
  v_and_b32 v161, 0xffff0000, v80
  v_lshlrev_b32 v162, 16, v81
  v_and_b32 v163, 0xffff0000, v81
  v_lshlrev_b32 v164, 16, v82
  v_and_b32 v165, 0xffff0000, v82
  v_lshlrev_b32 v166, 16, v83
  v_and_b32 v167, 0xffff0000, v83
  v_lshlrev_b32 v168, 16, v84
  v_and_b32 v169, 0xffff0000, v84
  v_lshlrev_b32 v170, 16, v85
  v_and_b32 v171, 0xffff0000, v85
  v_lshlrev_b32 v172, 16, v86
  v_and_b32 v173, 0xffff0000, v86
  v_lshlrev_b32 v174, 16, v87
  v_and_b32 v175, 0xffff0000, v87
  v_max_u32 v12, v16, v20
  v_cmp_eq_u32 vcc, -1, v12
  s_cbranch_vccnz k2_rp0
k2_rp0r:
  v_lshlrev_b32 v136, 16, v16
  v_and_b32 v137, 0xffff0000, v16
  v_lshlrev_b32 v138, 16, v17
  v_and_b32 v139, 0xffff0000, v17
  v_lshlrev_b32 v140, 16, v18
  v_and_b32 v141, 0xffff0000, v18
  v_lshlrev_b32 v142, 16, v19
  v_and_b32 v143, 0xffff0000, v19
  v_lshlrev_b32 v144, 16, v20
  v_and_b32 v145, 0xffff0000, v20
  v_lshlrev_b32 v146, 16, v21
  v_and_b32 v147, 0xffff0000, v21
  v_lshlrev_b32 v148, 16, v22
  v_and_b32 v149, 0xffff0000, v22
  v_lshlrev_b32 v150, 16, v23
  v_and_b32 v151, 0xffff0000, v23
  s_waitcnt vmcnt(12)
  v_max_u32 v12, v24, v28
  v_cmp_eq_u32 vcc, -1, v12
  s_cbranch_vccnz k2_rp1
k2_rp1r:
  v_lshlrev_b32 v176, 16, v24
  v_and_b32 v177, 0xffff0000, v24
  v_lshlrev_b32 v178, 16, v25
  v_and_b32 v179, 0xffff0000, v25
  v_lshlrev_b32 v180, 16, v26
  v_and_b32 v181, 0xffff0000, v26
  v_lshlrev_b32 v182, 16, v27
  v_and_b32 v183, 0xffff0000, v27
  v_lshlrev_b32 v184, 16, v28
  v_and_b32 v185, 0xffff0000, v28
  v_lshlrev_b32 v186, 16, v29
  v_and_b32 v187, 0xffff0000, v29
  v_lshlrev_b32 v188, 16, v30
  v_and_b32 v189, 0xffff0000, v30
  v_lshlrev_b32 v190, 16, v31
  v_and_b32 v191, 0xffff0000, v31
  v_pk_add_f32 v[136:137], v[136:137], v[176:177]
  v_pk_add_f32 v[138:139], v[138:139], v[178:179]
  v_pk_add_f32 v[140:141], v[140:141], v[180:181]
  v_pk_add_f32 v[142:143], v[142:143], v[182:183]
  v_pk_add_f32 v[144:145], v[144:145], v[184:185]
  v_pk_add_f32 v[146:147], v[146:147], v[186:187]
  v_pk_add_f32 v[148:149], v[148:149], v[188:189]
  v_pk_add_f32 v[150:151], v[150:151], v[190:191]
  s_waitcnt vmcnt(10)
  v_max_u32 v12, v32, v36
  v_cmp_eq_u32 vcc, -1, v12
  s_cbranch_vccnz k2_rp2
k2_rp2r:
  v_lshlrev_b32 v176, 16, v32
  v_and_b32 v177, 0xffff0000, v32
  v_lshlrev_b32 v178, 16, v33
  v_and_b32 v179, 0xffff0000, v33
  v_lshlrev_b32 v180, 16, v34
  v_and_b32 v181, 0xffff0000, v34
  v_lshlrev_b32 v182, 16, v35
  v_and_b32 v183, 0xffff0000, v35
  v_lshlrev_b32 v184, 16, v36
  v_and_b32 v185, 0xffff0000, v36
  v_lshlrev_b32 v186, 16, v37
  v_and_b32 v187, 0xffff0000, v37
  v_lshlrev_b32 v188, 16, v38
  v_and_b32 v189, 0xffff0000, v38
  v_lshlrev_b32 v190, 16, v39
  v_and_b32 v191, 0xffff0000, v39
  v_pk_add_f32 v[136:137], v[136:137], v[176:177]
  v_pk_add_f32 v[138:139], v[138:139], v[178:179]
  v_pk_add_f32 v[140:141], v[140:141], v[180:181]
  v_pk_add_f32 v[142:143], v[142:143], v[182:183]
  v_pk_add_f32 v[144:145], v[144:145], v[184:185]
  v_pk_add_f32 v[146:147], v[146:147], v[186:187]
  v_pk_add_f32 v[148:149], v[148:149], v[188:189]
  v_pk_add_f32 v[150:151], v[150:151], v[190:191]
  s_waitcnt vmcnt(8)
  v_max_u32 v12, v40, v44
  v_cmp_eq_u32 vcc, -1, v12
  s_cbranch_vccnz k2_rp3
k2_rp3r:
  v_lshlrev_b32 v176, 16, v40
  v_and_b32 v177, 0xffff0000, v40
  v_lshlrev_b32 v178, 16, v41
  v_and_b32 v179, 0xffff0000, v41
  v_lshlrev_b32 v180, 16, v42
  v_and_b32 v181, 0xffff0000, v42
  v_lshlrev_b32 v182, 16, v43
  v_and_b32 v183, 0xffff0000, v43
  v_lshlrev_b32 v184, 16, v44
  v_and_b32 v185, 0xffff0000, v44
  v_lshlrev_b32 v186, 16, v45
  v_and_b32 v187, 0xffff0000, v45
  v_lshlrev_b32 v188, 16, v46
  v_and_b32 v189, 0xffff0000, v46
  v_lshlrev_b32 v190, 16, v47
  v_and_b32 v191, 0xffff0000, v47
  v_pk_add_f32 v[136:137], v[136:137], v[176:177]
  v_pk_add_f32 v[138:139], v[138:139], v[178:179]
  v_pk_add_f32 v[140:141], v[140:141], v[180:181]
  v_pk_add_f32 v[142:143], v[142:143], v[182:183]
  v_pk_add_f32 v[144:145], v[144:145], v[184:185]
  v_pk_add_f32 v[146:147], v[146:147], v[186:187]
  v_pk_add_f32 v[148:149], v[148:149], v[188:189]
  v_pk_add_f32 v[150:151], v[150:151], v[190:191]
  s_waitcnt vmcnt(6)
  v_max_u32 v12, v48, v52
  v_cmp_eq_u32 vcc, -1, v12
  s_cbranch_vccnz k2_rp4
k2_rp4r:
  v_lshlrev_b32 v176, 16, v48
  v_and_b32 v177, 0xffff0000, v48
  v_lshlrev_b32 v178, 16, v49
  v_and_b32 v179, 0xffff0000, v49
  v_lshlrev_b32 v180, 16, v50
  v_and_b32 v181, 0xffff0000, v50
  v_lshlrev_b32 v182, 16, v51
  v_and_b32 v183, 0xffff0000, v51
  v_lshlrev_b32 v184, 16, v52
  v_and_b32 v185, 0xffff0000, v52
  v_lshlrev_b32 v186, 16, v53
  v_and_b32 v187, 0xffff0000, v53
  v_lshlrev_b32 v188, 16, v54
  v_and_b32 v189, 0xffff0000, v54
  v_lshlrev_b32 v190, 16, v55
  v_and_b32 v191, 0xffff0000, v55
  v_pk_add_f32 v[136:137], v[136:137], v[176:177]
  v_pk_add_f32 v[138:139], v[138:139], v[178:179]
  v_pk_add_f32 v[140:141], v[140:141], v[180:181]
  v_pk_add_f32 v[142:143], v[142:143], v[182:183]
  v_pk_add_f32 v[144:145], v[144:145], v[184:185]
  v_pk_add_f32 v[146:147], v[146:147], v[186:187]
  v_pk_add_f32 v[148:149], v[148:149], v[188:189]
  v_pk_add_f32 v[150:151], v[150:151], v[190:191]
  s_waitcnt vmcnt(4)
  v_max_u32 v12, v56, v60
  v_cmp_eq_u32 vcc, -1, v12
  s_cbranch_vccnz k2_rp5
k2_rp5r:
  v_lshlrev_b32 v176, 16, v56
  v_and_b32 v177, 0xffff0000, v56
  v_lshlrev_b32 v178, 16, v57
  v_and_b32 v179, 0xffff0000, v57
  v_lshlrev_b32 v180, 16, v58
  v_and_b32 v181, 0xffff0000, v58
  v_lshlrev_b32 v182, 16, v59
  v_and_b32 v183, 0xffff0000, v59
  v_lshlrev_b32 v184, 16, v60
  v_and_b32 v185, 0xffff0000, v60
  v_lshlrev_b32 v186, 16, v61
  v_and_b32 v187, 0xffff0000, v61
  v_lshlrev_b32 v188, 16, v62
  v_and_b32 v189, 0xffff0000, v62
  v_lshlrev_b32 v190, 16, v63
  v_and_b32 v191, 0xffff0000, v63
  v_pk_add_f32 v[136:137], v[136:137], v[176:177]
  v_pk_add_f32 v[138:139], v[138:139], v[178:179]
  v_pk_add_f32 v[140:141], v[140:141], v[180:181]
  v_pk_add_f32 v[142:143], v[142:143], v[182:183]
  v_pk_add_f32 v[144:145], v[144:145], v[184:185]
  v_pk_add_f32 v[146:147], v[146:147], v[186:187]
  v_pk_add_f32 v[148:149], v[148:149], v[188:189]
  v_pk_add_f32 v[150:151], v[150:151], v[190:191]
  s_waitcnt vmcnt(2)
  v_max_u32 v12, v64, v68
  v_cmp_eq_u32 vcc, -1, v12
  s_cbranch_vccnz k2_rp6
k2_rp6r:
  v_lshlrev_b32 v176, 16, v64
  v_and_b32 v177, 0xffff0000, v64
  v_lshlrev_b32 v178, 16, v65
  v_and_b32 v179, 0xffff0000, v65
  v_lshlrev_b32 v180, 16, v66
  v_and_b32 v181, 0xffff0000, v66
  v_lshlrev_b32 v182, 16, v67
  v_and_b32 v183, 0xffff0000, v67
  v_lshlrev_b32 v184, 16, v68
  v_and_b32 v185, 0xffff0000, v68
  v_lshlrev_b32 v186, 16, v69
  v_and_b32 v187, 0xffff0000, v69
  v_lshlrev_b32 v188, 16, v70
  v_and_b32 v189, 0xffff0000, v70
  v_lshlrev_b32 v190, 16, v71
  v_and_b32 v191, 0xffff0000, v71
  v_pk_add_f32 v[136:137], v[136:137], v[176:177]
  v_pk_add_f32 v[138:139], v[138:139], v[178:179]
  v_pk_add_f32 v[140:141], v[140:141], v[180:181]
  v_pk_add_f32 v[142:143], v[142:143], v[182:183]
  v_pk_add_f32 v[144:145], v[144:145], v[184:185]
  v_pk_add_f32 v[146:147], v[146:147], v[186:187]
  v_pk_add_f32 v[148:149], v[148:149], v[188:189]
  v_pk_add_f32 v[150:151], v[150:151], v[190:191]
  s_waitcnt vmcnt(0)
  v_max_u32 v12, v72, v76
  v_cmp_eq_u32 vcc, -1, v12
  s_cbranch_vccnz k2_rp7
k2_rp7r:
  v_lshlrev_b32 v176, 16, v72
  v_and_b32 v177, 0xffff0000, v72
  v_lshlrev_b32 v178, 16, v73
  v_and_b32 v179, 0xffff0000, v73
  v_lshlrev_b32 v180, 16, v74
  v_and_b32 v181, 0xffff0000, v74
  v_lshlrev_b32 v182, 16, v75
  v_and_b32 v183, 0xffff0000, v75
  v_lshlrev_b32 v184, 16, v76
  v_and_b32 v185, 0xffff0000, v76
  v_lshlrev_b32 v186, 16, v77
  v_and_b32 v187, 0xffff0000, v77
  v_lshlrev_b32 v188, 16, v78
  v_and_b32 v189, 0xffff0000, v78
  v_lshlrev_b32 v190, 16, v79
  v_and_b32 v191, 0xffff0000, v79
  v_pk_add_f32 v[136:137], v[136:137], v[176:177]
  v_pk_add_f32 v[138:139], v[138:139], v[178:179]
  v_pk_add_f32 v[140:141], v[140:141], v[180:181]
  v_pk_add_f32 v[142:143], v[142:143], v[182:183]
  v_pk_add_f32 v[144:145], v[144:145], v[184:185]
  v_pk_add_f32 v[146:147], v[146:147], v[186:187]
  v_pk_add_f32 v[148:149], v[148:149], v[188:189]
  v_pk_add_f32 v[150:151], v[150:151], v[190:191]
  v_pk_fma_f32 v[160:161], v[136:137], v[88:89], v[160:161]
  v_pk_fma_f32 v[162:163], v[138:139], v[90:91], v[162:163]
  v_pk_fma_f32 v[164:165], v[140:141], v[92:93], v[164:165]
  v_pk_fma_f32 v[166:167], v[142:143], v[94:95], v[166:167]
  v_pk_fma_f32 v[168:169], v[144:145], v[96:97], v[168:169]
  v_pk_fma_f32 v[170:171], v[146:147], v[98:99], v[170:171]
  v_pk_fma_f32 v[172:173], v[148:149], v[100:101], v[172:173]
  v_pk_fma_f32 v[174:175], v[150:151], v[102:103], v[174:175]
  v_cvt_pk_bf16_f32 v80, v160, v161
  v_cvt_pk_bf16_f32 v81, v162, v163
  v_cvt_pk_bf16_f32 v82, v164, v165
  v_cvt_pk_bf16_f32 v83, v166, v167
  v_cvt_pk_bf16_f32 v84, v168, v169
  v_cvt_pk_bf16_f32 v85, v170, v171
  v_cvt_pk_bf16_f32 v86, v172, v173
  v_cvt_pk_bf16_f32 v87, v174, v175
  v_lshlrev_b32 v160, 16, v80
  v_and_b32 v161, 0xffff0000, v80
  v_lshlrev_b32 v162, 16, v81
  v_and_b32 v163, 0xffff0000, v81
  v_lshlrev_b32 v164, 16, v82
  v_and_b32 v165, 0xffff0000, v82
  v_lshlrev_b32 v166, 16, v83
  v_and_b32 v167, 0xffff0000, v83
  v_lshlrev_b32 v168, 16, v84
  v_and_b32 v169, 0xffff0000, v84
  v_lshlrev_b32 v170, 16, v85
  v_and_b32 v171, 0xffff0000, v85
  v_lshlrev_b32 v172, 16, v86
  v_and_b32 v173, 0xffff0000, v86
  v_lshlrev_b32 v174, 16, v87
  v_and_b32 v175, 0xffff0000, v87
  v_pk_add_f32 v[176:177], v[160:161], v[168:169]
  v_pk_add_f32 v[178:179], v[162:163], v[170:171]
  v_pk_add_f32 v[180:181], v[164:165], v[172:173]
  v_pk_add_f32 v[182:183], v[166:167], v[174:175]
  v_pk_add_f32 v[176:177], v[176:177], v[180:181]
  v_pk_add_f32 v[178:179], v[178:179], v[182:183]
  v_pk_add_f32 v[176:177], v[176:177], v[178:179]
  v_add_f32 v224, v176, v177
  s_nop 1
  v_add_f32_dpp v224, v224, v224 row_ror:8 row_mask:0xf bank_mask:0xf
  v_mov_b32 v208, v224
  s_nop 1
  v_permlane16_swap_b32 v208, v224
  s_nop 0
  v_add_f32 v224, v224, v208
  v_mov_b32 v208, v224
  s_nop 1
  v_permlane32_swap_b32 v208, v224
  s_nop 0
  v_add_f32 v224, v224, v208
  v_mul_f32 v224, 0x3c000000, v224
  v_pk_add_f32 v[136:137], v[160:161], v[224:225] op_sel_hi:[1,0] neg_lo:[0,1] neg_hi:[0,1]
  v_pk_add_f32 v[138:139], v[162:163], v[224:225] op_sel_hi:[1,0] neg_lo:[0,1] neg_hi:[0,1]
  v_pk_add_f32 v[140:141], v[164:165], v[224:225] op_sel_hi:[1,0] neg_lo:[0,1] neg_hi:[0,1]
  v_pk_add_f32 v[142:143], v[166:167], v[224:225] op_sel_hi:[1,0] neg_lo:[0,1] neg_hi:[0,1]
  v_pk_add_f32 v[144:145], v[168:169], v[224:225] op_sel_hi:[1,0] neg_lo:[0,1] neg_hi:[0,1]
  v_pk_add_f32 v[146:147], v[170:171], v[224:225] op_sel_hi:[1,0] neg_lo:[0,1] neg_hi:[0,1]
  v_pk_add_f32 v[148:149], v[172:173], v[224:225] op_sel_hi:[1,0] neg_lo:[0,1] neg_hi:[0,1]
  v_pk_add_f32 v[150:151], v[174:175], v[224:225] op_sel_hi:[1,0] neg_lo:[0,1] neg_hi:[0,1]
  v_pk_mul_f32 v[176:177], v[136:137], v[136:137]
  v_pk_mul_f32 v[178:179], v[138:139], v[138:139]
  v_pk_fma_f32 v[176:177], v[140:141], v[140:141], v[176:177]
  v_pk_fma_f32 v[178:179], v[142:143], v[142:143], v[178:179]
  v_pk_fma_f32 v[176:177], v[144:145], v[144:145], v[176:177]
  v_pk_fma_f32 v[178:179], v[146:147], v[146:147], v[178:179]
  v_pk_fma_f32 v[176:177], v[148:149], v[148:149], v[176:177]
  v_pk_fma_f32 v[178:179], v[150:151], v[150:151], v[178:179]
  v_pk_add_f32 v[176:177], v[176:177], v[178:179]
  v_add_f32 v225, v176, v177
  s_nop 1
  v_add_f32_dpp v225, v225, v225 row_ror:8 row_mask:0xf bank_mask:0xf
  v_mov_b32 v208, v225
  s_nop 1
  v_permlane16_swap_b32 v208, v225
  s_nop 0
  v_add_f32 v225, v225, v208
  v_mov_b32 v208, v225
  s_nop 1
  v_permlane32_swap_b32 v208, v225
  s_nop 0
  v_add_f32 v225, v225, v208
  ds_write_b64 v226, v[224:225]
  s_add_u32 s42, s50, 2097152
  s_add_u32 s36, s50, 2113536
  s_mov_b64 exec, 1
  ds_add_u32 v228, v229
  s_mov_b64 exec, -1
  s_mov_b32 s33, 0x100000
k2_stl:
  ds_read_b32 v208, v228
  ds_read_b128 v[152:155], v227
  ds_read_b128 v[156:159], v227 offset:16
  s_waitcnt lgkmcnt(0)
  v_readfirstlane_b32 s35, v208
  s_sub_u32 s33, s33, 1
  s_cbranch_scc1 k2_stg
  s_cmp_lt_u32 s35, 4
  s_cbranch_scc1 k2_stl
k2_stg:
  v_add_f32 v224, v152, v154
  v_add_f32 v208, v156, v158
  v_add_f32 v224, v224, v208
  v_mul_f32 v224, 0x3e800000, v224
  v_add_f32 v225, v153, v155
  v_add_f32 v208, v157, v159
  v_add_f32 v225, v225, v208
  v_mov_b32 v209, 0
  v_sub_f32 v208, v152, v224
  v_fmac_f32 v209, v208, v208
  v_sub_f32 v208, v154, v224
  v_fmac_f32 v209, v208, v208
  v_sub_f32 v208, v156, v224
  v_fmac_f32 v209, v208, v208
  v_sub_f32 v208, v158, v224
  v_fmac_f32 v209, v208, v208
  v_fmac_f32 v225, 0x43000000, v209
  v_mov_b32 v208, 0x3727c5ac
  v_fmac_f32 v208, 0x3b000000, v225
  v_rsq_f32 v225, v208
  s_nop 0
  v_pk_add_f32 v[160:161], v[160:161], v[224:225] op_sel_hi:[1,0] neg_lo:[0,1] neg_hi:[0,1]
  v_pk_add_f32 v[162:163], v[162:163], v[224:225] op_sel_hi:[1,0] neg_lo:[0,1] neg_hi:[0,1]
  v_pk_add_f32 v[164:165], v[164:165], v[224:225] op_sel_hi:[1,0] neg_lo:[0,1] neg_hi:[0,1]
  v_pk_add_f32 v[166:167], v[166:167], v[224:225] op_sel_hi:[1,0] neg_lo:[0,1] neg_hi:[0,1]
  v_pk_add_f32 v[168:169], v[168:169], v[224:225] op_sel_hi:[1,0] neg_lo:[0,1] neg_hi:[0,1]
  v_pk_add_f32 v[170:171], v[170:171], v[224:225] op_sel_hi:[1,0] neg_lo:[0,1] neg_hi:[0,1]
  v_pk_add_f32 v[172:173], v[172:173], v[224:225] op_sel_hi:[1,0] neg_lo:[0,1] neg_hi:[0,1]
  v_pk_add_f32 v[174:175], v[174:175], v[224:225] op_sel_hi:[1,0] neg_lo:[0,1] neg_hi:[0,1]
  v_pk_mul_f32 v[160:161], v[160:161], v[224:225] op_sel:[0,1] op_sel_hi:[1,1]
  v_pk_mul_f32 v[162:163], v[162:163], v[224:225] op_sel:[0,1] op_sel_hi:[1,1]
  v_pk_mul_f32 v[164:165], v[164:165], v[224:225] op_sel:[0,1] op_sel_hi:[1,1]
  v_pk_mul_f32 v[166:167], v[166:167], v[224:225] op_sel:[0,1] op_sel_hi:[1,1]
  v_pk_mul_f32 v[168:169], v[168:169], v[224:225] op_sel:[0,1] op_sel_hi:[1,1]
  v_pk_mul_f32 v[170:171], v[170:171], v[224:225] op_sel:[0,1] op_sel_hi:[1,1]
  v_pk_mul_f32 v[172:173], v[172:173], v[224:225] op_sel:[0,1] op_sel_hi:[1,1]
  v_pk_mul_f32 v[174:175], v[174:175], v[224:225] op_sel:[0,1] op_sel_hi:[1,1]
  v_pk_fma_f32 v[160:161], v[160:161], v[104:105], v[120:121]
  v_pk_fma_f32 v[162:163], v[162:163], v[106:107], v[122:123]
  v_pk_fma_f32 v[164:165], v[164:165], v[108:109], v[124:125]
  v_pk_fma_f32 v[166:167], v[166:167], v[110:111], v[126:127]
  v_pk_fma_f32 v[168:169], v[168:169], v[112:113], v[128:129]
  v_pk_fma_f32 v[170:171], v[170:171], v[114:115], v[130:131]
  v_pk_fma_f32 v[172:173], v[172:173], v[116:117], v[132:133]
  v_pk_fma_f32 v[174:175], v[174:175], v[118:119], v[134:135]
  v_cvt_pk_bf16_f32 v136, v160, v161
  v_cvt_pk_bf16_f32 v137, v162, v163
  v_cvt_pk_bf16_f32 v138, v164, v165
  v_cvt_pk_bf16_f32 v139, v166, v167
  v_cvt_pk_bf16_f32 v140, v168, v169
  v_cvt_pk_bf16_f32 v141, v170, v171
  v_cvt_pk_bf16_f32 v142, v172, v173
  v_cvt_pk_bf16_f32 v143, v174, v175
  buffer_store_dwordx4 v[136:139], v220, s[24:27], s42 offen sc1
  buffer_store_dwordx4 v[140:143], v220, s[24:27], s36 offen sc1
  s_add_u32 s42, s50, 2359296
  s_add_u32 s36, s50, 2375680
  buffer_store_dwordx4 v[80:83], v220, s[24:27], s42 offen sc1
  buffer_store_dwordx4 v[84:87], v220, s[24:27], s36 offen sc1
  s_barrier
  s_cmp_ge_u32 s45, 3
  s_cselect_b32 s72, 1441792, 0
  s_sub_u32 s72, s39, s72
  s_cmp_ge_u32 s45, 2
  s_cselect_b32 s73, 1441792, 0
  s_sub_u32 s73, s39, s73
  v_add_u32 v220, s49, v1
  v_add_u32 v221, 98304, v220
  s_barrier
  s_add_u32 m0, s48, 0
  s_add_u32 s35, s41, 1056768
  buffer_load_dwordx4 v216, s[8:11], s35 offen lds
  s_add_u32 m0, s48, 1024
  s_add_u32 s35, s41, 1056768
  buffer_load_dwordx4 v217, s[8:11], s35 offen lds
  s_add_u32 m0, s48, 2048
  s_add_u32 s35, s41, 1056768
  buffer_load_dwordx4 v218, s[8:11], s35 offen lds
  s_add_u32 m0, s48, 12288
  s_add_u32 s35, s41, 1056768
  buffer_load_dwordx4 v216, s[16:19], s35 offen lds
  s_add_u32 m0, s48, 13312
  s_add_u32 s35, s41, 1056768
  buffer_load_dwordx4 v217, s[16:19], s35 offen lds
  s_add_u32 m0, s48, 14336
  s_add_u32 s35, s41, 1056768
  buffer_load_dwordx4 v218, s[16:19], s35 offen lds
  s_add_u32 m0, s49, 147456
  s_add_u32 s35, s39, 0
  buffer_load_dwordx4 v219, s[20:23], s35 offen lds
  s_add_u32 m0, s49, 148480
  s_add_u32 s35, s39, 8192
  buffer_load_dwordx4 v219, s[20:23], s35 offen lds
  s_add_u32 m0, s49, 149504
  s_add_u32 s35, s39, 16384
  buffer_load_dwordx4 v219, s[20:23], s35 offen lds
  s_add_u32 m0, s49, 150528
  s_add_u32 s35, s39, 24576
  buffer_load_dwordx4 v219, s[20:23], s35 offen lds
  s_barrier
  s_add_u32 m0, s48, 24576
  s_add_u32 s35, s41, 1232896
  buffer_load_dwordx4 v216, s[8:11], s35 offen lds
  s_add_u32 m0, s48, 25600
  s_add_u32 s35, s41, 1232896
  buffer_load_dwordx4 v217, s[8:11], s35 offen lds
  s_add_u32 m0, s48, 26624
  s_add_u32 s35, s41, 1232896
  buffer_load_dwordx4 v218, s[8:11], s35 offen lds
  s_add_u32 m0, s48, 36864
  s_add_u32 s35, s41, 1232896
  buffer_load_dwordx4 v216, s[16:19], s35 offen lds
  s_add_u32 m0, s48, 37888
  s_add_u32 s35, s41, 1232896
  buffer_load_dwordx4 v217, s[16:19], s35 offen lds
  s_add_u32 m0, s48, 38912
  s_add_u32 s35, s41, 1232896
  buffer_load_dwordx4 v218, s[16:19], s35 offen lds
  s_waitcnt vmcnt(0)
  s_barrier
  s_add_u32 m0, s49, 49152
  s_add_u32 s35, s39, 393216
  buffer_load_dwordx4 v219, s[20:23], s35 offen lds
  s_add_u32 m0, s49, 50176
  s_add_u32 s35, s39, 401408
  buffer_load_dwordx4 v219, s[20:23], s35 offen lds
  s_add_u32 m0, s49, 51200
  s_add_u32 s35, s39, 409600
  buffer_load_dwordx4 v219, s[20:23], s35 offen lds
  s_add_u32 m0, s49, 52224
  s_add_u32 s35, s39, 417792
  buffer_load_dwordx4 v219, s[20:23], s35 offen lds
  s_add_u32 m0, s49, 65536
  s_add_u32 s35, s39, 786432
  buffer_load_dwordx4 v219, s[20:23], s35 offen lds
  s_add_u32 m0, s49, 66560
  s_add_u32 s35, s39, 794624
  buffer_load_dwordx4 v219, s[20:23], s35 offen lds
  s_add_u32 m0, s49, 67584
  s_add_u32 s35, s39, 802816
  buffer_load_dwordx4 v219, s[20:23], s35 offen lds
  s_add_u32 m0, s49, 68608
  s_add_u32 s35, s39, 811008
  buffer_load_dwordx4 v219, s[20:23], s35 offen lds
  s_add_u32 m0, s49, 81920
  s_add_u32 s35, s72, 1179648
  buffer_load_dwordx4 v219, s[20:23], s35 offen lds
  s_add_u32 m0, s49, 82944
  s_add_u32 s35, s72, 1187840
  buffer_load_dwordx4 v219, s[20:23], s35 offen lds
  s_add_u32 m0, s49, 83968
  s_add_u32 s35, s72, 1196032
  buffer_load_dwordx4 v219, s[20:23], s35 offen lds
  s_add_u32 m0, s49, 84992
  s_add_u32 s35, s72, 1204224
  buffer_load_dwordx4 v219, s[20:23], s35 offen lds
  s_add_u32 s35, s39, 131072
  buffer_load_dwordx4 v[16:19], v219, s[20:23], s35 offen
  s_add_u32 s35, s39, 139264
  buffer_load_dwordx4 v[20:23], v219, s[20:23], s35 offen
  s_add_u32 s35, s39, 147456
  buffer_load_dwordx4 v[24:27], v219, s[20:23], s35 offen
  s_add_u32 s35, s39, 155648
  buffer_load_dwordx4 v[28:31], v219, s[20:23], s35 offen
  s_add_u32 s35, s39, 524288
  buffer_load_dwordx4 v[32:35], v219, s[20:23], s35 offen
  s_add_u32 s35, s39, 532480
  buffer_load_dwordx4 v[36:39], v219, s[20:23], s35 offen
  s_add_u32 s35, s39, 540672
  buffer_load_dwordx4 v[40:43], v219, s[20:23], s35 offen
  s_add_u32 s35, s39, 548864
  buffer_load_dwordx4 v[44:47], v219, s[20:23], s35 offen
  s_add_u32 s35, s39, 917504
  buffer_load_dwordx4 v[48:51], v219, s[20:23], s35 offen
  s_add_u32 s35, s39, 925696
  buffer_load_dwordx4 v[52:55], v219, s[20:23], s35 offen
  s_add_u32 s35, s39, 933888
  buffer_load_dwordx4 v[56:59], v219, s[20:23], s35 offen
  s_add_u32 s35, s39, 942080
  buffer_load_dwordx4 v[60:63], v219, s[20:23], s35 offen
  s_add_u32 s35, s73, 1310720
  buffer_load_dwordx4 v[64:67], v219, s[20:23], s35 offen
  s_add_u32 s35, s73, 1318912
  buffer_load_dwordx4 v[68:71], v219, s[20:23], s35 offen
  s_add_u32 s35, s73, 1327104
  buffer_load_dwordx4 v[72:75], v219, s[20:23], s35 offen
  s_add_u32 s35, s73, 1335296
  buffer_load_dwordx4 v[76:79], v219, s[20:23], s35 offen
  s_add_u32 s35, s39, 262144
  buffer_load_dwordx4 v[80:83], v219, s[20:23], s35 offen
  s_add_u32 s35, s39, 270336
  buffer_load_dwordx4 v[84:87], v219, s[20:23], s35 offen
  s_add_u32 s35, s39, 278528
  buffer_load_dwordx4 v[88:91], v219, s[20:23], s35 offen
  s_add_u32 s35, s39, 286720
  buffer_load_dwordx4 v[92:95], v219, s[20:23], s35 offen
  s_add_u32 s35, s39, 655360
  buffer_load_dwordx4 v[96:99], v219, s[20:23], s35 offen
  s_add_u32 s35, s39, 663552
  buffer_load_dwordx4 v[100:103], v219, s[20:23], s35 offen
  s_add_u32 s35, s39, 671744
  buffer_load_dwordx4 v[104:107], v219, s[20:23], s35 offen
  s_add_u32 s35, s39, 679936
  buffer_load_dwordx4 v[108:111], v219, s[20:23], s35 offen
  s_bfe_u32 s36, s30, 0x10003
  s_lshr_b32 s43, s37, 1
  s_add_u32 s43, s43, s36
  s_lshl_b32 s49, s45, 12
  s_and_b32 s40, s30, 7
  s_lshl_b32 s43, s43, 16
  s_lshl_b32 s35, s40, 12
  s_add_u32 s43, s43, s35
  s_add_u32 s43, s43, 2359296
  s_lshl_b32 s42, s32, 1
  s_add_u32 s42, s42, s36
  s_lshl_b32 s42, s42, 16
  s_lshl_b32 s35, s40, 7
  s_add_u32 s42, s42, s35
  s_add_u32 s50, s42, 32768
  s_lshl_b32 s35, s45, 3
  v_lshrrev_b32 v216, 3, v0
  v_add_u32 v216, s35, v216
  v_and_b32 v217, 7, v0
  v_lshlrev_b32 v228, 10, v216
  v_lshl_add_u32 v228, v217, 4, v228
  v_lshrrev_b32 v218, 1, v217
  v_lshlrev_b32 v231, 10, v218
  v_lshl_add_u32 v231, v216, 4, v231
  v_and_b32 v218, 1, v217
  v_lshl_add_u32 v231, v218, 3, v231
  s_add_u32 s36, s43, 32768
  buffer_load_dwordx2 v[212:213], v231, s[24:27], s36 offen sc1
  buffer_load_dwordx2 v[214:215], v231, s[24:27], s36 offen offset:512 sc1
  s_mov_b32 s64, s70
  s_mov_b32 s65, s71
  s_mov_b32 s66, 2097152
  s_mov_b32 s67, 0x20000
  v_and_b32 v218, 15, v216
  v_lshlrev_b32 v229, 1, v217
  v_xor_b32 v229, v229, v218
  v_lshlrev_b32 v229, 4, v229
  v_lshl_add_u32 v229, v218, 8, v229
  v_lshrrev_b32 v218, 4, v216
  v_lshl_add_u32 v229, v218, 14, v229
  v_add_u32 v229, 49152, v229
  v_xor_b32 v230, 16, v229
  s_barrier
  s_waitcnt vmcnt(0)
  ds_write_b128 v221, v[16:19] offset:0
  ds_write_b128 v221, v[20:23] offset:1024
  ds_write_b128 v221, v[24:27] offset:2048
  ds_write_b128 v221, v[28:31] offset:3072
  ds_write_b128 v221, v[32:35] offset:16384
  ds_write_b128 v221, v[36:39] offset:17408
  ds_write_b128 v221, v[40:43] offset:18432
  ds_write_b128 v221, v[44:47] offset:19456
  ds_write_b128 v221, v[48:51] offset:32768
  ds_write_b128 v221, v[52:55] offset:33792
  ds_write_b128 v221, v[56:59] offset:34816
  ds_write_b128 v221, v[60:63] offset:35840
  ds_write_b128 v220, v[64:67] offset:0
  ds_write_b128 v220, v[68:71] offset:1024
  ds_write_b128 v220, v[72:75] offset:2048
  ds_write_b128 v220, v[76:79] offset:3072
  ds_write_b128 v220, v[80:83] offset:16384
  ds_write_b128 v220, v[84:87] offset:17408
  ds_write_b128 v220, v[88:91] offset:18432
  ds_write_b128 v220, v[92:95] offset:19456
  ds_write_b128 v220, v[96:99] offset:32768
  ds_write_b128 v220, v[100:103] offset:33792
  ds_write_b128 v220, v[104:107] offset:34816
  ds_write_b128 v220, v[108:111] offset:35840
  s_waitcnt lgkmcnt(0)
  s_barrier
  v_max_u32 v12, v212, v214
  v_cmp_eq_u32 vcc, -1, v12
  s_cbranch_vccnz k2_rx1
k2_rx1r:
  s_barrier
  ds_read_b128 v[16:19], v229 offset:32768
  ds_read_b128 v[20:23], v230 offset:32768
  ds_read_b128 v[24:27], v229 offset:36864
  ds_read_b128 v[28:31], v230 offset:36864
  ds_read_b128 v[32:35], v229 offset:40960
  ds_read_b128 v[36:39], v230 offset:40960
  ds_read_b128 v[40:43], v229 offset:45056
  ds_read_b128 v[44:47], v230 offset:45056
  v_lshlrev_b32 v96, 16, v212
  v_and_b32 v97, 0xffff0000, v212
  v_lshlrev_b32 v98, 16, v213
  v_and_b32 v99, 0xffff0000, v213
  v_lshlrev_b32 v100, 16, v214
  v_and_b32 v101, 0xffff0000, v214
  v_lshlrev_b32 v102, 16, v215
  v_and_b32 v103, 0xffff0000, v215
  s_waitcnt lgkmcnt(4)
  v_pk_add_f32 v[16:17], v[16:17], v[24:25]
  v_pk_add_f32 v[18:19], v[18:19], v[26:27]
  v_pk_add_f32 v[20:21], v[20:21], v[28:29]
  v_pk_add_f32 v[22:23], v[22:23], v[30:31]
  s_waitcnt lgkmcnt(0)
  v_pk_add_f32 v[32:33], v[32:33], v[40:41]
  v_pk_add_f32 v[34:35], v[34:35], v[42:43]
  v_pk_add_f32 v[36:37], v[36:37], v[44:45]
  v_pk_add_f32 v[38:39], v[38:39], v[46:47]
  v_pk_add_f32 v[16:17], v[16:17], v[32:33]
  v_pk_add_f32 v[18:19], v[18:19], v[34:35]
  v_pk_add_f32 v[20:21], v[20:21], v[36:37]
  v_pk_add_f32 v[22:23], v[22:23], v[38:39]
  v_pk_fma_f32 v[96:97], v[16:17], v[244:245], v[96:97]
  v_pk_fma_f32 v[98:99], v[18:19], v[246:247], v[98:99]
  v_pk_fma_f32 v[100:101], v[20:21], v[248:249], v[100:101]
  v_pk_fma_f32 v[102:103], v[22:23], v[250:251], v[102:103]
  v_cvt_pk_bf16_f32 v212, v96, v97
  v_cvt_pk_bf16_f32 v213, v98, v99
  v_cvt_pk_bf16_f32 v214, v100, v101
  v_cvt_pk_bf16_f32 v215, v102, v103
  buffer_store_dwordx4 v[212:215], v228, s[64:67], s50 offen
  s_branch k2_fin
u_spin_PM:
  s_mov_b32 s33, 0x40000
u_spin2_PM:
  s_sleep 6
  buffer_load_dword v14, v13, s[68:71], s63 offen offset:128 sc1
  s_waitcnt vmcnt(0)
  v_readfirstlane_b32 s73, v14
  s_sub_u32 s33, s33, 1
  s_cbranch_scc1 u_go_PM
  s_cmp_lt_u32 s73, 1
  s_cbranch_scc1 u_spin2_PM
  s_branch u_go_PM
u_spin_PH:
  s_mov_b32 s33, 0x40000
u_spin2_PH:
  s_sleep 6
  buffer_load_dword v14, v13, s[76:79], s44 offen offset:128 sc1
  s_waitcnt vmcnt(0)
  v_readfirstlane_b32 s73, v14
  s_sub_u32 s33, s33, 1
  s_cbranch_scc1 u_go_PH
  s_cmp_lt_u32 s73, 1
  s_cbranch_scc1 u_spin2_PH
  s_branch u_go_PH
u_spin_PK:
  s_mov_b32 s33, 0x40000
u_spin2_PK:
  s_sleep 6
  buffer_load_dword v14, v13, s[76:79], s44 offen offset:0 sc1
  s_waitcnt vmcnt(0)
  v_readfirstlane_b32 s73, v14
  s_sub_u32 s33, s33, 1
  s_cbranch_scc1 u_go_PK
  s_cmp_lt_u32 s73, 8
  s_cbranch_scc1 u_spin2_PK
  s_branch u_go_PK
k2_cspin0:
  s_mov_b32 s36, 0x40000
k2_cspin0b:
  s_sleep 2
  buffer_load_dword v15, v13, s[76:79], s74 offen sc1
  s_waitcnt vmcnt(0)
  v_readfirstlane_b32 s35, v15
  s_sub_u32 s36, s36, 1
  s_cbranch_scc1 k2_cgo0
  s_cmp_lt_u32 s35, 4
  s_cbranch_scc1 k2_cspin0b
  s_branch k2_cgo0
k2_cspin1:
  s_mov_b32 s36, 0x40000
k2_cspin1b:
  s_sleep 2
  buffer_load_dword v15, v13, s[76:79], s74 offen sc1
  s_waitcnt vmcnt(0)
  v_readfirstlane_b32 s35, v15
  s_sub_u32 s36, s36, 1
  s_cbranch_scc1 k2_cgo1
  s_cmp_lt_u32 s35, 4
  s_cbranch_scc1 k2_cspin1b
  s_branch k2_cgo1
k2_fspin:
  s_mov_b32 s36, 0x40000
  s_sub_u32 s33, 7, s31
  s_max_u32 s33, s33, s31
  s_add_u32 s33, s33, 64
  s_lshl_b32 s33, s33, 7
k2_fspinb:
  buffer_load_dword v249, v248, s[76:79], s33 offen sc1
  s_waitcnt vmcnt(0)
  v_readfirstlane_b32 s35, v249
  s_sub_u32 s36, s36, 1
  s_cbranch_scc1 k2_fgo
  s_cmp_ge_u32 s35, 128
  s_cbranch_scc1 k2_fgo
  s_sleep 8
  s_branch k2_fspinb
k2_pref0:
  v_max_u32 v12, v16, v20
  v_cmp_eq_u32 vcc, -1, v12
  s_cbranch_vccz k2_pref1
  s_add_u32 s35, s50, 0
  buffer_load_dwordx4 v[16:19], v220, s[24:27], s35 offen sc1
  s_add_u32 s35, s50, 16384
  buffer_load_dwordx4 v[20:23], v220, s[24:27], s35 offen sc1
k2_pref1:
  v_max_u32 v12, v24, v28
  v_cmp_eq_u32 vcc, -1, v12
  s_cbranch_vccz k2_pref2
  s_add_u32 s35, s50, 262144
  buffer_load_dwordx4 v[24:27], v220, s[24:27], s35 offen sc1
  s_add_u32 s35, s50, 278528
  buffer_load_dwordx4 v[28:31], v220, s[24:27], s35 offen sc1
k2_pref2:
  v_max_u32 v12, v32, v36
  v_cmp_eq_u32 vcc, -1, v12
  s_cbranch_vccz k2_pref3
  s_add_u32 s35, s50, 524288
  buffer_load_dwordx4 v[32:35], v220, s[24:27], s35 offen sc1
  s_add_u32 s35, s50, 540672
  buffer_load_dwordx4 v[36:39], v220, s[24:27], s35 offen sc1
k2_pref3:
  v_max_u32 v12, v40, v44
  v_cmp_eq_u32 vcc, -1, v12
  s_cbranch_vccz k2_pref4
  s_add_u32 s35, s50, 786432
  buffer_load_dwordx4 v[40:43], v220, s[24:27], s35 offen sc1
  s_add_u32 s35, s50, 802816
  buffer_load_dwordx4 v[44:47], v220, s[24:27], s35 offen sc1
k2_pref4:
  v_max_u32 v12, v48, v52
  v_cmp_eq_u32 vcc, -1, v12
  s_cbranch_vccz k2_pref5
  s_add_u32 s35, s50, 1048576
  buffer_load_dwordx4 v[48:51], v220, s[24:27], s35 offen sc1
  s_add_u32 s35, s50, 1064960
  buffer_load_dwordx4 v[52:55], v220, s[24:27], s35 offen sc1
k2_pref5:
  v_max_u32 v12, v56, v60
  v_cmp_eq_u32 vcc, -1, v12
  s_cbranch_vccz k2_pref6
  s_add_u32 s35, s50, 1310720
  buffer_load_dwordx4 v[56:59], v220, s[24:27], s35 offen sc1
  s_add_u32 s35, s50, 1327104
  buffer_load_dwordx4 v[60:63], v220, s[24:27], s35 offen sc1
k2_pref6:
  v_max_u32 v12, v64, v68
  v_cmp_eq_u32 vcc, -1, v12
  s_cbranch_vccz k2_pref7
  s_add_u32 s35, s50, 1572864
  buffer_load_dwordx4 v[64:67], v220, s[24:27], s35 offen sc1
  s_add_u32 s35, s50, 1589248
  buffer_load_dwordx4 v[68:71], v220, s[24:27], s35 offen sc1
k2_pref7:
  v_max_u32 v12, v72, v76
  v_cmp_eq_u32 vcc, -1, v12
  s_cbranch_vccz k2_pref8
  s_add_u32 s35, s50, 1835008
  buffer_load_dwordx4 v[72:75], v220, s[24:27], s35 offen sc1
  s_add_u32 s35, s50, 1851392
  buffer_load_dwordx4 v[76:79], v220, s[24:27], s35 offen sc1
k2_pref8:
  s_setpc_b64 s[46:47]
k2_ry:
  s_mov_b32 s33, 0x8000
k2_ryb:
  s_sleep 2
  s_add_u32 s36, s42, 0
  buffer_load_dwordx4 v[112:115], v1, s[24:27], s36 offen offset:0 sc1
  s_add_u32 s36, s42, 0
  buffer_load_dwordx4 v[116:119], v1, s[24:27], s36 offen offset:1024 sc1
  s_add_u32 s36, s42, 0
  buffer_load_dwordx4 v[120:123], v1, s[24:27], s36 offen offset:2048 sc1
  s_add_u32 s36, s42, 0
  buffer_load_dwordx4 v[124:127], v1, s[24:27], s36 offen offset:3072 sc1
  s_waitcnt vmcnt(0)
  v_max3_u32 v12, v112, v116, v120
  v_max_u32 v12, v12, v124
  v_cmp_eq_u32 vcc, -1, v12
  s_cbranch_vccz k2_ryc
  s_sub_u32 s33, s33, 1
  s_cbranch_scc0 k2_ryb
k2_ryc:
  s_branch k2_ryr
k2_ry4:
  s_mov_b32 s33, 0x8000
k2_ry4b:
  s_sleep 2
  s_add_u32 s36, s42, 4096
  buffer_load_dwordx4 v[128:131], v1, s[24:27], s36 offen offset:0 sc1
  s_waitcnt vmcnt(0)
  v_cmp_eq_u32 vcc, -1, v128
  s_cbranch_vccz k2_ry4c
  s_sub_u32 s33, s33, 1
  s_cbranch_scc0 k2_ry4b
k2_ry4c:
  s_branch k2_ry4r
k2_ry5:
  s_mov_b32 s33, 0x8000
k2_ry5b:
  s_sleep 2
  s_add_u32 s36, s42, 4096
  buffer_load_dwordx4 v[132:135], v1, s[24:27], s36 offen offset:1024 sc1
  s_waitcnt vmcnt(0)
  v_cmp_eq_u32 vcc, -1, v132
  s_cbranch_vccz k2_ry5c
  s_sub_u32 s33, s33, 1
  s_cbranch_scc0 k2_ry5b
k2_ry5c:
  s_branch k2_ry5r
k2_ry6:
  s_mov_b32 s33, 0x8000
k2_ry6b:
  s_sleep 2
  s_add_u32 s36, s42, 4096
  buffer_load_dwordx4 v[136:139], v1, s[24:27], s36 offen offset:2048 sc1
  s_waitcnt vmcnt(0)
  v_cmp_eq_u32 vcc, -1, v136
  s_cbranch_vccz k2_ry6c
  s_sub_u32 s33, s33, 1
  s_cbranch_scc0 k2_ry6b
k2_ry6c:
  s_branch k2_ry6r
k2_ry7:
  s_mov_b32 s33, 0x8000
k2_ry7b:
  s_sleep 2
  s_add_u32 s36, s42, 4096
  buffer_load_dwordx4 v[140:143], v1, s[24:27], s36 offen offset:3072 sc1
  s_waitcnt vmcnt(0)
  v_cmp_eq_u32 vcc, -1, v140
  s_cbranch_vccz k2_ry7c
  s_sub_u32 s33, s33, 1
  s_cbranch_scc0 k2_ry7b
k2_ry7c:
  s_branch k2_ry7r
k2_ry8:
  s_mov_b32 s33, 0x8000
k2_ry8b:
  s_sleep 2
  s_add_u32 s36, s42, 8192
  buffer_load_dwordx4 v[144:147], v1, s[24:27], s36 offen offset:0 sc1
  s_waitcnt vmcnt(0)
  v_cmp_eq_u32 vcc, -1, v144
  s_cbranch_vccz k2_ry8c
  s_sub_u32 s33, s33, 1
  s_cbranch_scc0 k2_ry8b
k2_ry8c:
  s_branch k2_ry8r
k2_ry9:
  s_mov_b32 s33, 0x8000
k2_ry9b:
  s_sleep 2
  s_add_u32 s36, s42, 8192
  buffer_load_dwordx4 v[148:151], v1, s[24:27], s36 offen offset:1024 sc1
  s_waitcnt vmcnt(0)
  v_cmp_eq_u32 vcc, -1, v148
  s_cbranch_vccz k2_ry9c
  s_sub_u32 s33, s33, 1
  s_cbranch_scc0 k2_ry9b
k2_ry9c:
  s_branch k2_ry9r
k2_ry10:
  s_mov_b32 s33, 0x8000
k2_ry10b:
  s_sleep 2
  s_add_u32 s36, s42, 8192
  buffer_load_dwordx4 v[152:155], v1, s[24:27], s36 offen offset:2048 sc1
  s_waitcnt vmcnt(0)
  v_cmp_eq_u32 vcc, -1, v152
  s_cbranch_vccz k2_ry10c
  s_sub_u32 s33, s33, 1
  s_cbranch_scc0 k2_ry10b
k2_ry10c:
  s_branch k2_ry10r
k2_ry11:
  s_mov_b32 s33, 0x8000
k2_ry11b:
  s_sleep 2
  s_add_u32 s36, s42, 8192
  buffer_load_dwordx4 v[156:159], v1, s[24:27], s36 offen offset:3072 sc1
  s_waitcnt vmcnt(0)
  v_cmp_eq_u32 vcc, -1, v156
  s_cbranch_vccz k2_ry11c
  s_sub_u32 s33, s33, 1
  s_cbranch_scc0 k2_ry11b
k2_ry11c:
  s_branch k2_ry11r
k2_ry12:
  s_mov_b32 s33, 0x8000
k2_ry12b:
  s_sleep 2
  s_add_u32 s36, s42, 12288
  buffer_load_dwordx4 v[160:163], v1, s[24:27], s36 offen offset:0 sc1
  s_waitcnt vmcnt(0)
  v_cmp_eq_u32 vcc, -1, v160
  s_cbranch_vccz k2_ry12c
  s_sub_u32 s33, s33, 1
  s_cbranch_scc0 k2_ry12b
k2_ry12c:
  s_branch k2_ry12r
k2_ry13:
  s_mov_b32 s33, 0x8000
k2_ry13b:
  s_sleep 2
  s_add_u32 s36, s42, 12288
  buffer_load_dwordx4 v[164:167], v1, s[24:27], s36 offen offset:1024 sc1
  s_waitcnt vmcnt(0)
  v_cmp_eq_u32 vcc, -1, v164
  s_cbranch_vccz k2_ry13c
  s_sub_u32 s33, s33, 1
  s_cbranch_scc0 k2_ry13b
k2_ry13c:
  s_branch k2_ry13r
k2_ry14:
  s_mov_b32 s33, 0x8000
k2_ry14b:
  s_sleep 2
  s_add_u32 s36, s42, 12288
  buffer_load_dwordx4 v[168:171], v1, s[24:27], s36 offen offset:2048 sc1
  s_waitcnt vmcnt(0)
  v_cmp_eq_u32 vcc, -1, v168
  s_cbranch_vccz k2_ry14c
  s_sub_u32 s33, s33, 1
  s_cbranch_scc0 k2_ry14b
k2_ry14c:
  s_branch k2_ry14r
k2_ry15:
  s_mov_b32 s33, 0x8000
k2_ry15b:
  s_sleep 2
  s_add_u32 s36, s42, 12288
  buffer_load_dwordx4 v[172:175], v1, s[24:27], s36 offen offset:3072 sc1
  s_waitcnt vmcnt(0)
  v_cmp_eq_u32 vcc, -1, v172
  s_cbranch_vccz k2_ry15c
  s_sub_u32 s33, s33, 1
  s_cbranch_scc0 k2_ry15b
k2_ry15c:
  s_branch k2_ry15r
k2_ry16:
  s_mov_b32 s33, 0x8000
k2_ry16b:
  s_sleep 2
  s_add_u32 s36, s42, 16384
  buffer_load_dwordx4 v[112:115], v1, s[24:27], s36 offen offset:0 sc1
  s_waitcnt vmcnt(0)
  v_cmp_eq_u32 vcc, -1, v112
  s_cbranch_vccz k2_ry16c
  s_sub_u32 s33, s33, 1
  s_cbranch_scc0 k2_ry16b
k2_ry16c:
  s_branch k2_ry16r
k2_ry17:
  s_mov_b32 s33, 0x8000
k2_ry17b:
  s_sleep 2
  s_add_u32 s36, s42, 16384
  buffer_load_dwordx4 v[116:119], v1, s[24:27], s36 offen offset:1024 sc1
  s_waitcnt vmcnt(0)
  v_cmp_eq_u32 vcc, -1, v116
  s_cbranch_vccz k2_ry17c
  s_sub_u32 s33, s33, 1
  s_cbranch_scc0 k2_ry17b
k2_ry17c:
  s_branch k2_ry17r
k2_ry18:
  s_mov_b32 s33, 0x8000
k2_ry18b:
  s_sleep 2
  s_add_u32 s36, s42, 16384
  buffer_load_dwordx4 v[120:123], v1, s[24:27], s36 offen offset:2048 sc1
  s_waitcnt vmcnt(0)
  v_cmp_eq_u32 vcc, -1, v120
  s_cbranch_vccz k2_ry18c
  s_sub_u32 s33, s33, 1
  s_cbranch_scc0 k2_ry18b
k2_ry18c:
  s_branch k2_ry18r
k2_ry19:
  s_mov_b32 s33, 0x8000
k2_ry19b:
  s_sleep 2
  s_add_u32 s36, s42, 16384
  buffer_load_dwordx4 v[124:127], v1, s[24:27], s36 offen offset:3072 sc1
  s_waitcnt vmcnt(0)
  v_cmp_eq_u32 vcc, -1, v124
  s_cbranch_vccz k2_ry19c
  s_sub_u32 s33, s33, 1
  s_cbranch_scc0 k2_ry19b
k2_ry19c:
  s_branch k2_ry19r
k2_ry20:
  s_mov_b32 s33, 0x8000
k2_ry20b:
  s_sleep 2
  s_add_u32 s36, s42, 20480
  buffer_load_dwordx4 v[128:131], v1, s[24:27], s36 offen offset:0 sc1
  s_waitcnt vmcnt(0)
  v_cmp_eq_u32 vcc, -1, v128
  s_cbranch_vccz k2_ry20c
  s_sub_u32 s33, s33, 1
  s_cbranch_scc0 k2_ry20b
k2_ry20c:
  s_branch k2_ry20r
k2_ry21:
  s_mov_b32 s33, 0x8000
k2_ry21b:
  s_sleep 2
  s_add_u32 s36, s42, 20480
  buffer_load_dwordx4 v[132:135], v1, s[24:27], s36 offen offset:1024 sc1
  s_waitcnt vmcnt(0)
  v_cmp_eq_u32 vcc, -1, v132
  s_cbranch_vccz k2_ry21c
  s_sub_u32 s33, s33, 1
  s_cbranch_scc0 k2_ry21b
k2_ry21c:
  s_branch k2_ry21r
k2_ry22:
  s_mov_b32 s33, 0x8000
k2_ry22b:
  s_sleep 2
  s_add_u32 s36, s42, 20480
  buffer_load_dwordx4 v[136:139], v1, s[24:27], s36 offen offset:2048 sc1
  s_waitcnt vmcnt(0)
  v_cmp_eq_u32 vcc, -1, v136
  s_cbranch_vccz k2_ry22c
  s_sub_u32 s33, s33, 1
  s_cbranch_scc0 k2_ry22b
k2_ry22c:
  s_branch k2_ry22r
k2_ry23:
  s_mov_b32 s33, 0x8000
k2_ry23b:
  s_sleep 2
  s_add_u32 s36, s42, 20480
  buffer_load_dwordx4 v[140:143], v1, s[24:27], s36 offen offset:3072 sc1
  s_waitcnt vmcnt(0)
  v_cmp_eq_u32 vcc, -1, v140
  s_cbranch_vccz k2_ry23c
  s_sub_u32 s33, s33, 1
  s_cbranch_scc0 k2_ry23b
k2_ry23c:
  s_branch k2_ry23r
k2_ry24:
  s_mov_b32 s33, 0x8000
k2_ry24b:
  s_sleep 2
  s_add_u32 s36, s42, 24576
  buffer_load_dwordx4 v[144:147], v1, s[24:27], s36 offen offset:0 sc1
  s_waitcnt vmcnt(0)
  v_cmp_eq_u32 vcc, -1, v144
  s_cbranch_vccz k2_ry24c
  s_sub_u32 s33, s33, 1
  s_cbranch_scc0 k2_ry24b
k2_ry24c:
  s_branch k2_ry24r
k2_ry25:
  s_mov_b32 s33, 0x8000
k2_ry25b:
  s_sleep 2
  s_add_u32 s36, s42, 24576
  buffer_load_dwordx4 v[148:151], v1, s[24:27], s36 offen offset:1024 sc1
  s_waitcnt vmcnt(0)
  v_cmp_eq_u32 vcc, -1, v148
  s_cbranch_vccz k2_ry25c
  s_sub_u32 s33, s33, 1
  s_cbranch_scc0 k2_ry25b
k2_ry25c:
  s_branch k2_ry25r
k2_ry26:
  s_mov_b32 s33, 0x8000
k2_ry26b:
  s_sleep 2
  s_add_u32 s36, s42, 24576
  buffer_load_dwordx4 v[152:155], v1, s[24:27], s36 offen offset:2048 sc1
  s_waitcnt vmcnt(0)
  v_cmp_eq_u32 vcc, -1, v152
  s_cbranch_vccz k2_ry26c
  s_sub_u32 s33, s33, 1
  s_cbranch_scc0 k2_ry26b
k2_ry26c:
  s_branch k2_ry26r
k2_ry27:
  s_mov_b32 s33, 0x8000
k2_ry27b:
  s_sleep 2
  s_add_u32 s36, s42, 24576
  buffer_load_dwordx4 v[156:159], v1, s[24:27], s36 offen offset:3072 sc1
  s_waitcnt vmcnt(0)
  v_cmp_eq_u32 vcc, -1, v156
  s_cbranch_vccz k2_ry27c
  s_sub_u32 s33, s33, 1
  s_cbranch_scc0 k2_ry27b
k2_ry27c:
  s_branch k2_ry27r
k2_ry28:
  s_mov_b32 s33, 0x8000
k2_ry28b:
  s_sleep 2
  s_add_u32 s36, s42, 28672
  buffer_load_dwordx4 v[160:163], v1, s[24:27], s36 offen offset:0 sc1
  s_waitcnt vmcnt(0)
  v_cmp_eq_u32 vcc, -1, v160
  s_cbranch_vccz k2_ry28c
  s_sub_u32 s33, s33, 1
  s_cbranch_scc0 k2_ry28b
k2_ry28c:
  s_branch k2_ry28r
k2_ry29:
  s_mov_b32 s33, 0x8000
k2_ry29b:
  s_sleep 2
  s_add_u32 s36, s42, 28672
  buffer_load_dwordx4 v[164:167], v1, s[24:27], s36 offen offset:1024 sc1
  s_waitcnt vmcnt(0)
  v_cmp_eq_u32 vcc, -1, v164
  s_cbranch_vccz k2_ry29c
  s_sub_u32 s33, s33, 1
  s_cbranch_scc0 k2_ry29b
k2_ry29c:
  s_branch k2_ry29r
k2_ry30:
  s_mov_b32 s33, 0x8000
k2_ry30b:
  s_sleep 2
  s_add_u32 s36, s42, 28672
  buffer_load_dwordx4 v[168:171], v1, s[24:27], s36 offen offset:2048 sc1
  s_waitcnt vmcnt(0)
  v_cmp_eq_u32 vcc, -1, v168
  s_cbranch_vccz k2_ry30c
  s_sub_u32 s33, s33, 1
  s_cbranch_scc0 k2_ry30b
k2_ry30c:
  s_branch k2_ry30r
k2_ry31:
  s_mov_b32 s33, 0x8000
k2_ry31b:
  s_sleep 2
  s_add_u32 s36, s42, 28672
  buffer_load_dwordx4 v[172:175], v1, s[24:27], s36 offen offset:3072 sc1
  s_waitcnt vmcnt(0)
  v_cmp_eq_u32 vcc, -1, v172
  s_cbranch_vccz k2_ry31c
  s_sub_u32 s33, s33, 1
  s_cbranch_scc0 k2_ry31b
k2_ry31c:
  s_branch k2_ry31r
k2_rg0:
  s_mov_b32 s33, 0x8000
k2_rg0b:
  s_sleep 2
  s_add_u32 s36, s41, 0
  buffer_load_dwordx4 v[112:115], v1, s[24:27], s36 offen offset:0 sc1
  buffer_load_dwordx4 v[116:119], v1, s[24:27], s36 offen offset:1024 sc1
  buffer_load_dwordx4 v[120:123], v1, s[24:27], s36 offen offset:2048 sc1
  buffer_load_dwordx4 v[124:127], v1, s[24:27], s36 offen offset:3072 sc1
  s_waitcnt vmcnt(0)
  v_max3_u32 v12, v112, v116, v120
  v_max_u32 v12, v12, v124
  v_cmp_eq_u32 vcc, -1, v12
  s_cbranch_vccz k2_rg0c
  s_sub_u32 s33, s33, 1
  s_cbranch_scc0 k2_rg0b
k2_rg0c:
  s_add_u32 s36, s41, 196608
  buffer_load_dwordx4 v[128:131], v1, s[24:27], s36 offen offset:0 sc1
  buffer_load_dwordx4 v[132:135], v1, s[24:27], s36 offen offset:1024 sc1
  buffer_load_dwordx4 v[136:139], v1, s[24:27], s36 offen offset:2048 sc1
  buffer_load_dwordx4 v[140:143], v1, s[24:27], s36 offen offset:3072 sc1
  s_add_u32 s36, s41, 393216
  buffer_load_dwordx4 v[144:147], v1, s[24:27], s36 offen offset:0 sc1
  buffer_load_dwordx4 v[148:151], v1, s[24:27], s36 offen offset:1024 sc1
  buffer_load_dwordx4 v[152:155], v1, s[24:27], s36 offen offset:2048 sc1
  buffer_load_dwordx4 v[156:159], v1, s[24:27], s36 offen offset:3072 sc1
  s_add_u32 s36, s74, 589824
  buffer_load_dwordx4 v[160:163], v1, s[24:27], s36 offen offset:0 sc1
  buffer_load_dwordx4 v[164:167], v1, s[24:27], s36 offen offset:1024 sc1
  buffer_load_dwordx4 v[168:171], v1, s[24:27], s36 offen offset:2048 sc1
  buffer_load_dwordx4 v[172:175], v1, s[24:27], s36 offen offset:3072 sc1
  s_branch k2_rg0r
k2_rg1:
  s_mov_b32 s33, 0x8000
k2_rg1b:
  s_sleep 2
  s_add_u32 s36, s41, 196608
  buffer_load_dwordx4 v[128:131], v1, s[24:27], s36 offen offset:0 sc1
  buffer_load_dwordx4 v[132:135], v1, s[24:27], s36 offen offset:1024 sc1
  buffer_load_dwordx4 v[136:139], v1, s[24:27], s36 offen offset:2048 sc1
  buffer_load_dwordx4 v[140:143], v1, s[24:27], s36 offen offset:3072 sc1
  s_waitcnt vmcnt(0)
  v_max3_u32 v12, v128, v132, v136
  v_max_u32 v12, v12, v140
  v_cmp_eq_u32 vcc, -1, v12
  s_cbranch_vccz k2_rg1c
  s_sub_u32 s33, s33, 1
  s_cbranch_scc0 k2_rg1b
k2_rg1c:
  s_add_u32 s36, s41, 393216
  buffer_load_dwordx4 v[144:147], v1, s[24:27], s36 offen offset:0 sc1
  buffer_load_dwordx4 v[148:151], v1, s[24:27], s36 offen offset:1024 sc1
  buffer_load_dwordx4 v[152:155], v1, s[24:27], s36 offen offset:2048 sc1
  buffer_load_dwordx4 v[156:159], v1, s[24:27], s36 offen offset:3072 sc1
  s_add_u32 s36, s74, 589824
  buffer_load_dwordx4 v[160:163], v1, s[24:27], s36 offen offset:0 sc1
  buffer_load_dwordx4 v[164:167], v1, s[24:27], s36 offen offset:1024 sc1
  buffer_load_dwordx4 v[168:171], v1, s[24:27], s36 offen offset:2048 sc1
  buffer_load_dwordx4 v[172:175], v1, s[24:27], s36 offen offset:3072 sc1
  s_add_u32 s36, s41, 65536
  buffer_load_dwordx4 v[80:83], v1, s[24:27], s36 offen offset:0 sc1
  buffer_load_dwordx4 v[84:87], v1, s[24:27], s36 offen offset:1024 sc1
  buffer_load_dwordx4 v[88:91], v1, s[24:27], s36 offen offset:2048 sc1
  buffer_load_dwordx4 v[92:95], v1, s[24:27], s36 offen offset:3072 sc1
  s_branch k2_rg1r
k2_rg2:
  s_mov_b32 s33, 0x8000
k2_rg2b:
  s_sleep 2
  s_add_u32 s36, s41, 393216
  buffer_load_dwordx4 v[144:147], v1, s[24:27], s36 offen offset:0 sc1
  buffer_load_dwordx4 v[148:151], v1, s[24:27], s36 offen offset:1024 sc1
  buffer_load_dwordx4 v[152:155], v1, s[24:27], s36 offen offset:2048 sc1
  buffer_load_dwordx4 v[156:159], v1, s[24:27], s36 offen offset:3072 sc1
  s_waitcnt vmcnt(0)
  v_max3_u32 v12, v144, v148, v152
  v_max_u32 v12, v12, v156
  v_cmp_eq_u32 vcc, -1, v12
  s_cbranch_vccz k2_rg2c
  s_sub_u32 s33, s33, 1
  s_cbranch_scc0 k2_rg2b
k2_rg2c:
  s_add_u32 s36, s74, 589824
  buffer_load_dwordx4 v[160:163], v1, s[24:27], s36 offen offset:0 sc1
  buffer_load_dwordx4 v[164:167], v1, s[24:27], s36 offen offset:1024 sc1
  buffer_load_dwordx4 v[168:171], v1, s[24:27], s36 offen offset:2048 sc1
  buffer_load_dwordx4 v[172:175], v1, s[24:27], s36 offen offset:3072 sc1
  s_add_u32 s36, s41, 65536
  buffer_load_dwordx4 v[80:83], v1, s[24:27], s36 offen offset:0 sc1
  buffer_load_dwordx4 v[84:87], v1, s[24:27], s36 offen offset:1024 sc1
  buffer_load_dwordx4 v[88:91], v1, s[24:27], s36 offen offset:2048 sc1
  buffer_load_dwordx4 v[92:95], v1, s[24:27], s36 offen offset:3072 sc1
  s_add_u32 s36, s41, 262144
  buffer_load_dwordx4 v[96:99], v1, s[24:27], s36 offen offset:0 sc1
  buffer_load_dwordx4 v[100:103], v1, s[24:27], s36 offen offset:1024 sc1
  buffer_load_dwordx4 v[104:107], v1, s[24:27], s36 offen offset:2048 sc1
  buffer_load_dwordx4 v[108:111], v1, s[24:27], s36 offen offset:3072 sc1
  s_branch k2_rg2r
k2_rg3:
  s_mov_b32 s33, 0x8000
k2_rg3b:
  s_sleep 2
  s_add_u32 s36, s74, 589824
  buffer_load_dwordx4 v[160:163], v1, s[24:27], s36 offen offset:0 sc1
  buffer_load_dwordx4 v[164:167], v1, s[24:27], s36 offen offset:1024 sc1
  buffer_load_dwordx4 v[168:171], v1, s[24:27], s36 offen offset:2048 sc1
  buffer_load_dwordx4 v[172:175], v1, s[24:27], s36 offen offset:3072 sc1
  s_waitcnt vmcnt(0)
  v_max3_u32 v12, v160, v164, v168
  v_max_u32 v12, v12, v172
  v_cmp_eq_u32 vcc, -1, v12
  s_cbranch_vccz k2_rg3c
  s_sub_u32 s33, s33, 1
  s_cbranch_scc0 k2_rg3b
k2_rg3c:
  s_add_u32 s36, s41, 65536
  buffer_load_dwordx4 v[80:83], v1, s[24:27], s36 offen offset:0 sc1
  buffer_load_dwordx4 v[84:87], v1, s[24:27], s36 offen offset:1024 sc1
  buffer_load_dwordx4 v[88:91], v1, s[24:27], s36 offen offset:2048 sc1
  buffer_load_dwordx4 v[92:95], v1, s[24:27], s36 offen offset:3072 sc1
  s_add_u32 s36, s41, 262144
  buffer_load_dwordx4 v[96:99], v1, s[24:27], s36 offen offset:0 sc1
  buffer_load_dwordx4 v[100:103], v1, s[24:27], s36 offen offset:1024 sc1
  buffer_load_dwordx4 v[104:107], v1, s[24:27], s36 offen offset:2048 sc1
  buffer_load_dwordx4 v[108:111], v1, s[24:27], s36 offen offset:3072 sc1
  s_add_u32 s36, s41, 458752
  buffer_load_dwordx4 v[112:115], v1, s[24:27], s36 offen offset:0 sc1
  buffer_load_dwordx4 v[116:119], v1, s[24:27], s36 offen offset:1024 sc1
  buffer_load_dwordx4 v[120:123], v1, s[24:27], s36 offen offset:2048 sc1
  buffer_load_dwordx4 v[124:127], v1, s[24:27], s36 offen offset:3072 sc1
  s_branch k2_rg3r
k2_rg4:
  s_mov_b32 s33, 0x8000
k2_rg4b:
  s_sleep 2
  s_add_u32 s36, s41, 65536
  buffer_load_dwordx4 v[80:83], v1, s[24:27], s36 offen offset:0 sc1
  buffer_load_dwordx4 v[84:87], v1, s[24:27], s36 offen offset:1024 sc1
  buffer_load_dwordx4 v[88:91], v1, s[24:27], s36 offen offset:2048 sc1
  buffer_load_dwordx4 v[92:95], v1, s[24:27], s36 offen offset:3072 sc1
  s_waitcnt vmcnt(0)
  v_max3_u32 v12, v80, v84, v88
  v_max_u32 v12, v12, v92
  v_cmp_eq_u32 vcc, -1, v12
  s_cbranch_vccz k2_rg4c
  s_sub_u32 s33, s33, 1
  s_cbranch_scc0 k2_rg4b
k2_rg4c:
  s_add_u32 s36, s41, 262144
  buffer_load_dwordx4 v[96:99], v1, s[24:27], s36 offen offset:0 sc1
  buffer_load_dwordx4 v[100:103], v1, s[24:27], s36 offen offset:1024 sc1
  buffer_load_dwordx4 v[104:107], v1, s[24:27], s36 offen offset:2048 sc1
  buffer_load_dwordx4 v[108:111], v1, s[24:27], s36 offen offset:3072 sc1
  s_add_u32 s36, s41, 458752
  buffer_load_dwordx4 v[112:115], v1, s[24:27], s36 offen offset:0 sc1
  buffer_load_dwordx4 v[116:119], v1, s[24:27], s36 offen offset:1024 sc1
  buffer_load_dwordx4 v[120:123], v1, s[24:27], s36 offen offset:2048 sc1
  buffer_load_dwordx4 v[124:127], v1, s[24:27], s36 offen offset:3072 sc1
  s_add_u32 m0, s49, 147456
  s_add_u32 s35, s39, 1048576
  buffer_load_dwordx4 v219, s[20:23], s35 offen lds
  s_add_u32 m0, s49, 148480
  s_add_u32 s35, s39, 1056768
  buffer_load_dwordx4 v219, s[20:23], s35 offen lds
  s_add_u32 m0, s49, 149504
  s_add_u32 s35, s39, 1064960
  buffer_load_dwordx4 v219, s[20:23], s35 offen lds
  s_add_u32 m0, s49, 150528
  s_add_u32 s35, s39, 1073152
  buffer_load_dwordx4 v219, s[20:23], s35 offen lds
  buffer_load_dwordx2 v[208:209], v231, s[24:27], s43 offen sc1
  buffer_load_dwordx2 v[210:211], v231, s[24:27], s43 offen offset:512 sc1
  s_add_u32 s36, s75, 655360
  buffer_load_dwordx4 v[128:131], v1, s[24:27], s36 offen offset:0 sc1
  buffer_load_dwordx4 v[132:135], v1, s[24:27], s36 offen offset:1024 sc1
  buffer_load_dwordx4 v[136:139], v1, s[24:27], s36 offen offset:2048 sc1
  buffer_load_dwordx4 v[140:143], v1, s[24:27], s36 offen offset:3072 sc1
  s_branch k2_rg4r
k2_rg5:
  s_mov_b32 s33, 0x8000
k2_rg5b:
  s_sleep 2
  s_add_u32 s36, s41, 262144
  buffer_load_dwordx4 v[96:99], v1, s[24:27], s36 offen offset:0 sc1
  buffer_load_dwordx4 v[100:103], v1, s[24:27], s36 offen offset:1024 sc1
  buffer_load_dwordx4 v[104:107], v1, s[24:27], s36 offen offset:2048 sc1
  buffer_load_dwordx4 v[108:111], v1, s[24:27], s36 offen offset:3072 sc1
  s_waitcnt vmcnt(0)
  v_max3_u32 v12, v96, v100, v104
  v_max_u32 v12, v12, v108
  v_cmp_eq_u32 vcc, -1, v12
  s_cbranch_vccz k2_rg5c
  s_sub_u32 s33, s33, 1
  s_cbranch_scc0 k2_rg5b
k2_rg5c:
  s_add_u32 s36, s41, 458752
  buffer_load_dwordx4 v[112:115], v1, s[24:27], s36 offen offset:0 sc1
  buffer_load_dwordx4 v[116:119], v1, s[24:27], s36 offen offset:1024 sc1
  buffer_load_dwordx4 v[120:123], v1, s[24:27], s36 offen offset:2048 sc1
  buffer_load_dwordx4 v[124:127], v1, s[24:27], s36 offen offset:3072 sc1
  s_add_u32 m0, s49, 147456
  s_add_u32 s35, s39, 1048576
  buffer_load_dwordx4 v219, s[20:23], s35 offen lds
  s_add_u32 m0, s49, 148480
  s_add_u32 s35, s39, 1056768
  buffer_load_dwordx4 v219, s[20:23], s35 offen lds
  s_add_u32 m0, s49, 149504
  s_add_u32 s35, s39, 1064960
  buffer_load_dwordx4 v219, s[20:23], s35 offen lds
  s_add_u32 m0, s49, 150528
  s_add_u32 s35, s39, 1073152
  buffer_load_dwordx4 v219, s[20:23], s35 offen lds
  buffer_load_dwordx2 v[208:209], v231, s[24:27], s43 offen sc1
  buffer_load_dwordx2 v[210:211], v231, s[24:27], s43 offen offset:512 sc1
  s_add_u32 s36, s75, 655360
  buffer_load_dwordx4 v[128:131], v1, s[24:27], s36 offen offset:0 sc1
  buffer_load_dwordx4 v[132:135], v1, s[24:27], s36 offen offset:1024 sc1
  buffer_load_dwordx4 v[136:139], v1, s[24:27], s36 offen offset:2048 sc1
  buffer_load_dwordx4 v[140:143], v1, s[24:27], s36 offen offset:3072 sc1
  s_add_u32 s36, s41, 131072
  buffer_load_dwordx4 v[144:147], v1, s[24:27], s36 offen offset:0 sc1
  buffer_load_dwordx4 v[148:151], v1, s[24:27], s36 offen offset:1024 sc1
  buffer_load_dwordx4 v[152:155], v1, s[24:27], s36 offen offset:2048 sc1
  buffer_load_dwordx4 v[156:159], v1, s[24:27], s36 offen offset:3072 sc1
  s_branch k2_rg5r
k2_rg6:
  s_mov_b32 s33, 0x8000
k2_rg6b:
  s_sleep 2
  s_add_u32 s36, s41, 458752
  buffer_load_dwordx4 v[112:115], v1, s[24:27], s36 offen offset:0 sc1
  buffer_load_dwordx4 v[116:119], v1, s[24:27], s36 offen offset:1024 sc1
  buffer_load_dwordx4 v[120:123], v1, s[24:27], s36 offen offset:2048 sc1
  buffer_load_dwordx4 v[124:127], v1, s[24:27], s36 offen offset:3072 sc1
  s_waitcnt vmcnt(0)
  v_max3_u32 v12, v112, v116, v120
  v_max_u32 v12, v12, v124
  v_cmp_eq_u32 vcc, -1, v12
  s_cbranch_vccz k2_rg6c
  s_sub_u32 s33, s33, 1
  s_cbranch_scc0 k2_rg6b
k2_rg6c:
  s_add_u32 m0, s49, 147456
  s_add_u32 s35, s39, 1048576
  buffer_load_dwordx4 v219, s[20:23], s35 offen lds
  s_add_u32 m0, s49, 148480
  s_add_u32 s35, s39, 1056768
  buffer_load_dwordx4 v219, s[20:23], s35 offen lds
  s_add_u32 m0, s49, 149504
  s_add_u32 s35, s39, 1064960
  buffer_load_dwordx4 v219, s[20:23], s35 offen lds
  s_add_u32 m0, s49, 150528
  s_add_u32 s35, s39, 1073152
  buffer_load_dwordx4 v219, s[20:23], s35 offen lds
  buffer_load_dwordx2 v[208:209], v231, s[24:27], s43 offen sc1
  buffer_load_dwordx2 v[210:211], v231, s[24:27], s43 offen offset:512 sc1
  s_add_u32 s36, s75, 655360
  buffer_load_dwordx4 v[128:131], v1, s[24:27], s36 offen offset:0 sc1
  buffer_load_dwordx4 v[132:135], v1, s[24:27], s36 offen offset:1024 sc1
  buffer_load_dwordx4 v[136:139], v1, s[24:27], s36 offen offset:2048 sc1
  buffer_load_dwordx4 v[140:143], v1, s[24:27], s36 offen offset:3072 sc1
  s_add_u32 s36, s41, 131072
  buffer_load_dwordx4 v[144:147], v1, s[24:27], s36 offen offset:0 sc1
  buffer_load_dwordx4 v[148:151], v1, s[24:27], s36 offen offset:1024 sc1
  buffer_load_dwordx4 v[152:155], v1, s[24:27], s36 offen offset:2048 sc1
  buffer_load_dwordx4 v[156:159], v1, s[24:27], s36 offen offset:3072 sc1
  s_add_u32 s36, s41, 327680
  buffer_load_dwordx4 v[160:163], v1, s[24:27], s36 offen offset:0 sc1
  buffer_load_dwordx4 v[164:167], v1, s[24:27], s36 offen offset:1024 sc1
  buffer_load_dwordx4 v[168:171], v1, s[24:27], s36 offen offset:2048 sc1
  buffer_load_dwordx4 v[172:175], v1, s[24:27], s36 offen offset:3072 sc1
  s_branch k2_rg6r
k2_rg7:
  s_mov_b32 s33, 0x8000
k2_rg7b:
  s_sleep 2
  s_add_u32 s36, s75, 655360
  buffer_load_dwordx4 v[128:131], v1, s[24:27], s36 offen offset:0 sc1
  buffer_load_dwordx4 v[132:135], v1, s[24:27], s36 offen offset:1024 sc1
  buffer_load_dwordx4 v[136:139], v1, s[24:27], s36 offen offset:2048 sc1
  buffer_load_dwordx4 v[140:143], v1, s[24:27], s36 offen offset:3072 sc1
  s_waitcnt vmcnt(0)
  v_max3_u32 v12, v128, v132, v136
  v_max_u32 v12, v12, v140
  v_cmp_eq_u32 vcc, -1, v12
  s_cbranch_vccz k2_rg7c
  s_sub_u32 s33, s33, 1
  s_cbranch_scc0 k2_rg7b
k2_rg7c:
  s_add_u32 s36, s41, 131072
  buffer_load_dwordx4 v[144:147], v1, s[24:27], s36 offen offset:0 sc1
  buffer_load_dwordx4 v[148:151], v1, s[24:27], s36 offen offset:1024 sc1
  buffer_load_dwordx4 v[152:155], v1, s[24:27], s36 offen offset:2048 sc1
  buffer_load_dwordx4 v[156:159], v1, s[24:27], s36 offen offset:3072 sc1
  s_add_u32 s36, s41, 327680
  buffer_load_dwordx4 v[160:163], v1, s[24:27], s36 offen offset:0 sc1
  buffer_load_dwordx4 v[164:167], v1, s[24:27], s36 offen offset:1024 sc1
  buffer_load_dwordx4 v[168:171], v1, s[24:27], s36 offen offset:2048 sc1
  buffer_load_dwordx4 v[172:175], v1, s[24:27], s36 offen offset:3072 sc1
  s_add_u32 s36, s41, 524288
  buffer_load_dwordx4 v[80:83], v1, s[24:27], s36 offen offset:0 sc1
  buffer_load_dwordx4 v[84:87], v1, s[24:27], s36 offen offset:1024 sc1
  buffer_load_dwordx4 v[88:91], v1, s[24:27], s36 offen offset:2048 sc1
  buffer_load_dwordx4 v[92:95], v1, s[24:27], s36 offen offset:3072 sc1
  s_branch k2_rg7r
k2_rg8:
  s_mov_b32 s33, 0x8000
k2_rg8b:
  s_sleep 2
  s_add_u32 s36, s41, 131072
  buffer_load_dwordx4 v[144:147], v1, s[24:27], s36 offen offset:0 sc1
  buffer_load_dwordx4 v[148:151], v1, s[24:27], s36 offen offset:1024 sc1
  buffer_load_dwordx4 v[152:155], v1, s[24:27], s36 offen offset:2048 sc1
  buffer_load_dwordx4 v[156:159], v1, s[24:27], s36 offen offset:3072 sc1
  s_waitcnt vmcnt(0)
  v_max3_u32 v12, v144, v148, v152
  v_max_u32 v12, v12, v156
  v_cmp_eq_u32 vcc, -1, v12
  s_cbranch_vccz k2_rg8c
  s_sub_u32 s33, s33, 1
  s_cbranch_scc0 k2_rg8b
k2_rg8c:
  s_add_u32 s36, s41, 327680
  buffer_load_dwordx4 v[160:163], v1, s[24:27], s36 offen offset:0 sc1
  buffer_load_dwordx4 v[164:167], v1, s[24:27], s36 offen offset:1024 sc1
  buffer_load_dwordx4 v[168:171], v1, s[24:27], s36 offen offset:2048 sc1
  buffer_load_dwordx4 v[172:175], v1, s[24:27], s36 offen offset:3072 sc1
  s_add_u32 s36, s41, 524288
  buffer_load_dwordx4 v[80:83], v1, s[24:27], s36 offen offset:0 sc1
  buffer_load_dwordx4 v[84:87], v1, s[24:27], s36 offen offset:1024 sc1
  buffer_load_dwordx4 v[88:91], v1, s[24:27], s36 offen offset:2048 sc1
  buffer_load_dwordx4 v[92:95], v1, s[24:27], s36 offen offset:3072 sc1
  s_branch k2_rg8r
k2_rg9:
  s_mov_b32 s33, 0x8000
k2_rg9b:
  s_sleep 2
  s_add_u32 s36, s41, 327680
  buffer_load_dwordx4 v[160:163], v1, s[24:27], s36 offen offset:0 sc1
  buffer_load_dwordx4 v[164:167], v1, s[24:27], s36 offen offset:1024 sc1
  buffer_load_dwordx4 v[168:171], v1, s[24:27], s36 offen offset:2048 sc1
  buffer_load_dwordx4 v[172:175], v1, s[24:27], s36 offen offset:3072 sc1
  s_waitcnt vmcnt(0)
  v_max3_u32 v12, v160, v164, v168
  v_max_u32 v12, v12, v172
  v_cmp_eq_u32 vcc, -1, v12
  s_cbranch_vccz k2_rg9c
  s_sub_u32 s33, s33, 1
  s_cbranch_scc0 k2_rg9b
k2_rg9c:
  s_add_u32 s36, s41, 524288
  buffer_load_dwordx4 v[80:83], v1, s[24:27], s36 offen offset:0 sc1
  buffer_load_dwordx4 v[84:87], v1, s[24:27], s36 offen offset:1024 sc1
  buffer_load_dwordx4 v[88:91], v1, s[24:27], s36 offen offset:2048 sc1
  buffer_load_dwordx4 v[92:95], v1, s[24:27], s36 offen offset:3072 sc1
  s_branch k2_rg9r
k2_rg10:
  s_mov_b32 s33, 0x8000
k2_rg10b:
  s_sleep 2
  s_add_u32 s36, s41, 524288
  buffer_load_dwordx4 v[80:83], v1, s[24:27], s36 offen offset:0 sc1
  buffer_load_dwordx4 v[84:87], v1, s[24:27], s36 offen offset:1024 sc1
  buffer_load_dwordx4 v[88:91], v1, s[24:27], s36 offen offset:2048 sc1
  buffer_load_dwordx4 v[92:95], v1, s[24:27], s36 offen offset:3072 sc1
  s_waitcnt vmcnt(0)
  v_max3_u32 v12, v80, v84, v88
  v_max_u32 v12, v12, v92
  v_cmp_eq_u32 vcc, -1, v12
  s_cbranch_vccz k2_rg10c
  s_sub_u32 s33, s33, 1
  s_cbranch_scc0 k2_rg10b
k2_rg10c:
  s_branch k2_rg10r
k2_rx:
  s_mov_b32 s33, 0x8000
k2_rxb:
  s_sleep 2
  buffer_load_dwordx2 v[208:209], v231, s[24:27], s43 offen sc1
  buffer_load_dwordx2 v[210:211], v231, s[24:27], s43 offen offset:512 sc1
  s_waitcnt vmcnt(0)
  v_max_u32 v12, v208, v210
  v_cmp_eq_u32 vcc, -1, v12
  s_cbranch_vccz k2_rxc
  s_sub_u32 s33, s33, 1
  s_cbranch_scc0 k2_rxb
k2_rxc:
  s_branch k2_rxr
k2_rp0:
  s_mov_b32 s33, 0x8000
k2_rp0b:
  s_sleep 2
  s_waitcnt vmcnt(0)
  s_call_b64 s[46:47], k2_pref0
  s_waitcnt vmcnt(0)
  v_max_u32 v12, v16, v20
  v_cmp_eq_u32 vcc, -1, v12
  s_cbranch_vccz k2_rp0c
  s_sub_u32 s33, s33, 1
  s_cbranch_scc0 k2_rp0b
k2_rp0c:
  s_branch k2_rp0r
k2_rp1:
  s_mov_b32 s33, 0x8000
k2_rp1b:
  s_sleep 2
  s_waitcnt vmcnt(0)
  s_call_b64 s[46:47], k2_pref1
  s_waitcnt vmcnt(0)
  v_max_u32 v12, v24, v28
  v_cmp_eq_u32 vcc, -1, v12
  s_cbranch_vccz k2_rp1c
  s_sub_u32 s33, s33, 1
  s_cbranch_scc0 k2_rp1b
k2_rp1c:
  s_branch k2_rp1r
k2_rp2:
  s_mov_b32 s33, 0x8000
k2_rp2b:
  s_sleep 2
  s_waitcnt vmcnt(0)
  s_call_b64 s[46:47], k2_pref2
  s_waitcnt vmcnt(0)
  v_max_u32 v12, v32, v36
  v_cmp_eq_u32 vcc, -1, v12
  s_cbranch_vccz k2_rp2c
  s_sub_u32 s33, s33, 1
  s_cbranch_scc0 k2_rp2b
k2_rp2c:
  s_branch k2_rp2r
k2_rp3:
  s_mov_b32 s33, 0x8000
k2_rp3b:
  s_sleep 2
  s_waitcnt vmcnt(0)
  s_call_b64 s[46:47], k2_pref3
  s_waitcnt vmcnt(0)
  v_max_u32 v12, v40, v44
  v_cmp_eq_u32 vcc, -1, v12
  s_cbranch_vccz k2_rp3c
  s_sub_u32 s33, s33, 1
  s_cbranch_scc0 k2_rp3b
k2_rp3c:
  s_branch k2_rp3r
k2_rp4:
  s_mov_b32 s33, 0x8000
k2_rp4b:
  s_sleep 2
  s_waitcnt vmcnt(0)
  s_call_b64 s[46:47], k2_pref4
  s_waitcnt vmcnt(0)
  v_max_u32 v12, v48, v52
  v_cmp_eq_u32 vcc, -1, v12
  s_cbranch_vccz k2_rp4c
  s_sub_u32 s33, s33, 1
  s_cbranch_scc0 k2_rp4b
k2_rp4c:
  s_branch k2_rp4r
k2_rp5:
  s_mov_b32 s33, 0x8000
k2_rp5b:
  s_sleep 2
  s_waitcnt vmcnt(0)
  s_call_b64 s[46:47], k2_pref5
  s_waitcnt vmcnt(0)
  v_max_u32 v12, v56, v60
  v_cmp_eq_u32 vcc, -1, v12
  s_cbranch_vccz k2_rp5c
  s_sub_u32 s33, s33, 1
  s_cbranch_scc0 k2_rp5b
k2_rp5c:
  s_branch k2_rp5r
k2_rp6:
  s_mov_b32 s33, 0x8000
k2_rp6b:
  s_sleep 2
  s_waitcnt vmcnt(0)
  s_call_b64 s[46:47], k2_pref6
  s_waitcnt vmcnt(0)
  v_max_u32 v12, v64, v68
  v_cmp_eq_u32 vcc, -1, v12
  s_cbranch_vccz k2_rp6c
  s_sub_u32 s33, s33, 1
  s_cbranch_scc0 k2_rp6b
k2_rp6c:
  s_branch k2_rp6r
k2_rp7:
  s_mov_b32 s33, 0x8000
k2_rp7b:
  s_sleep 2
  s_waitcnt vmcnt(0)
  s_call_b64 s[46:47], k2_pref7
  s_waitcnt vmcnt(0)
  v_max_u32 v12, v72, v76
  v_cmp_eq_u32 vcc, -1, v12
  s_cbranch_vccz k2_rp7c
  s_sub_u32 s33, s33, 1
  s_cbranch_scc0 k2_rp7b
k2_rp7c:
  s_branch k2_rp7r
k2_rx1:
  s_mov_b32 s33, 0x8000
k2_rx1b:
  s_sleep 2
  s_add_u32 s36, s43, 32768
  buffer_load_dwordx2 v[212:213], v231, s[24:27], s36 offen sc1
  buffer_load_dwordx2 v[214:215], v231, s[24:27], s36 offen offset:512 sc1
  s_waitcnt vmcnt(0)
  v_max_u32 v12, v212, v214
  v_cmp_eq_u32 vcc, -1, v12
  s_cbranch_vccz k2_rx1c
  s_sub_u32 s33, s33, 1
  s_cbranch_scc0 k2_rx1b
k2_rx1c:
  s_branch k2_rx1r
k2_stage:
  s_cmp_ge_u32 s40, s34
  s_cbranch_scc1 k2_stage_wo
  s_cmp_le_u32 s75, 61440
  s_cbranch_scc1 k2_fl_9
k2_fl_9r:
  s_add_u32 s75, s75, 6144
  s_mov_b32 m0, s38
  s_sub_u32 s36, s39, 532480
  buffer_load_dwordx4 v1, s[12:15], s39 offen offset:0 sc1 lds
  buffer_load_dwordx4 v1, s[12:15], s39 offen offset:1024 sc1 lds
  buffer_load_dwordx4 v1, s[12:15], s39 offen offset:2048 sc1 lds
  buffer_load_dwordx4 v1, s[12:15], s39 offen offset:3072 sc1 lds
  s_add_u32 m0, s38, 16384
  s_add_u32 s40, s40, 1
  buffer_load_dwordx4 v1, s[12:15], s36 offen offset:0 sc1 lds
  buffer_load_dwordx4 v1, s[12:15], s36 offen offset:1024 sc1 lds
  buffer_load_dwordx4 v1, s[12:15], s36 offen offset:2048 sc1 lds
  buffer_load_dwordx4 v1, s[12:15], s36 offen offset:3072 sc1 lds
  s_add_u32 s39, s39, 16384
  s_add_u32 s38, s38, 32768
  s_and_b32 s38, s38, 0x1ffff
  s_setpc_b64 s[46:47]
k2_fl_2:
  s_cmp_eq_u32 s75, 61440
  s_cbranch_scc1 k2_fl_2s
  s_add_u32 s35, s75, 4096
  buffer_store_dwordx4 v[244:247], v1, s[68:71], s75 offen offset:0 sc1
  buffer_store_dwordx4 v[244:247], v1, s[68:71], s75 offen offset:1024 sc1
  buffer_store_dwordx4 v[244:247], v1, s[68:71], s75 offen offset:2048 sc1
  buffer_store_dwordx4 v[244:247], v1, s[68:71], s75 offen offset:3072 sc1
  buffer_store_dwordx4 v[244:247], v1, s[68:71], s35 offen offset:0 sc1
  buffer_store_dwordx4 v[244:247], v1, s[68:71], s35 offen offset:1024 sc1
  s_branch k2_fl_2r
k2_fl_2s:
  s_add_u32 s35, s31, 64
  s_lshl_b32 s35, s35, 7
  s_mov_b64 exec, 1
  buffer_atomic_add v249, v248, s[76:79], s35 offen sc1
  s_mov_b64 exec, -1
  s_branch k2_fl_2r
k2_fl_9:
  s_cmp_eq_u32 s75, 61440
  s_cbranch_scc1 k2_fl_9s
  s_add_u32 s35, s75, 4096
  buffer_store_dwordx4 v[244:247], v1, s[68:71], s75 offen offset:0 sc1
  buffer_store_dwordx4 v[244:247], v1, s[68:71], s75 offen offset:1024 sc1
  buffer_store_dwordx4 v[244:247], v1, s[68:71], s75 offen offset:2048 sc1
  buffer_store_dwordx4 v[244:247], v1, s[68:71], s75 offen offset:3072 sc1
  buffer_store_dwordx4 v[244:247], v1, s[68:71], s35 offen offset:0 sc1
  buffer_store_dwordx4 v[244:247], v1, s[68:71], s35 offen offset:1024 sc1
  s_branch k2_fl_9r
k2_fl_9s:
  s_add_u32 s35, s31, 64
  s_lshl_b32 s35, s35, 7
  s_mov_b64 exec, 1
  buffer_atomic_add v249, v248, s[76:79], s35 offen sc1
  s_mov_b64 exec, -1
  s_branch k2_fl_9r
k2_stage_wo:
  s_sub_u32 s36, s40, s34
  s_lshl_b32 s35, s36, 1
  s_add_u32 s35, s35, s30
  s_and_b32 s35, s35, 3
  s_lshl_b32 s35, s35, 17
  s_lshr_b32 s36, s36, 1
  s_lshl_b32 s36, s36, 7
  s_add_u32 s35, s35, s36
  s_add_u32 m0, s38, 0
  s_add_u32 s36, s35, s62
  buffer_load_dwordx4 v9, s[64:67], s36 offen lds
  s_add_u32 m0, s38, 1024
  s_add_u32 s36, s35, s62
  s_add_u32 s36, s36, 8192
  buffer_load_dwordx4 v9, s[64:67], s36 offen lds
  s_add_u32 m0, s38, 2048
  s_add_u32 s36, s35, s62
  s_add_u32 s36, s36, 16384
  buffer_load_dwordx4 v9, s[64:67], s36 offen lds
  s_add_u32 m0, s38, 3072
  s_add_u32 s36, s35, s62
  s_add_u32 s36, s36, 24576
  buffer_load_dwordx4 v9, s[64:67], s36 offen lds
  s_add_u32 s35, s35, 0x20000
  s_and_b32 s35, s35, 0x7ffff
  s_add_u32 m0, s38, 16384
  s_add_u32 s36, s35, s62
  buffer_load_dwordx4 v9, s[64:67], s36 offen lds
  s_add_u32 m0, s38, 17408
  s_add_u32 s36, s35, s62
  s_add_u32 s36, s36, 8192
  buffer_load_dwordx4 v9, s[64:67], s36 offen lds
  s_add_u32 m0, s38, 18432
  s_add_u32 s36, s35, s62
  s_add_u32 s36, s36, 16384
  buffer_load_dwordx4 v9, s[64:67], s36 offen lds
  s_add_u32 m0, s38, 19456
  s_add_u32 s36, s35, s62
  s_add_u32 s36, s36, 24576
  buffer_load_dwordx4 v9, s[64:67], s36 offen lds
  s_add_u32 s40, s40, 1
  s_add_u32 s38, s38, 32768
  s_and_b32 s38, s38, 0x1ffff
  s_setpc_b64 s[46:47]
k2_slow_f00:
  s_nop 7
  s_nop 7
  v_max3_f32 v14, v112, v113, v114
  v_max3_f32 v14, v14, v115, v116
  v_max3_f32 v14, v14, v117, v118
  v_max3_f32 v14, v14, v119, v120
  v_max3_f32 v14, v14, v121, v122
  v_max3_f32 v14, v14, v123, v124
  v_max3_f32 v14, v14, v125, v126
  v_max_f32 v14, v14, v127
  v_mov_b32 v15, v14
  s_nop 1
  v_permlane32_swap_b32 v15, v14
  s_nop 0
  v_max_f32 v14, v14, v15
  s_call_b64 s[46:47], k2_rescale
  v_exp_f32 v208, v112
  v_exp_f32 v209, v113
  v_exp_f32 v210, v114
  v_add_f32 v13, v208, v209
  v_cvt_pk_bf16_f32 v144, v208, v209
  v_exp_f32 v211, v115
  v_add_f32 v13, v13, v210
  v_exp_f32 v208, v116
  v_add_f32 v13, v13, v211
  v_cvt_pk_bf16_f32 v145, v210, v211
  v_exp_f32 v209, v117
  v_add_f32 v13, v13, v208
  v_exp_f32 v210, v118
  v_add_f32 v13, v13, v209
  v_cvt_pk_bf16_f32 v146, v208, v209
  v_exp_f32 v211, v119
  v_add_f32 v13, v13, v210
  s_nop 0
  v_add_f32 v13, v13, v211
  v_cvt_pk_bf16_f32 v147, v210, v211
  s_nop 1
  s_branch k2_ret_f00
k2_slow_f01:
  s_nop 7
  s_nop 7
  v_max3_f32 v14, v112, v113, v114
  v_max3_f32 v14, v14, v115, v116
  v_max3_f32 v14, v14, v117, v118
  v_max3_f32 v14, v14, v119, v120
  v_max3_f32 v14, v14, v121, v122
  v_max3_f32 v14, v14, v123, v124
  v_max3_f32 v14, v14, v125, v126
  v_max_f32 v14, v14, v127
  v_mov_b32 v15, v14
  s_nop 1
  v_permlane32_swap_b32 v15, v14
  s_nop 0
  v_max_f32 v14, v14, v15
  s_call_b64 s[46:47], k2_rescale
  v_exp_f32 v208, v120
  v_exp_f32 v209, v121
  v_exp_f32 v210, v122
  v_add_f32 v13, v208, v209
  v_cvt_pk_bf16_f32 v148, v208, v209
  v_exp_f32 v211, v123
  v_add_f32 v13, v13, v210
  v_exp_f32 v208, v124
  v_add_f32 v13, v13, v211
  v_cvt_pk_bf16_f32 v149, v210, v211
  v_exp_f32 v209, v125
  v_add_f32 v13, v13, v208
  v_exp_f32 v210, v126
  v_add_f32 v13, v13, v209
  v_cvt_pk_bf16_f32 v150, v208, v209
  v_exp_f32 v211, v127
  v_add_f32 v13, v13, v210
  s_nop 0
  v_add_f32 v13, v13, v211
  v_cvt_pk_bf16_f32 v151, v210, v211
  s_nop 1
  s_branch k2_ret_f01
k2_slow_f10:
  s_nop 7
  s_nop 7
  v_max3_f32 v14, v128, v129, v130
  v_max3_f32 v14, v14, v131, v132
  v_max3_f32 v14, v14, v133, v134
  v_max3_f32 v14, v14, v135, v136
  v_max3_f32 v14, v14, v137, v138
  v_max3_f32 v14, v14, v139, v140
  v_max3_f32 v14, v14, v141, v142
  v_max_f32 v14, v14, v143
  v_mov_b32 v15, v14
  s_nop 1
  v_permlane32_swap_b32 v15, v14
  s_nop 0
  v_max_f32 v14, v14, v15
  s_call_b64 s[46:47], k2_rescale
  v_exp_f32 v208, v128
  v_exp_f32 v209, v129
  v_exp_f32 v210, v130
  v_add_f32 v13, v208, v209
  v_cvt_pk_bf16_f32 v152, v208, v209
  v_exp_f32 v211, v131
  v_add_f32 v13, v13, v210
  v_exp_f32 v208, v132
  v_add_f32 v13, v13, v211
  v_cvt_pk_bf16_f32 v153, v210, v211
  v_exp_f32 v209, v133
  v_add_f32 v13, v13, v208
  v_exp_f32 v210, v134
  v_add_f32 v13, v13, v209
  v_cvt_pk_bf16_f32 v154, v208, v209
  v_exp_f32 v211, v135
  v_add_f32 v13, v13, v210
  s_nop 0
  v_add_f32 v13, v13, v211
  v_cvt_pk_bf16_f32 v155, v210, v211
  s_nop 1
  s_branch k2_ret_f10
k2_slow_f11:
  s_nop 7
  s_nop 7
  v_max3_f32 v14, v128, v129, v130
  v_max3_f32 v14, v14, v131, v132
  v_max3_f32 v14, v14, v133, v134
  v_max3_f32 v14, v14, v135, v136
  v_max3_f32 v14, v14, v137, v138
  v_max3_f32 v14, v14, v139, v140
  v_max3_f32 v14, v14, v141, v142
  v_max_f32 v14, v14, v143
  v_mov_b32 v15, v14
  s_nop 1
  v_permlane32_swap_b32 v15, v14
  s_nop 0
  v_max_f32 v14, v14, v15
  s_call_b64 s[46:47], k2_rescale
  v_exp_f32 v208, v136
  v_exp_f32 v209, v137
  v_exp_f32 v210, v138
  v_add_f32 v13, v208, v209
  v_cvt_pk_bf16_f32 v156, v208, v209
  v_exp_f32 v211, v139
  v_add_f32 v13, v13, v210
  v_exp_f32 v208, v140
  v_add_f32 v13, v13, v211
  v_cvt_pk_bf16_f32 v157, v210, v211
  v_exp_f32 v209, v141
  v_add_f32 v13, v13, v208
  v_exp_f32 v210, v142
  v_add_f32 v13, v13, v209
  v_cvt_pk_bf16_f32 v158, v208, v209
  v_exp_f32 v211, v143
  v_add_f32 v13, v13, v210
  s_nop 0
  v_add_f32 v13, v13, v211
  v_cvt_pk_bf16_f32 v159, v210, v211
  s_nop 1
  s_branch k2_ret_f11
k2_slow_t00:
  s_nop 7
  s_nop 7
  v_max3_f32 v14, v112, v113, v114
  v_max3_f32 v14, v14, v115, v116
  v_max3_f32 v14, v14, v117, v118
  v_max3_f32 v14, v14, v119, v120
  v_max3_f32 v14, v14, v121, v122
  v_max3_f32 v14, v14, v123, v124
  v_max3_f32 v14, v14, v125, v126
  v_max_f32 v14, v14, v127
  v_mov_b32 v15, v14
  s_nop 1
  v_permlane32_swap_b32 v15, v14
  s_nop 0
  v_max_f32 v14, v14, v15
  s_call_b64 s[46:47], k2_rescale
  v_exp_f32 v208, v112
  v_exp_f32 v209, v113
  v_exp_f32 v210, v114
  v_add_f32 v13, v208, v209
  v_cvt_pk_bf16_f32 v144, v208, v209
  v_exp_f32 v211, v115
  v_add_f32 v13, v13, v210
  v_exp_f32 v208, v116
  v_add_f32 v13, v13, v211
  v_cvt_pk_bf16_f32 v145, v210, v211
  v_exp_f32 v209, v117
  v_add_f32 v13, v13, v208
  v_exp_f32 v210, v118
  v_add_f32 v13, v13, v209
  v_cvt_pk_bf16_f32 v146, v208, v209
  v_exp_f32 v211, v119
  v_add_f32 v13, v13, v210
  s_nop 0
  v_add_f32 v13, v13, v211
  v_cvt_pk_bf16_f32 v147, v210, v211
  s_nop 1
  s_branch k2_ret_t00
k2_slow_t01:
  s_nop 7
  s_nop 7
  v_max3_f32 v14, v112, v113, v114
  v_max3_f32 v14, v14, v115, v116
  v_max3_f32 v14, v14, v117, v118
  v_max3_f32 v14, v14, v119, v120
  v_max3_f32 v14, v14, v121, v122
  v_max3_f32 v14, v14, v123, v124
  v_max3_f32 v14, v14, v125, v126
  v_max_f32 v14, v14, v127
  v_mov_b32 v15, v14
  s_nop 1
  v_permlane32_swap_b32 v15, v14
  s_nop 0
  v_max_f32 v14, v14, v15
  s_call_b64 s[46:47], k2_rescale
  v_exp_f32 v208, v120
  v_exp_f32 v209, v121
  v_exp_f32 v210, v122
  v_add_f32 v13, v208, v209
  v_cvt_pk_bf16_f32 v148, v208, v209
  v_exp_f32 v211, v123
  v_add_f32 v13, v13, v210
  v_exp_f32 v208, v124
  v_add_f32 v13, v13, v211
  v_cvt_pk_bf16_f32 v149, v210, v211
  v_exp_f32 v209, v125
  v_add_f32 v13, v13, v208
  v_exp_f32 v210, v126
  v_add_f32 v13, v13, v209
  v_cvt_pk_bf16_f32 v150, v208, v209
  v_exp_f32 v211, v127
  v_add_f32 v13, v13, v210
  s_nop 0
  v_add_f32 v13, v13, v211
  v_cvt_pk_bf16_f32 v151, v210, v211
  s_nop 1
  s_branch k2_ret_t01
k2_slow_t10:
  s_nop 7
  s_nop 7
  v_max3_f32 v14, v128, v129, v130
  v_max3_f32 v14, v14, v131, v132
  v_max3_f32 v14, v14, v133, v134
  v_max3_f32 v14, v14, v135, v136
  v_max3_f32 v14, v14, v137, v138
  v_max3_f32 v14, v14, v139, v140
  v_max3_f32 v14, v14, v141, v142
  v_max_f32 v14, v14, v143
  v_mov_b32 v15, v14
  s_nop 1
  v_permlane32_swap_b32 v15, v14
  s_nop 0
  v_max_f32 v14, v14, v15
  s_call_b64 s[46:47], k2_rescale
  v_exp_f32 v208, v128
  v_exp_f32 v209, v129
  v_exp_f32 v210, v130
  v_add_f32 v13, v208, v209
  v_cvt_pk_bf16_f32 v152, v208, v209
  v_exp_f32 v211, v131
  v_add_f32 v13, v13, v210
  v_exp_f32 v208, v132
  v_add_f32 v13, v13, v211
  v_cvt_pk_bf16_f32 v153, v210, v211
  v_exp_f32 v209, v133
  v_add_f32 v13, v13, v208
  v_exp_f32 v210, v134
  v_add_f32 v13, v13, v209
  v_cvt_pk_bf16_f32 v154, v208, v209
  v_exp_f32 v211, v135
  v_add_f32 v13, v13, v210
  s_nop 0
  v_add_f32 v13, v13, v211
  v_cvt_pk_bf16_f32 v155, v210, v211
  s_nop 1
  s_branch k2_ret_t10
k2_slow_t11:
  s_nop 7
  s_nop 7
  v_max3_f32 v14, v128, v129, v130
  v_max3_f32 v14, v14, v131, v132
  v_max3_f32 v14, v14, v133, v134
  v_max3_f32 v14, v14, v135, v136
  v_max3_f32 v14, v14, v137, v138
  v_max3_f32 v14, v14, v139, v140
  v_max3_f32 v14, v14, v141, v142
  v_max_f32 v14, v14, v143
  v_mov_b32 v15, v14
  s_nop 1
  v_permlane32_swap_b32 v15, v14
  s_nop 0
  v_max_f32 v14, v14, v15
  s_call_b64 s[46:47], k2_rescale
  v_exp_f32 v208, v136
  v_exp_f32 v209, v137
  v_exp_f32 v210, v138
  v_add_f32 v13, v208, v209
  v_cvt_pk_bf16_f32 v156, v208, v209
  v_exp_f32 v211, v139
  v_add_f32 v13, v13, v210
  v_exp_f32 v208, v140
  v_add_f32 v13, v13, v211
  v_cvt_pk_bf16_f32 v157, v210, v211
  v_exp_f32 v209, v141
  v_add_f32 v13, v13, v208
  v_exp_f32 v210, v142
  v_add_f32 v13, v13, v209
  v_cvt_pk_bf16_f32 v158, v208, v209
  v_exp_f32 v211, v143
  v_add_f32 v13, v13, v210
  s_nop 0
  v_add_f32 v13, v13, v211
  v_cvt_pk_bf16_f32 v159, v210, v211
  s_nop 1
  s_branch k2_ret_t11
k2_rescale:
  v_max_f32 v14, 0, v14
  v_sub_f32 v15, 0, v14
  v_exp_f32 v15, v15
  v_sub_f32 v112, v112, v14
  v_sub_f32 v113, v113, v14
  v_sub_f32 v114, v114, v14
  v_sub_f32 v115, v115, v14
  v_sub_f32 v116, v116, v14
  v_sub_f32 v117, v117, v14
  v_sub_f32 v118, v118, v14
  v_sub_f32 v119, v119, v14
  v_sub_f32 v120, v120, v14
  v_sub_f32 v121, v121, v14
  v_sub_f32 v122, v122, v14
  v_sub_f32 v123, v123, v14
  v_sub_f32 v124, v124, v14
  v_sub_f32 v125, v125, v14
  v_sub_f32 v126, v126, v14
  v_sub_f32 v127, v127, v14
  v_sub_f32 v128, v128, v14
  v_sub_f32 v129, v129, v14
  v_sub_f32 v130, v130, v14
  v_sub_f32 v131, v131, v14
  v_sub_f32 v132, v132, v14
  v_sub_f32 v133, v133, v14
  v_sub_f32 v134, v134, v14
  v_sub_f32 v135, v135, v14
  v_sub_f32 v136, v136, v14
  v_sub_f32 v137, v137, v14
  v_sub_f32 v138, v138, v14
  v_sub_f32 v139, v139, v14
  v_sub_f32 v140, v140, v14
  v_sub_f32 v141, v141, v14
  v_sub_f32 v142, v142, v14
  v_sub_f32 v143, v143, v14
  v_sub_f32 v160, v160, v14
  v_sub_f32 v161, v161, v14
  v_sub_f32 v162, v162, v14
  v_sub_f32 v163, v163, v14
  v_sub_f32 v164, v164, v14
  v_sub_f32 v165, v165, v14
  v_sub_f32 v166, v166, v14
  v_sub_f32 v167, v167, v14
  v_sub_f32 v168, v168, v14
  v_sub_f32 v169, v169, v14
  v_sub_f32 v170, v170, v14
  v_sub_f32 v171, v171, v14
  v_sub_f32 v172, v172, v14
  v_sub_f32 v173, v173, v14
  v_sub_f32 v174, v174, v14
  v_sub_f32 v175, v175, v14
  v_mul_f32 v16, v16, v15
  v_mul_f32 v17, v17, v15
  v_mul_f32 v18, v18, v15
  v_mul_f32 v19, v19, v15
  v_mul_f32 v20, v20, v15
  v_mul_f32 v21, v21, v15
  v_mul_f32 v22, v22, v15
  v_mul_f32 v23, v23, v15
  v_mul_f32 v24, v24, v15
  v_mul_f32 v25, v25, v15
  v_mul_f32 v26, v26, v15
  v_mul_f32 v27, v27, v15
  v_mul_f32 v28, v28, v15
  v_mul_f32 v29, v29, v15
  v_mul_f32 v30, v30, v15
  v_mul_f32 v31, v31, v15
  v_mul_f32 v32, v32, v15
  v_mul_f32 v33, v33, v15
  v_mul_f32 v34, v34, v15
  v_mul_f32 v35, v35, v15
  v_mul_f32 v36, v36, v15
  v_mul_f32 v37, v37, v15
  v_mul_f32 v38, v38, v15
  v_mul_f32 v39, v39, v15
  v_mul_f32 v40, v40, v15
  v_mul_f32 v41, v41, v15
  v_mul_f32 v42, v42, v15
  v_mul_f32 v43, v43, v15
  v_mul_f32 v44, v44, v15
  v_mul_f32 v45, v45, v15
  v_mul_f32 v46, v46, v15
  v_mul_f32 v47, v47, v15
  v_mul_f32 v48, v48, v15
  v_mul_f32 v49, v49, v15
  v_mul_f32 v50, v50, v15
  v_mul_f32 v51, v51, v15
  v_mul_f32 v52, v52, v15
  v_mul_f32 v53, v53, v15
  v_mul_f32 v54, v54, v15
  v_mul_f32 v55, v55, v15
  v_mul_f32 v56, v56, v15
  v_mul_f32 v57, v57, v15
  v_mul_f32 v58, v58, v15
  v_mul_f32 v59, v59, v15
  v_mul_f32 v60, v60, v15
  v_mul_f32 v61, v61, v15
  v_mul_f32 v62, v62, v15
  v_mul_f32 v63, v63, v15
  v_mul_f32 v64, v64, v15
  v_mul_f32 v65, v65, v15
  v_mul_f32 v66, v66, v15
  v_mul_f32 v67, v67, v15
  v_mul_f32 v68, v68, v15
  v_mul_f32 v69, v69, v15
  v_mul_f32 v70, v70, v15
  v_mul_f32 v71, v71, v15
  v_mul_f32 v72, v72, v15
  v_mul_f32 v73, v73, v15
  v_mul_f32 v74, v74, v15
  v_mul_f32 v75, v75, v15
  v_mul_f32 v76, v76, v15
  v_mul_f32 v77, v77, v15
  v_mul_f32 v78, v78, v15
  v_mul_f32 v79, v79, v15
  v_mul_f32 v12, v12, v15
  s_nop 1
  s_setpc_b64 s[46:47]
k2_fin:
adaLN_cond__compressed_kv_cla__geglu_ffn__prompt_kernel_end:
  s_endpgm
text_end:
.section .rodata,"a"
.p2align 6
.amdhsa_kernel adaLN_cond__compressed_kv_cla__geglu_ffn__prompt_kernel
  .amdhsa_next_free_vgpr 256
  .amdhsa_next_free_sgpr 102
  .amdhsa_accum_offset 256
  .amdhsa_group_segment_fixed_size 0
  .amdhsa_kernarg_size 120
  .amdhsa_user_sgpr_count 2
  .amdhsa_user_sgpr_kernarg_segment_ptr 1
  .amdhsa_system_sgpr_workgroup_id_x 1
  .amdhsa_float_denorm_mode_32 3
.end_amdhsa_kernel
```
